```python
import torch

def _softmax(x, axis=-1):
    return torch.softmax(x, dim=axis)
def _gelu(x):
    return torch.nn.functional.gelu(x, approximate="tanh")
def _silu(x):
    return torch.nn.functional.silu(x)
def _sigmoid(x):
    return torch.sigmoid(x)
def _layernorm(x, axis=-1, eps=1e-5):
    m = x.mean(dim=axis, keepdim=True)
    v = x.var(dim=axis, keepdim=True, unbiased=False)
    return (x - m) / torch.sqrt(v + eps)
def _scatter_add(tgt, idx, src, axis=0):
    return tgt.clone().index_add_(axis, idx, src)
def _segment_sum(src, seg, n):
    out = torch.zeros((n,) + src.shape[1:], dtype=src.dtype)
    return out.index_add_(0, seg, src)
def _pad(x, pw):
    flat = tuple(v for pair in reversed(pw) for v in pair)
    return torch.nn.functional.pad(x, flat)

kernel_name = 'sequential_preLN__softmax_full_mha__dense_activation_gelu__prompt'

def setup_inputs():

    _w = (lambda a: (lambda t: t.to(torch.bfloat16) if t.is_floating_point() else t)(torch.as_tensor(a)))
    def _A_setup():
        B, S, D = 1, 2048, 640
        return {
            "x": _w((lambda *s: torch.randn(*s, dtype=torch.bfloat16) * 0.05)(B, S, D)),
            "wqkv": _w((lambda *s: torch.randn(*s, dtype=torch.bfloat16) * 0.05)(D, 3 * D)),
            "wo": _w((lambda *s: torch.randn(*s, dtype=torch.bfloat16) * 0.05)(D, D)),
        }
    _A_in = _A_setup()

    def _B_setup():
        B, S, D, F = 1, 2048, 640, 1728
        return {
            "x": _w((lambda *s: torch.randn(*s, dtype=torch.bfloat16) * 0.05)(B, S, D)),
            "w1": _w((lambda *s: torch.randn(*s, dtype=torch.bfloat16) * 1.6)(D, F) * (D ** -0.5)),
            "b1": _w((lambda *s: torch.randn(*s, dtype=torch.bfloat16) * 1.6)(F) * 0.01),
            "w2": _w((lambda *s: torch.randn(*s, dtype=torch.bfloat16) * 0.2)(F, D) * (F ** -0.5)),
            "b2": _w((lambda *s: torch.randn(*s, dtype=torch.bfloat16) * 0.2)(D) * 0.01),
        }
    _B_in = _B_setup()

    return {
        "A_x": _A_in["x"],
        "A_wqkv": _A_in["wqkv"],
        "A_wo": _A_in["wo"],
        "B_x": _B_in["x"],
        "B_w1": _B_in["w1"],
        "B_b1": _B_in["b1"],
        "B_w2": _B_in["w2"],
        "B_b2": _B_in["b2"],
    }

def reference(A_x, A_wqkv, A_wo, B_x, B_w1, B_b1, B_w2, B_b2):
    def _A_ref(x, wqkv, wo):
        B, S, D = x.shape
        H = 32; Dh = D // H
        qkv = (lambda x, *d: x.permute(*d))((x @ wqkv).reshape(B, S, 3, H, Dh), 2, 0, 3, 1, 4)
        q, k, v = qkv[0], qkv[1], qkv[2]
        scale = Dh ** -0.5
        scores = torch.einsum("bhqd,bhkd->bhqk", q, k) * scale
        p = _softmax(scores, axis=-1)
        o = torch.einsum("bhqk,bhkd->bhqd", p, v)
        return (lambda x, *d: x.permute(*d))(o, 0, 2, 1, 3).reshape(B, S, D) @ wo

    def _B_ref(x, w1, b1, w2, b2):
        h = torch.einsum("bsd,df->bsf", x, w1) + b1
        h = _gelu(h)
        return torch.einsum("bsf,fd->bsd", h, w2) + b2

    x = A_x
    h = x + _A_ref(_layernorm(x, axis=-1), A_wqkv, A_wo)
    h2 = h + _B_ref(_layernorm(h, axis=-1), B_w1, B_b1, B_w2, B_b2)
    return h2
```

```asm
; @launch grid=(256,1,1) block=(512,1,1) lds=163840
.amdgcn_target "amdgcn-amd-amdhsa--gfx950"
.text
.globl sequential_preLN__softmax_full_mha__dense_activation_gelu__prompt_kernel
.p2align 8
.type sequential_preLN__softmax_full_mha__dense_activation_gelu__prompt_kernel,@function
sequential_preLN__softmax_full_mha__dense_activation_gelu__prompt_kernel:
    s_cmp_ge_u32 s2, 256
    s_cbranch_scc1 Lend
    s_load_dwordx16 s[64:79], s[0:1], 0
    s_load_dwordx4 s[80:83], s[0:1], 64
    s_load_dwordx2 s[84:85], s[0:1], 80
    v_lshrrev_b32 v1, 6, v0
    v_and_b32 v0, 63, v0
    s_getreg_b32 s60, hwreg(HW_REG_XCC_ID, 0, 3)
    v_readfirstlane_b32 s3, v1
    s_getreg_b32 s61, hwreg(HW_REG_HW_ID, 13, 2)
    s_lshl_b32 s61, s61, 3
    s_add_u32 s60, s60, s61
    v_mov_b32 v201, 134144
    s_cmp_lg_u32 s3, 7
    s_cbranch_scc1 Lnocp
    s_getpc_b64 s[90:91]
Uc1:
    s_add_u32 s90, s90, sequential_preLN__softmax_full_mha__dense_activation_gelu__prompt_kernel-Uc1
    s_addc_u32 s91, s91, -1
    v_lshlrev_b32 v207, 7, v0
    v_min_u32 v204, Lcode_end-sequential_preLN__softmax_full_mha__dense_activation_gelu__prompt_kernel-4, v207
    v_mov_b32 v205, s91
    v_add_co_u32 v204, vcc, s90, v204
    v_add_u32 v207, 8192, v207
    s_nop 0
    v_addc_co_u32 v205, vcc, 0, v205, vcc
    global_load_dword v206, v[204:205], off
    v_min_u32 v204, Lcode_end-sequential_preLN__softmax_full_mha__dense_activation_gelu__prompt_kernel-4, v207
    v_mov_b32 v205, s91
    v_add_co_u32 v204, vcc, s90, v204
    v_add_u32 v207, 8192, v207
    s_nop 0
    v_addc_co_u32 v205, vcc, 0, v205, vcc
    global_load_dword v206, v[204:205], off
    v_min_u32 v204, Lcode_end-sequential_preLN__softmax_full_mha__dense_activation_gelu__prompt_kernel-4, v207
    v_mov_b32 v205, s91
    v_add_co_u32 v204, vcc, s90, v204
    v_add_u32 v207, 8192, v207
    s_nop 0
    v_addc_co_u32 v205, vcc, 0, v205, vcc
    global_load_dword v206, v[204:205], off
Lnocp:
    s_and_b32 s28, s3, 3
    s_cmp_lt_u32 s3, 4
    s_cbranch_scc1 Lc1
    v_lshrrev_b32 v2, 3, v0
    v_and_b32 v3, 7, v0
    v_lshrrev_b32 v4, 4, v0
    v_xor_b32 v3, v3, v4
    v_mul_u32_u24 v2, 1280, v2
    v_lshl_add_u32 v10, v3, 4, v2
    v_xor_b32 v5, 64, v10
    v_add_u32 v11, 9216, v5
    v_add_u32 v12, 18432, v10
    v_add_u32 v13, 27648, v5
    v_and_b32 v3, 15, v0
    v_lshlrev_b32 v5, 2, v4
    v_xor_b32 v3, v3, v5
    v_mul_u32_u24 v14, 3840, v4
    v_lshl_add_u32 v14, v3, 4, v14
    v_xor_b32 v5, 32, v14
    v_add_u32 v15, 14336, v14
    v_add_u32 v16, 28672, v5
    v_add_u32 v17, 43008, v5
    s_bfe_u32 s44, s60, 0x20001
    s_lshl_b32 s44, s44, 2
    s_lshr_b32 s33, s60, 3
    s_add_u32 s44, s44, s33
    s_mul_i32 s45, s28, 40960
    s_lshl_b32 s39, s28, 12
    s_waitcnt lgkmcnt(0)
    s_mov_b32 s12, s64
    s_mov_b32 s13, s65
    s_mov_b32 s14, 2621440
    s_mov_b32 s15, 0x20000
    s_or_b32 s33, s2, s28
    s_cbranch_scc1 Lh_nz
    s_memrealtime s[34:35]
    s_waitcnt lgkmcnt(0)
    s_or_b32 s34, s34, 1
    s_atomic_swap s34, s[82:83], 0
Lh_nz:
    s_mul_i32 s36, s44, 163840
    s_add_u32 s36, s36, s45
    s_add_u32 m0, s39, 0
    s_nop 0
    buffer_load_dwordx4 v10, s[12:15], s36 offen offset:0 lds
    buffer_load_dwordx4 v11, s[12:15], s36 offen offset:1024 lds
    buffer_load_dwordx4 v12, s[12:15], s36 offen offset:2048 lds
    buffer_load_dwordx4 v13, s[12:15], s36 offen offset:3072 lds
    s_add_u32 s36, s36, 128
    s_mov_b32 s16, s66
    s_mov_b32 s17, s67
    s_mov_b32 s18, 2457600
    s_mov_b32 s19, 0x20000
    s_mov_b32 s20, s84
    s_mov_b32 s21, s85
    s_mov_b32 s22, 29450240
    s_mov_b32 s23, 0x20000
    s_getreg_b32 s33, hwreg(HW_REG_HW_ID, 9, 7)
    s_lshl_b32 s33, s33, 2
    s_add_u32 s33, s33, s28
    s_cmp_lg_u32 s33, 7
    s_cbranch_scc1 Lh_np
    s_getpc_b64 s[90:91]
Uc2:
    s_add_u32 s90, s90, Lc1e-Uc2
    s_addc_u32 s91, s91, 0
    v_lshlrev_b32 v207, 7, v0
    v_min_u32 v204, Lcode_end-Lc1e-4, v207
    v_mov_b32 v205, s91
    v_add_co_u32 v204, vcc, s90, v204
    v_add_u32 v207, 8192, v207
    s_nop 0
    v_addc_co_u32 v205, vcc, 0, v205, vcc
    global_load_dword v206, v[204:205], off
    v_min_u32 v204, Lcode_end-Lc1e-4, v207
    v_mov_b32 v205, s91
    v_add_co_u32 v204, vcc, s90, v204
    v_add_u32 v207, 8192, v207
    s_nop 0
    v_addc_co_u32 v205, vcc, 0, v205, vcc
    global_load_dword v206, v[204:205], off
    v_min_u32 v204, Lcode_end-Lc1e-4, v207
    v_mov_b32 v205, s91
    v_add_co_u32 v204, vcc, s90, v204
    v_add_u32 v207, 8192, v207
    s_nop 0
    v_addc_co_u32 v205, vcc, 0, v205, vcc
    global_load_dword v206, v[204:205], off
    v_min_u32 v204, Lcode_end-Lc1e-4, v207
    v_mov_b32 v205, s91
    v_add_co_u32 v204, vcc, s90, v204
    v_add_u32 v207, 8192, v207
    s_nop 0
    v_addc_co_u32 v205, vcc, 0, v205, vcc
    global_load_dword v206, v[204:205], off
    v_min_u32 v204, Lcode_end-Lc1e-4, v207
    v_mov_b32 v205, s91
    v_add_co_u32 v204, vcc, s90, v204
    v_add_u32 v207, 8192, v207
    s_nop 0
    v_addc_co_u32 v205, vcc, 0, v205, vcc
    global_load_dword v206, v[204:205], off
Lh_np:
    s_cmp_lg_u32 s3, 0
    s_cbranch_scc1 Ut5
    s_mov_b32 s61, 31
Ut3:
    s_waitcnt lgkmcnt(0)
    s_cmp_lt_u32 s57, 8
    s_cbranch_scc1 Ut4
    s_sub_u32 s61, s61, 1
    s_cbranch_scc1 Ut4
    s_add_u32 s60, s60, 1
    s_and_b32 s60, s60, 31
    s_lshl_b32 s57, s60, 3
    s_add_u32 s86, s82, s57
    s_addc_u32 s87, s83, 0
    s_mov_b32 s57, 1
    s_atomic_add s57, s[86:87], 4 glc
    s_branch Ut3
Ut4:
    s_and_b32 s57, s57, 7
    s_lshl_b32 s57, s57, 5
    s_add_u32 s57, s57, s60
    v_mov_b32 v200, s57
    ds_write_b32 v201, v200
    s_waitcnt lgkmcnt(0)
Ut5:
    s_barrier
    ds_read_b32 v200, v201
    s_waitcnt lgkmcnt(0)
    v_readfirstlane_b32 s32, v200
    s_nop 0
    s_and_b32 s31, s32, 7
    s_lshr_b32 s32, s32, 3
    s_and_b32 s33, s31, 1
    s_lshl_b32 s33, s33, 3
    s_lshr_b32 s30, s32, 2
    s_add_u32 s30, s30, s33
    s_and_b32 s33, s32, 3
    s_lshr_b32 s29, s31, 1
    s_lshl_b32 s29, s29, 2
    s_add_u32 s29, s29, s33
    s_cmp_eq_u32 s30, 15
    s_cbranch_scc1 Lspare_h
    s_cmp_eq_u32 s29, s44
    s_cbranch_scc1 Lh_go
    s_waitcnt vmcnt(0)
    s_mul_i32 s36, s29, 163840
    s_add_u32 s36, s36, s45
    s_add_u32 m0, s39, 0
    s_nop 0
    buffer_load_dwordx4 v10, s[12:15], s36 offen offset:0 lds
    buffer_load_dwordx4 v11, s[12:15], s36 offen offset:1024 lds
    buffer_load_dwordx4 v12, s[12:15], s36 offen offset:2048 lds
    buffer_load_dwordx4 v13, s[12:15], s36 offen offset:3072 lds
    s_add_u32 s36, s36, 128
Lh_go:
    s_lshl_b32 s37, s30, 8
    s_mul_i32 s33, s28, 61440
    s_add_u32 s37, s37, s33
    s_add_u32 m0, s39, 16384
    s_nop 0
    buffer_load_dwordx4 v14, s[16:19], s37 offen offset:0 lds
    buffer_load_dwordx4 v15, s[16:19], s37 offen offset:1024 lds
    buffer_load_dwordx4 v16, s[16:19], s37 offen offset:2048 lds
    buffer_load_dwordx4 v17, s[16:19], s37 offen offset:3072 lds
    s_add_u32 s37, s37, 245760
    s_add_u32 m0, s39, 32768
    s_nop 0
    buffer_load_dwordx4 v10, s[12:15], s36 offen offset:0 lds
    buffer_load_dwordx4 v11, s[12:15], s36 offen offset:1024 lds
    buffer_load_dwordx4 v12, s[12:15], s36 offen offset:2048 lds
    buffer_load_dwordx4 v13, s[12:15], s36 offen offset:3072 lds
    s_add_u32 s36, s36, 128
    s_add_u32 m0, s39, 49152
    s_nop 0
    buffer_load_dwordx4 v14, s[16:19], s37 offen offset:0 lds
    buffer_load_dwordx4 v15, s[16:19], s37 offen offset:1024 lds
    buffer_load_dwordx4 v16, s[16:19], s37 offen offset:2048 lds
    buffer_load_dwordx4 v17, s[16:19], s37 offen offset:3072 lds
    s_add_u32 s37, s37, 245760
    s_add_u32 m0, s39, 65536
    s_nop 0
    buffer_load_dwordx4 v10, s[12:15], s36 offen offset:0 lds
    buffer_load_dwordx4 v11, s[12:15], s36 offen offset:1024 lds
    buffer_load_dwordx4 v12, s[12:15], s36 offen offset:2048 lds
    buffer_load_dwordx4 v13, s[12:15], s36 offen offset:3072 lds
    s_add_u32 s36, s36, 128
    s_mov_b32 s24, s82
    s_mov_b32 s25, s83
    s_mov_b32 s26, 256
    s_mov_b32 s27, 0x20000
    v_mov_b32 v205, 0
    v_and_b32 v2, 31, v0
    v_lshrrev_b32 v3, 5, v0
    s_lshl_b32 s33, s29, 2
    s_add_u32 s33, s33, s28
    s_lshl_b32 s40, s33, 2
    s_lshl_b32 s41, s30, 1
    s_lshr_b32 s42, s28, 1
    s_add_u32 s41, s41, s42
    s_lshl_b32 s41, s41, 3
    s_sub_u32 s41, s41, 4
    v_min_u32 v4, 11, v0
    v_add_u32 v5, s40, v4
    v_cmp_gt_u32 vcc, 4, v4
    v_add_u32 v4, s41, v4
    s_lshl_b32 s40, s33, 9
    v_cndmask_b32 v4, v4, v5, vcc
    v_cndmask_b32 v5, 8, v205, vcc
    v_lshl_add_u32 v4, v4, 7, v5
    v_add_u32 v20, 28434432, v4
    s_add_u32 s40, s40, 28278784
    v_lshlrev_b32 v21, 4, v2
    v_mul_u32_u24 v22, 61440, v3
    v_lshl_add_u32 v22, v2, 2, v22
    s_lshl_b32 s41, s30, 2
    s_add_u32 s41, s41, s28
    s_lshl_b32 s41, s41, 7
    s_add_u32 s41, s41, 28311552
    v_mov_b32 v45, 0
    s_lshl_b32 s33, s28, 5
    v_add_u32 v2, s33, v2
    v_lshlrev_b32 v26, 3, v2
    v_add_u32 v26, 131072, v26
    v_lshlrev_b32 v27, 2, v2
    v_add_u32 v27, 132096, v27
    s_waitcnt vmcnt(12)
    s_barrier
    s_add_u32 m0, s39, 81920
    s_nop 0
    buffer_load_dwordx4 v14, s[16:19], s37 offen offset:0 lds
    buffer_load_dwordx4 v15, s[16:19], s37 offen offset:1024 lds
    buffer_load_dwordx4 v16, s[16:19], s37 offen offset:2048 lds
    buffer_load_dwordx4 v17, s[16:19], s37 offen offset:3072 lds
    s_add_u32 s37, s37, 245760
    s_add_u32 m0, s39, 98304
    s_nop 0
    buffer_load_dwordx4 v10, s[12:15], s36 offen offset:0 lds
    buffer_load_dwordx4 v11, s[12:15], s36 offen offset:1024 lds
    buffer_load_dwordx4 v12, s[12:15], s36 offen offset:2048 lds
    buffer_load_dwordx4 v13, s[12:15], s36 offen offset:3072 lds
    s_add_u32 s36, s36, 128
    s_waitcnt vmcnt(12)
    s_barrier
    s_add_u32 m0, s39, 114688
    s_nop 0
    buffer_load_dwordx4 v14, s[16:19], s37 offen offset:0 lds
    buffer_load_dwordx4 v15, s[16:19], s37 offen offset:1024 lds
    buffer_load_dwordx4 v16, s[16:19], s37 offen offset:2048 lds
    buffer_load_dwordx4 v17, s[16:19], s37 offen offset:3072 lds
    s_add_u32 s37, s37, 245760
    s_add_u32 m0, s39, 0
    s_nop 0
    buffer_load_dwordx4 v10, s[12:15], s36 offen offset:0 lds
    buffer_load_dwordx4 v11, s[12:15], s36 offen offset:1024 lds
    buffer_load_dwordx4 v12, s[12:15], s36 offen offset:2048 lds
    buffer_load_dwordx4 v13, s[12:15], s36 offen offset:3072 lds
    s_add_u32 s36, s36, 128
    s_waitcnt vmcnt(12)
    s_barrier
    s_add_u32 m0, s39, 16384
    s_nop 0
    buffer_load_dwordx4 v14, s[16:19], s37 offen offset:0 lds
    buffer_load_dwordx4 v15, s[16:19], s37 offen offset:1024 lds
    buffer_load_dwordx4 v16, s[16:19], s37 offen offset:2048 lds
    buffer_load_dwordx4 v17, s[16:19], s37 offen offset:3072 lds
    s_add_u32 s37, s37, 245760
    s_add_u32 m0, s39, 32768
    s_nop 0
    buffer_load_dwordx4 v10, s[12:15], s36 offen offset:0 lds
    buffer_load_dwordx4 v11, s[12:15], s36 offen offset:1024 lds
    buffer_load_dwordx4 v12, s[12:15], s36 offen offset:2048 lds
    buffer_load_dwordx4 v13, s[12:15], s36 offen offset:3072 lds
    s_add_u32 s36, s36, 128
    s_waitcnt vmcnt(12)
    s_barrier
    s_add_u32 m0, s39, 49152
    s_nop 0
    buffer_load_dwordx4 v14, s[16:19], s37 offen offset:0 lds
    buffer_load_dwordx4 v15, s[16:19], s37 offen offset:1024 lds
    buffer_load_dwordx4 v16, s[16:19], s37 offen offset:2048 lds
    buffer_load_dwordx4 v17, s[16:19], s37 offen offset:3072 lds
    s_add_u32 s37, s37, 245760
    s_add_u32 m0, s39, 65536
    s_nop 0
    buffer_load_dwordx4 v10, s[12:15], s36 offen offset:0 lds
    buffer_load_dwordx4 v11, s[12:15], s36 offen offset:1024 lds
    buffer_load_dwordx4 v12, s[12:15], s36 offen offset:2048 lds
    buffer_load_dwordx4 v13, s[12:15], s36 offen offset:3072 lds
    s_add_u32 s36, s36, 128
    s_waitcnt vmcnt(12)
    s_barrier
    s_add_u32 m0, s39, 81920
    s_nop 0
    buffer_load_dwordx4 v14, s[16:19], s37 offen offset:0 lds
    buffer_load_dwordx4 v15, s[16:19], s37 offen offset:1024 lds
    buffer_load_dwordx4 v16, s[16:19], s37 offen offset:2048 lds
    buffer_load_dwordx4 v17, s[16:19], s37 offen offset:3072 lds
    s_add_u32 s37, s37, 245760
    s_add_u32 m0, s39, 98304
    s_nop 0
    buffer_load_dwordx4 v10, s[12:15], s36 offen offset:0 lds
    buffer_load_dwordx4 v11, s[12:15], s36 offen offset:1024 lds
    buffer_load_dwordx4 v12, s[12:15], s36 offen offset:2048 lds
    buffer_load_dwordx4 v13, s[12:15], s36 offen offset:3072 lds
    s_add_u32 s36, s36, 128
    s_waitcnt vmcnt(12)
    s_barrier
    s_add_u32 m0, s39, 114688
    s_nop 0
    buffer_load_dwordx4 v14, s[16:19], s37 offen offset:0 lds
    buffer_load_dwordx4 v15, s[16:19], s37 offen offset:1024 lds
    buffer_load_dwordx4 v16, s[16:19], s37 offen offset:2048 lds
    buffer_load_dwordx4 v17, s[16:19], s37 offen offset:3072 lds
    s_add_u32 s37, s37, 245760
    s_add_u32 m0, s39, 0
    s_nop 0
    buffer_load_dwordx4 v10, s[12:15], s36 offen offset:0 lds
    buffer_load_dwordx4 v11, s[12:15], s36 offen offset:1024 lds
    buffer_load_dwordx4 v12, s[12:15], s36 offen offset:2048 lds
    buffer_load_dwordx4 v13, s[12:15], s36 offen offset:3072 lds
    s_add_u32 s36, s36, 128
    s_waitcnt vmcnt(12)
    s_barrier
    buffer_load_dword v204, v205, s[24:27], 0 offen sc1
    buffer_load_dwordx2 v[24:25], v20, s[20:23], 0 offen sc1
    s_add_u32 m0, s39, 16384
    s_nop 0
    buffer_load_dwordx4 v14, s[16:19], s37 offen offset:0 lds
    buffer_load_dwordx4 v15, s[16:19], s37 offen offset:1024 lds
    buffer_load_dwordx4 v16, s[16:19], s37 offen offset:2048 lds
    buffer_load_dwordx4 v17, s[16:19], s37 offen offset:3072 lds
    s_add_u32 s37, s37, 245760
    s_add_u32 m0, s39, 32768
    s_nop 0
    buffer_load_dwordx4 v10, s[12:15], s36 offen offset:0 lds
    buffer_load_dwordx4 v11, s[12:15], s36 offen offset:1024 lds
    buffer_load_dwordx4 v12, s[12:15], s36 offen offset:2048 lds
    buffer_load_dwordx4 v13, s[12:15], s36 offen offset:3072 lds
    s_add_u32 s36, s36, 128
    s_waitcnt vmcnt(14)
    s_barrier
    s_add_u32 m0, s39, 49152
    s_nop 0
    buffer_load_dwordx4 v14, s[16:19], s37 offen offset:0 lds
    buffer_load_dwordx4 v15, s[16:19], s37 offen offset:1024 lds
    buffer_load_dwordx4 v16, s[16:19], s37 offen offset:2048 lds
    buffer_load_dwordx4 v17, s[16:19], s37 offen offset:3072 lds
    s_add_u32 s37, s37, 245760
    s_waitcnt vmcnt(8)
    s_barrier
    s_waitcnt vmcnt(12)
    s_mov_b32 s60, 200000
Uz6:
    v_readfirstlane_b32 s100, v204
    s_nop 0
    s_cmp_lg_u32 s100, 0
    s_cbranch_scc1 Uz7
    buffer_load_dword v204, v205, s[24:27], 0 offen sc1
    s_waitcnt vmcnt(0)
    s_sub_u32 s60, s60, 1
    s_cbranch_scc0 Uz6
Uz7:
    s_mov_b32 s101, s100
    v_xor_b32 v24, s100, v24
    v_xor_b32 v25, s100, v25
    v_or_b32 v24, v24, v25
    v_cmp_ne_u32 vcc, 0, v24
    s_nop 1
    s_cmp_lg_u64 vcc, 0
    s_cbranch_scc0 Lh_ok
    s_mov_b32 s60, 200000
Up8:
    buffer_load_dwordx2 v[4:5], v20, s[20:23], 0 offen sc1
    s_sub_u32 s60, s60, 1
    s_cbranch_scc1 Ue9
    s_waitcnt vmcnt(0)
    v_xor_b32 v4, s100, v4
    v_xor_b32 v5, s100, v5
    v_or_b32 v4, v4, v5
    v_cmp_ne_u32 vcc, 0, v4
    s_nop 1
    s_cmp_lg_u64 vcc, 0
    s_cbranch_scc1 Up8
Ue9:
    s_waitcnt vmcnt(0)
    s_mov_b64 exec, -1
Lh_ok:
    buffer_load_dwordx4 v[40:43], v21, s[20:23], s40 offen sc1
    buffer_load_dword v48, v22, s[20:23], s41 offen sc1
    s_add_u32 s41, s41, 7680
    buffer_load_dword v49, v22, s[20:23], s41 offen sc1
    s_add_u32 s41, s41, 7680
    buffer_load_dword v50, v22, s[20:23], s41 offen sc1
    s_add_u32 s41, s41, 7680
    buffer_load_dword v51, v22, s[20:23], s41 offen sc1
    s_add_u32 s41, s41, 7680
    buffer_load_dword v52, v22, s[20:23], s41 offen sc1
    s_add_u32 s41, s41, 7680
    buffer_load_dword v53, v22, s[20:23], s41 offen sc1
    s_add_u32 s41, s41, 7680
    buffer_load_dword v54, v22, s[20:23], s41 offen sc1
    s_add_u32 s41, s41, 7680
    buffer_load_dword v55, v22, s[20:23], s41 offen sc1
    s_add_u32 s41, s41, 7680
    s_waitcnt vmcnt(9)
    s_barrier
    s_setprio 3
    s_waitcnt vmcnt(0)
    v_add_f32 v48, v48, v52
    v_add_f32 v49, v49, v53
    v_add_f32 v50, v50, v54
    v_add_f32 v51, v51, v55
    v_add_f32 v48, v48, v50
    v_add_f32 v49, v49, v51
    v_add_f32 v36, v48, v49
    v_mov_b32 v37, v36
    s_nop 1
    v_permlane32_swap_b32 v36, v37
    v_add_f32 v36, v36, v37
    v_cvt_pk_bf16_f32 v37, v36, v36
    v_lshlrev_b32 v37, 16, v37
    v_sub_f32 v36, v36, v37
    v_cvt_pk_bf16_f32 v44, v37, v36
    ds_write_b64 v26, v[40:41]
    ds_write_b32 v27, v42
    ds_write_b64 v26, v[44:45] offset:2048
    s_waitcnt lgkmcnt(0)
    s_barrier
    s_branch Lh2
Lc1:
    s_cmp_lg_u32 s3, 0
    s_waitcnt lgkmcnt(0)
    s_cbranch_scc1 Lnoask
    s_and_b32 s60, s60, 31
    s_lshl_b32 s57, s60, 3
    s_add_u32 s86, s82, s57
    s_addc_u32 s87, s83, 0
    s_mov_b32 s57, 1
    s_atomic_add s57, s[86:87], 4 glc
Lnoask:
    s_mov_b32 s20, s84
    s_mov_b32 s21, s85
    s_mov_b32 s22, 29450240
    s_mov_b32 s23, 0x20000
    s_cmp_ge_u32 s3, 2
    s_cbranch_scc1 Lst_w
    s_mov_b32 s12, s64
    s_mov_b32 s13, s65
    s_mov_b32 s14, 2621440
    s_mov_b32 s15, 0x20000
    v_lshrrev_b32 v228, 4, v0
    v_and_b32 v229, 15, v0
    v_mul_u32_u24 v230, 1280, v228
    v_lshl_add_u32 v230, v229, 4, v230
    s_lshl_b32 s33, s2, 1
    s_add_u32 s33, s33, s3
    s_mul_i32 s34, s33, 5120
    buffer_load_dwordx4 v[208:211], v230, s[12:15], s34 offen offset:0
    buffer_load_dwordx4 v[212:215], v230, s[12:15], s34 offen offset:256
    buffer_load_dwordx4 v[216:219], v230, s[12:15], s34 offen offset:512
    buffer_load_dwordx4 v[220:223], v230, s[12:15], s34 offen offset:768
    buffer_load_dwordx4 v[224:227], v230, s[12:15], s34 offen offset:1024
    s_branch Lst_i
Lst_w:
    s_mov_b32 s12, s66
    s_mov_b32 s13, s67
    s_mov_b32 s14, 2457600
    s_mov_b32 s15, 0x20000
    v_lshrrev_b32 v228, 3, v0
    v_and_b32 v229, 7, v0
    v_mul_u32_u24 v230, 3840, v228
    v_lshl_add_u32 v230, v229, 4, v230
    s_and_b32 s33, s2, 7
    s_lshl_b32 s33, s33, 1
    s_add_u32 s33, s33, s3
    s_sub_u32 s33, s33, 2
    s_mul_i32 s34, s33, 153600
    s_lshr_b32 s35, s2, 3
    s_min_u32 s35, s35, 29
    s_lshl_b32 s36, s35, 7
    s_add_u32 s34, s34, s36
    buffer_load_dwordx4 v[208:211], v230, s[12:15], s34 offen
    s_add_u32 s34, s34, 30720
    buffer_load_dwordx4 v[212:215], v230, s[12:15], s34 offen
    s_add_u32 s34, s34, 30720
    buffer_load_dwordx4 v[216:219], v230, s[12:15], s34 offen
    s_add_u32 s34, s34, 30720
    buffer_load_dwordx4 v[220:223], v230, s[12:15], s34 offen
    s_add_u32 s34, s34, 30720
    buffer_load_dwordx4 v[224:227], v230, s[12:15], s34 offen
    s_add_u32 s34, s34, 30720
Lst_i:
    s_mov_b32 s52, s33
    s_mov_b32 s53, s35
    s_and_b32 s34, s28, 1
    s_lshr_b32 s35, s28, 1
    v_and_b32 v2, 15, v0
    v_lshrrev_b32 v3, 4, v0
    v_bfe_u32 v4, v0, 1, 3
    v_xor_b32 v4, v4, v3
    v_lshlrev_b32 v4, 4, v4
    v_lshl_add_u32 v4, v2, 7, v4
    s_lshl_b32 s33, s34, 13
    v_add_u32 v10, s33, v4
    v_xor_b32 v11, 64, v10
    v_add_u32 v12, 0x10000, v10
    v_add_u32 v13, 0x10000, v11
    v_bfe_u32 v4, v0, 2, 2
    v_lshl_add_u32 v5, v3, 3, v4
    v_lshlrev_b32 v5, 8, v5
    v_and_b32 v6, 1, v3
    v_lshl_add_u32 v5, v6, 5, v5
    v_and_b32 v7, 3, v0
    v_lshl_add_u32 v5, v7, 3, v5
    v_add_u32 v5, 16384, v5
    s_lshl_b32 s33, s35, 1
    v_xor_b32 v4, s33, v4
    v_lshl_add_u32 v14, v4, 6, v5
    v_xor_b32 v15, 32, v14
    v_xor_b32 v16, 64, v14
    v_xor_b32 v17, 96, v14
    v_add_u32 v18, 0x10000, v14
    v_add_u32 v19, 0x10000, v15
    v_add_u32 v20, 0x10000, v16
    v_add_u32 v21, 0x10000, v17
    s_lshl_b32 s33, s34, 6
    v_add_u32 v22, s33, v2
    v_lshlrev_b32 v23, 2, v22
    v_add_u32 v23, 132096, v23
    v_lshlrev_b32 v22, 3, v22
    v_add_u32 v22, 131072, v22
    s_lshl_b32 s33, s35, 6
    v_add_u32 v24, s33, v2
    v_lshlrev_b32 v24, 3, v24
    v_add_u32 v24, 133120, v24
    s_lshl_b32 s33, s34, 8
    s_add_u32 s33, s33, 132096
    v_lshl_add_u32 v25, v3, 4, s33
    s_cmp_lg_u32 s3, 0
    s_cbranch_scc1 Ut12
    s_mov_b32 s61, 31
Ut10:
    s_waitcnt lgkmcnt(0)
    s_cmp_lt_u32 s57, 8
    s_cbranch_scc1 Ut11
    s_sub_u32 s61, s61, 1
    s_cbranch_scc1 Ut11
    s_add_u32 s60, s60, 1
    s_and_b32 s60, s60, 31
    s_lshl_b32 s57, s60, 3
    s_add_u32 s86, s82, s57
    s_addc_u32 s87, s83, 0
    s_mov_b32 s57, 1
    s_atomic_add s57, s[86:87], 4 glc
    s_branch Ut10
Ut11:
    s_and_b32 s57, s57, 7
    s_lshl_b32 s57, s57, 5
    s_add_u32 s57, s57, s60
    v_mov_b32 v200, s57
    ds_write_b32 v201, v200
    s_waitcnt lgkmcnt(0)
Ut12:
    s_barrier
    ds_read_b32 v200, v201
    s_waitcnt lgkmcnt(0)
    v_readfirstlane_b32 s32, v200
    s_nop 0
    s_and_b32 s31, s32, 7
    s_lshr_b32 s32, s32, 3
    s_and_b32 s33, s31, 1
    s_lshl_b32 s33, s33, 3
    s_lshr_b32 s30, s32, 2
    s_add_u32 s30, s30, s33
    s_and_b32 s33, s32, 3
    s_lshr_b32 s29, s31, 1
    s_lshl_b32 s29, s29, 2
    s_add_u32 s29, s29, s33
    s_cmp_eq_u32 s30, 15
    s_cbranch_scc1 Lspare_c
    s_lshl_b32 s58, s30, 1
    s_lshr_b32 s33, s28, 1
    s_add_u32 s58, s58, s33
    s_lshl_b32 s58, s58, 4
    s_add_u32 s58, s58, s29
    s_lshl_b32 s58, s58, 1
    s_and_b32 s33, s28, 1
    s_add_u32 s58, s58, s33
    s_lshl_b32 s58, s58, 7
    s_add_u32 s58, s58, 28598272
    s_mul_i32 s36, s29, 10240
    s_cmp_ge_u32 s30, 10
    s_cbranch_scc1 Lc1v
    v_lshlrev_b32 v4, 4, v2
    s_lshl_b32 s33, s34, 10
    v_lshl_add_u32 v5, v6, 9, v4
    v_add_u32 v5, s33, v5
    v_mul_u32_u24 v7, 163840, v6
    s_lshl_b32 s33, s34, 9
    v_add3_u32 v7, v7, v4, s33
    s_lshl_b32 s37, s30, 4
    s_lshl_b32 s33, s35, 3
    s_add_u32 s37, s37, s33
    v_lshrrev_b32 v8, 5, v0
    v_add_u32 v8, s37, v8
    v_mov_b32 v30, 157696
    v_mul_u32_u24 v9, 52429, v8
    v_lshrrev_b32 v9, 18, v9
    v_mul_u32_u24 v31, 5, v9
    v_sub_u32 v31, v8, v31
    v_cmp_lt_u32 vcc, 2, v31
    v_cmp_ne_u32 s[40:41], 2, v31
    v_mul_u32_u24 v9, 327680, v9
    v_lshl_add_u32 v9, v31, 11, v9
    v_cndmask_b32 v31, 0, v30, vcc
    v_cndmask_b32 v26, v7, v5, s[40:41]
    v_add3_u32 v26, v26, v9, v31
    v_add_u32 v8, 2, v8
    v_mul_u32_u24 v9, 52429, v8
    v_lshrrev_b32 v9, 18, v9
    v_mul_u32_u24 v31, 5, v9
    v_sub_u32 v31, v8, v31
    v_cmp_lt_u32 vcc, 2, v31
    v_cmp_ne_u32 s[42:43], 2, v31
    v_mul_u32_u24 v9, 327680, v9
    v_lshl_add_u32 v9, v31, 11, v9
    v_cndmask_b32 v31, 0, v30, vcc
    v_cndmask_b32 v27, v7, v5, s[42:43]
    v_add3_u32 v27, v27, v9, v31
    v_add_u32 v8, 2, v8
    v_mul_u32_u24 v9, 52429, v8
    v_lshrrev_b32 v9, 18, v9
    v_mul_u32_u24 v31, 5, v9
    v_sub_u32 v31, v8, v31
    v_cmp_lt_u32 vcc, 2, v31
    v_cmp_ne_u32 s[44:45], 2, v31
    v_mul_u32_u24 v9, 327680, v9
    v_lshl_add_u32 v9, v31, 11, v9
    v_cndmask_b32 v31, 0, v30, vcc
    v_cndmask_b32 v28, v7, v5, s[44:45]
    v_add3_u32 v28, v28, v9, v31
    v_add_u32 v8, 2, v8
    v_mul_u32_u24 v9, 52429, v8
    v_lshrrev_b32 v9, 18, v9
    v_mul_u32_u24 v31, 5, v9
    v_sub_u32 v31, v8, v31
    v_cmp_lt_u32 vcc, 2, v31
    v_cmp_ne_u32 s[46:47], 2, v31
    v_mul_u32_u24 v9, 327680, v9
    v_lshl_add_u32 v9, v31, 11, v9
    v_cndmask_b32 v31, 0, v30, vcc
    v_cndmask_b32 v29, v7, v5, s[46:47]
    v_add3_u32 v29, v29, v9, v31
    v_add_u32 v8, 2, v8
    s_cmp_lt_u32 s30, 5
    s_cselect_b32 s37, 0x3ea52b5c, 1.0
    s_cmp_ge_u32 s3, 2
    s_cbranch_scc1 Uw13
    v_mov_b32 v234, 0x3f803f80
    v_mov_b32 v236, 0
    v_mov_b32 v237, 0
    v_mov_b32 v238, 0
    v_mov_b32 v239, 0
    s_waitcnt vmcnt(0)
    v_dot2_f32_bf16 v236, v208, v234, v236
    v_dot2_f32_bf16 v238, v208, v208, v238
    v_dot2_f32_bf16 v237, v209, v234, v237
    v_dot2_f32_bf16 v239, v209, v209, v239
    v_dot2_f32_bf16 v236, v210, v234, v236
    v_dot2_f32_bf16 v238, v210, v210, v238
    v_dot2_f32_bf16 v237, v211, v234, v237
    v_dot2_f32_bf16 v239, v211, v211, v239
    v_dot2_f32_bf16 v236, v212, v234, v236
    v_dot2_f32_bf16 v238, v212, v212, v238
    v_dot2_f32_bf16 v237, v213, v234, v237
    v_dot2_f32_bf16 v239, v213, v213, v239
    v_dot2_f32_bf16 v236, v214, v234, v236
    v_dot2_f32_bf16 v238, v214, v214, v238
    v_dot2_f32_bf16 v237, v215, v234, v237
    v_dot2_f32_bf16 v239, v215, v215, v239
    v_dot2_f32_bf16 v236, v216, v234, v236
    v_dot2_f32_bf16 v238, v216, v216, v238
    v_dot2_f32_bf16 v237, v217, v234, v237
    v_dot2_f32_bf16 v239, v217, v217, v239
    v_dot2_f32_bf16 v236, v218, v234, v236
    v_dot2_f32_bf16 v238, v218, v218, v238
    v_dot2_f32_bf16 v237, v219, v234, v237
    v_dot2_f32_bf16 v239, v219, v219, v239
    v_dot2_f32_bf16 v236, v220, v234, v236
    v_dot2_f32_bf16 v238, v220, v220, v238
    v_dot2_f32_bf16 v237, v221, v234, v237
    v_dot2_f32_bf16 v239, v221, v221, v239
    v_dot2_f32_bf16 v236, v222, v234, v236
    v_dot2_f32_bf16 v238, v222, v222, v238
    v_dot2_f32_bf16 v237, v223, v234, v237
    v_dot2_f32_bf16 v239, v223, v223, v239
    v_dot2_f32_bf16 v236, v224, v234, v236
    v_dot2_f32_bf16 v238, v224, v224, v238
    v_dot2_f32_bf16 v237, v225, v234, v237
    v_dot2_f32_bf16 v239, v225, v225, v239
    v_dot2_f32_bf16 v236, v226, v234, v236
    v_dot2_f32_bf16 v238, v226, v226, v238
    v_dot2_f32_bf16 v237, v227, v234, v237
    v_dot2_f32_bf16 v239, v227, v227, v239
    s_nop 2
    v_add_f32 v236, v236, v237
    v_add_f32 v238, v238, v239
    s_nop 1
    v_add_f32_dpp v236, v236, v236 row_ror:8 row_mask:0xf bank_mask:0xf
    v_add_f32_dpp v238, v238, v238 row_ror:8 row_mask:0xf bank_mask:0xf
    s_nop 1
    v_add_f32_dpp v236, v236, v236 row_ror:4 row_mask:0xf bank_mask:0xf
    v_add_f32_dpp v238, v238, v238 row_ror:4 row_mask:0xf bank_mask:0xf
    s_nop 1
    v_add_f32_dpp v236, v236, v236 row_ror:2 row_mask:0xf bank_mask:0xf
    v_add_f32_dpp v238, v238, v238 row_ror:2 row_mask:0xf bank_mask:0xf
    s_nop 1
    v_add_f32_dpp v236, v236, v236 row_ror:1 row_mask:0xf bank_mask:0xf
    v_add_f32_dpp v238, v238, v238 row_ror:1 row_mask:0xf bank_mask:0xf
    v_mul_f32 v236, 0x3acccccd, v236
    v_mul_f32 v238, 0x3acccccd, v238
    v_fma_f32 v238, -v236, v236, v238
    v_max_f32 v238, 0, v238
    v_cvt_pk_bf16_f32 v238, v238, v238
    v_lshlrev_b32 v238, 16, v238
    v_add_f32 v238, 0x3727c5ac, v238
    v_cvt_pk_bf16_f32 v238, v238, v238
    v_lshlrev_b32 v238, 16, v238
    v_sqrt_f32 v238, v238
    v_mul_f32 v236, 0x3e800000, v236
    v_cvt_pk_bf16_f32 v238, v238, v238
    v_lshlrev_b32 v238, 16, v238
    v_cvt_pk_bf16_f32 v244, -v236, -v236
    v_rcp_f32 v246, v238
    v_mul_f32 v238, 0x3e800000, v238
    v_lshrrev_b32 v245, 16, v238
    v_and_b32 v230, 48, v0
    s_lshl_b32 s54, s52, 6
    s_add_u32 s54, s54, 28278784
    s_mov_b32 exec_lo, 0x00010001
    s_mov_b32 exec_hi, 0x00010001
    buffer_store_dwordx4 v[244:247], v230, s[20:23], s54 offen sc1
    s_mov_b64 exec, -1
    s_branch Uw14
Uw13:
    v_mov_b32 v234, 0x3f80
    v_mov_b32 v235, 0x3f800000
    v_mov_b32 v236, 0
    v_mov_b32 v237, 0
    v_mov_b32 v238, 0
    v_mov_b32 v239, 0
    v_mov_b32 v240, 0
    v_mov_b32 v241, 0
    v_mov_b32 v242, 0
    v_mov_b32 v243, 0
    s_waitcnt vmcnt(0)
    v_dot2_f32_bf16 v236, v208, v234, v236
    v_dot2_f32_bf16 v237, v208, v235, v237
    v_dot2_f32_bf16 v238, v209, v234, v238
    v_dot2_f32_bf16 v239, v209, v235, v239
    v_dot2_f32_bf16 v240, v210, v234, v240
    v_dot2_f32_bf16 v241, v210, v235, v241
    v_dot2_f32_bf16 v242, v211, v234, v242
    v_dot2_f32_bf16 v243, v211, v235, v243
    v_dot2_f32_bf16 v236, v212, v234, v236
    v_dot2_f32_bf16 v237, v212, v235, v237
    v_dot2_f32_bf16 v238, v213, v234, v238
    v_dot2_f32_bf16 v239, v213, v235, v239
    v_dot2_f32_bf16 v240, v214, v234, v240
    v_dot2_f32_bf16 v241, v214, v235, v241
    v_dot2_f32_bf16 v242, v215, v234, v242
    v_dot2_f32_bf16 v243, v215, v235, v243
    v_dot2_f32_bf16 v236, v216, v234, v236
    v_dot2_f32_bf16 v237, v216, v235, v237
    v_dot2_f32_bf16 v238, v217, v234, v238
    v_dot2_f32_bf16 v239, v217, v235, v239
    v_dot2_f32_bf16 v240, v218, v234, v240
    v_dot2_f32_bf16 v241, v218, v235, v241
    v_dot2_f32_bf16 v242, v219, v234, v242
    v_dot2_f32_bf16 v243, v219, v235, v243
    v_dot2_f32_bf16 v236, v220, v234, v236
    v_dot2_f32_bf16 v237, v220, v235, v237
    v_dot2_f32_bf16 v238, v221, v234, v238
    v_dot2_f32_bf16 v239, v221, v235, v239
    v_dot2_f32_bf16 v240, v222, v234, v240
    v_dot2_f32_bf16 v241, v222, v235, v241
    v_dot2_f32_bf16 v242, v223, v234, v242
    v_dot2_f32_bf16 v243, v223, v235, v243
    v_dot2_f32_bf16 v236, v224, v234, v236
    v_dot2_f32_bf16 v237, v224, v235, v237
    v_dot2_f32_bf16 v238, v225, v234, v238
    v_dot2_f32_bf16 v239, v225, v235, v239
    v_dot2_f32_bf16 v240, v226, v234, v240
    v_dot2_f32_bf16 v241, v226, v235, v241
    v_dot2_f32_bf16 v242, v227, v234, v242
    v_dot2_f32_bf16 v243, v227, v235, v243
    s_nop 2
    v_permlane32_swap_b32 v236, v240
    v_permlane32_swap_b32 v237, v241
    v_permlane32_swap_b32 v238, v242
    v_permlane32_swap_b32 v239, v243
    v_add_f32 v236, v236, v240
    v_add_f32 v237, v237, v241
    v_add_f32 v238, v238, v242
    v_add_f32 v239, v239, v243
    s_nop 0
    v_permlane16_swap_b32 v236, v238
    v_permlane16_swap_b32 v237, v239
    v_add_f32 v236, v236, v238
    v_add_f32 v237, v237, v239
    v_and_b32 v230, 7, v0
    v_lshlrev_b32 v230, 5, v230
    v_add_f32_dpp v236, v236, v236 row_ror:8 row_mask:0xf bank_mask:0xf
    v_add_f32_dpp v237, v237, v237 row_ror:8 row_mask:0xf bank_mask:0xf
    v_lshrrev_b32 v231, 4, v0
    v_lshl_add_u32 v230, v231, 3, v230
    s_mul_i32 s54, s52, 7680
    s_lshl_b32 s55, s53, 8
    s_add_u32 s54, s54, s55
    s_add_u32 s54, s54, 28311552
    buffer_store_dwordx2 v[236:237], v230, s[20:23], s54 offen sc1
Uw14:
    s_mov_b32 s24, s82
    s_mov_b32 s25, s83
    s_mov_b32 s26, 256
    s_mov_b32 s27, 0x20000
    v_mov_b32 v205, 0
    buffer_load_dword v204, v205, s[24:27], 0 offen sc1
    v_mov_b32 v206, 0
    buffer_load_dword v207, v206, s[20:23], s58 offen sc1
    s_barrier
    ds_read_b64_tr_b16 v[144:145], v14 offset:0
    ds_read_b64_tr_b16 v[146:147], v14 offset:1024
    ds_read_b128 v[128:131], v10 offset:0
    ds_read_b128 v[132:135], v10 offset:2048
    ds_read_b128 v[136:139], v10 offset:4096
    ds_read_b128 v[140:143], v10 offset:6144
    ds_read_b64_tr_b16 v[148:149], v15 offset:0
    ds_read_b64_tr_b16 v[150:151], v15 offset:1024
    ds_read_b64_tr_b16 v[152:153], v16 offset:0
    ds_read_b64_tr_b16 v[154:155], v16 offset:1024
    ds_read_b64_tr_b16 v[156:157], v17 offset:0
    ds_read_b64_tr_b16 v[158:159], v17 offset:1024
    s_waitcnt lgkmcnt(0)
    v_mfma_f32_16x16x32_bf16 v[64:67], v[144:147], v[128:131], 0
    v_mfma_f32_16x16x32_bf16 v[68:71], v[144:147], v[132:135], 0
    v_mfma_f32_16x16x32_bf16 v[72:75], v[144:147], v[136:139], 0
    v_mfma_f32_16x16x32_bf16 v[76:79], v[144:147], v[140:143], 0
    v_mfma_f32_16x16x32_bf16 v[80:83], v[148:151], v[128:131], 0
    v_mfma_f32_16x16x32_bf16 v[84:87], v[148:151], v[132:135], 0
    v_mfma_f32_16x16x32_bf16 v[88:91], v[148:151], v[136:139], 0
    v_mfma_f32_16x16x32_bf16 v[92:95], v[148:151], v[140:143], 0
    v_mfma_f32_16x16x32_bf16 v[96:99], v[152:155], v[128:131], 0
    v_mfma_f32_16x16x32_bf16 v[100:103], v[152:155], v[132:135], 0
    v_mfma_f32_16x16x32_bf16 v[104:107], v[152:155], v[136:139], 0
    v_mfma_f32_16x16x32_bf16 v[108:111], v[152:155], v[140:143], 0
    v_mfma_f32_16x16x32_bf16 v[112:115], v[156:159], v[128:131], 0
    v_mfma_f32_16x16x32_bf16 v[116:119], v[156:159], v[132:135], 0
    ds_read_b64_tr_b16 v[176:177], v14 offset:8192
    ds_read_b64_tr_b16 v[178:179], v14 offset:9216
    ds_read_b128 v[160:163], v11 offset:0
    ds_read_b128 v[164:167], v11 offset:2048
    v_mfma_f32_16x16x32_bf16 v[120:123], v[156:159], v[136:139], 0
    ds_read_b128 v[168:171], v11 offset:4096
    ds_read_b128 v[172:175], v11 offset:6144
    ds_read_b64_tr_b16 v[180:181], v15 offset:8192
    ds_read_b64_tr_b16 v[182:183], v15 offset:9216
    v_mfma_f32_16x16x32_bf16 v[124:127], v[156:159], v[140:143], 0
    ds_read_b64_tr_b16 v[184:185], v16 offset:8192
    ds_read_b64_tr_b16 v[186:187], v16 offset:9216
    ds_read_b64_tr_b16 v[188:189], v17 offset:8192
    ds_read_b64_tr_b16 v[190:191], v17 offset:9216
    s_waitcnt lgkmcnt(0)
    s_barrier
    v_mfma_f32_16x16x32_bf16 v[64:67], v[176:179], v[160:163], v[64:67]
    v_mfma_f32_16x16x32_bf16 v[68:71], v[176:179], v[164:167], v[68:71]
    v_mfma_f32_16x16x32_bf16 v[72:75], v[176:179], v[168:171], v[72:75]
    v_mfma_f32_16x16x32_bf16 v[76:79], v[176:179], v[172:175], v[76:79]
    v_mfma_f32_16x16x32_bf16 v[80:83], v[180:183], v[160:163], v[80:83]
    v_mfma_f32_16x16x32_bf16 v[84:87], v[180:183], v[164:167], v[84:87]
    v_mfma_f32_16x16x32_bf16 v[88:91], v[180:183], v[168:171], v[88:91]
    v_mfma_f32_16x16x32_bf16 v[92:95], v[180:183], v[172:175], v[92:95]
    v_mfma_f32_16x16x32_bf16 v[96:99], v[184:187], v[160:163], v[96:99]
    v_mfma_f32_16x16x32_bf16 v[100:103], v[184:187], v[164:167], v[100:103]
    v_mfma_f32_16x16x32_bf16 v[104:107], v[184:187], v[168:171], v[104:107]
    v_mfma_f32_16x16x32_bf16 v[108:111], v[184:187], v[172:175], v[108:111]
    v_mfma_f32_16x16x32_bf16 v[112:115], v[188:191], v[160:163], v[112:115]
    v_mfma_f32_16x16x32_bf16 v[116:119], v[188:191], v[164:167], v[116:119]
    ds_read_b64_tr_b16 v[144:145], v14 offset:32768
    ds_read_b64_tr_b16 v[146:147], v14 offset:33792
    ds_read_b128 v[128:131], v10 offset:32768
    ds_read_b128 v[132:135], v10 offset:34816
    v_mfma_f32_16x16x32_bf16 v[120:123], v[188:191], v[168:171], v[120:123]
    ds_read_b128 v[136:139], v10 offset:36864
    ds_read_b128 v[140:143], v10 offset:38912
    ds_read_b64_tr_b16 v[148:149], v15 offset:32768
    ds_read_b64_tr_b16 v[150:151], v15 offset:33792
    v_mfma_f32_16x16x32_bf16 v[124:127], v[188:191], v[172:175], v[124:127]
    ds_read_b64_tr_b16 v[152:153], v16 offset:32768
    ds_read_b64_tr_b16 v[154:155], v16 offset:33792
    ds_read_b64_tr_b16 v[156:157], v17 offset:32768
    ds_read_b64_tr_b16 v[158:159], v17 offset:33792
    s_waitcnt lgkmcnt(0)
    v_mfma_f32_16x16x32_bf16 v[64:67], v[144:147], v[128:131], v[64:67]
    v_mfma_f32_16x16x32_bf16 v[68:71], v[144:147], v[132:135], v[68:71]
    v_mfma_f32_16x16x32_bf16 v[72:75], v[144:147], v[136:139], v[72:75]
    v_mfma_f32_16x16x32_bf16 v[76:79], v[144:147], v[140:143], v[76:79]
    v_mfma_f32_16x16x32_bf16 v[80:83], v[148:151], v[128:131], v[80:83]
    v_mfma_f32_16x16x32_bf16 v[84:87], v[148:151], v[132:135], v[84:87]
    v_mfma_f32_16x16x32_bf16 v[88:91], v[148:151], v[136:139], v[88:91]
    v_mfma_f32_16x16x32_bf16 v[92:95], v[148:151], v[140:143], v[92:95]
    v_mfma_f32_16x16x32_bf16 v[96:99], v[152:155], v[128:131], v[96:99]
    v_mfma_f32_16x16x32_bf16 v[100:103], v[152:155], v[132:135], v[100:103]
    v_mfma_f32_16x16x32_bf16 v[104:107], v[152:155], v[136:139], v[104:107]
    v_mfma_f32_16x16x32_bf16 v[108:111], v[152:155], v[140:143], v[108:111]
    v_mfma_f32_16x16x32_bf16 v[112:115], v[156:159], v[128:131], v[112:115]
    v_mfma_f32_16x16x32_bf16 v[116:119], v[156:159], v[132:135], v[116:119]
    ds_read_b64_tr_b16 v[176:177], v14 offset:40960
    ds_read_b64_tr_b16 v[178:179], v14 offset:41984
    ds_read_b128 v[160:163], v11 offset:32768
    ds_read_b128 v[164:167], v11 offset:34816
    v_mfma_f32_16x16x32_bf16 v[120:123], v[156:159], v[136:139], v[120:123]
    ds_read_b128 v[168:171], v11 offset:36864
    ds_read_b128 v[172:175], v11 offset:38912
    ds_read_b64_tr_b16 v[180:181], v15 offset:40960
    ds_read_b64_tr_b16 v[182:183], v15 offset:41984
    v_mfma_f32_16x16x32_bf16 v[124:127], v[156:159], v[140:143], v[124:127]
    ds_read_b64_tr_b16 v[184:185], v16 offset:40960
    ds_read_b64_tr_b16 v[186:187], v16 offset:41984
    ds_read_b64_tr_b16 v[188:189], v17 offset:40960
    ds_read_b64_tr_b16 v[190:191], v17 offset:41984
    s_waitcnt lgkmcnt(0)
    s_waitcnt vmcnt(0)
    s_mov_b32 s60, 200000
Uz15:
    v_readfirstlane_b32 s100, v204
    s_nop 0
    s_cmp_lg_u32 s100, 0
    s_cbranch_scc1 Uz16
    buffer_load_dword v204, v205, s[24:27], 0 offen sc1
    s_waitcnt vmcnt(0)
    s_sub_u32 s60, s60, 1
    s_cbranch_scc0 Uz15
Uz16:
    s_mov_b32 s101, s100
    s_lshl_b32 s33, s2, 7
    s_add_u32 s33, s33, 28434432
    v_mov_b32 v202, s100
    v_lshlrev_b32 v203, 2, s28
    s_waitcnt vmcnt(0)
    s_mov_b64 exec, 1
    buffer_store_dword v202, v203, s[20:23], s33 offen sc1
    s_mov_b64 exec, -1
    s_barrier
    v_mfma_f32_16x16x32_bf16 v[64:67], v[176:179], v[160:163], v[64:67]
    v_mfma_f32_16x16x32_bf16 v[68:71], v[176:179], v[164:167], v[68:71]
    v_mfma_f32_16x16x32_bf16 v[72:75], v[176:179], v[168:171], v[72:75]
    v_mfma_f32_16x16x32_bf16 v[76:79], v[176:179], v[172:175], v[76:79]
    v_mfma_f32_16x16x32_bf16 v[80:83], v[180:183], v[160:163], v[80:83]
    v_mfma_f32_16x16x32_bf16 v[84:87], v[180:183], v[164:167], v[84:87]
    v_mfma_f32_16x16x32_bf16 v[88:91], v[180:183], v[168:171], v[88:91]
    v_mfma_f32_16x16x32_bf16 v[92:95], v[180:183], v[172:175], v[92:95]
    v_mfma_f32_16x16x32_bf16 v[96:99], v[184:187], v[160:163], v[96:99]
    v_mfma_f32_16x16x32_bf16 v[100:103], v[184:187], v[164:167], v[100:103]
    v_mfma_f32_16x16x32_bf16 v[104:107], v[184:187], v[168:171], v[104:107]
    v_mfma_f32_16x16x32_bf16 v[108:111], v[184:187], v[172:175], v[108:111]
    v_mfma_f32_16x16x32_bf16 v[112:115], v[188:191], v[160:163], v[112:115]
    v_mfma_f32_16x16x32_bf16 v[116:119], v[188:191], v[164:167], v[116:119]
    ds_read_b64_tr_b16 v[144:145], v18 offset:0
    ds_read_b64_tr_b16 v[146:147], v18 offset:1024
    ds_read_b128 v[128:131], v12 offset:0
    ds_read_b128 v[132:135], v12 offset:2048
    v_mfma_f32_16x16x32_bf16 v[120:123], v[188:191], v[168:171], v[120:123]
    ds_read_b128 v[136:139], v12 offset:4096
    ds_read_b128 v[140:143], v12 offset:6144
    ds_read_b64_tr_b16 v[148:149], v19 offset:0
    ds_read_b64_tr_b16 v[150:151], v19 offset:1024
    v_mfma_f32_16x16x32_bf16 v[124:127], v[188:191], v[172:175], v[124:127]
    ds_read_b64_tr_b16 v[152:153], v20 offset:0
    ds_read_b64_tr_b16 v[154:155], v20 offset:1024
    ds_read_b64_tr_b16 v[156:157], v21 offset:0
    ds_read_b64_tr_b16 v[158:159], v21 offset:1024
    s_waitcnt lgkmcnt(0)
    v_mfma_f32_16x16x32_bf16 v[64:67], v[144:147], v[128:131], v[64:67]
    v_mfma_f32_16x16x32_bf16 v[68:71], v[144:147], v[132:135], v[68:71]
    v_mfma_f32_16x16x32_bf16 v[72:75], v[144:147], v[136:139], v[72:75]
    v_mfma_f32_16x16x32_bf16 v[76:79], v[144:147], v[140:143], v[76:79]
    v_mfma_f32_16x16x32_bf16 v[80:83], v[148:151], v[128:131], v[80:83]
    v_mfma_f32_16x16x32_bf16 v[84:87], v[148:151], v[132:135], v[84:87]
    v_mfma_f32_16x16x32_bf16 v[88:91], v[148:151], v[136:139], v[88:91]
    v_mfma_f32_16x16x32_bf16 v[92:95], v[148:151], v[140:143], v[92:95]
    v_mfma_f32_16x16x32_bf16 v[96:99], v[152:155], v[128:131], v[96:99]
    v_mfma_f32_16x16x32_bf16 v[100:103], v[152:155], v[132:135], v[100:103]
    v_mfma_f32_16x16x32_bf16 v[104:107], v[152:155], v[136:139], v[104:107]
    v_mfma_f32_16x16x32_bf16 v[108:111], v[152:155], v[140:143], v[108:111]
    v_mfma_f32_16x16x32_bf16 v[112:115], v[156:159], v[128:131], v[112:115]
    v_mfma_f32_16x16x32_bf16 v[116:119], v[156:159], v[132:135], v[116:119]
    ds_read_b64_tr_b16 v[176:177], v18 offset:8192
    ds_read_b64_tr_b16 v[178:179], v18 offset:9216
    ds_read_b128 v[160:163], v13 offset:0
    ds_read_b128 v[164:167], v13 offset:2048
    v_mfma_f32_16x16x32_bf16 v[120:123], v[156:159], v[136:139], v[120:123]
    ds_read_b128 v[168:171], v13 offset:4096
    ds_read_b128 v[172:175], v13 offset:6144
    ds_read_b64_tr_b16 v[180:181], v19 offset:8192
    ds_read_b64_tr_b16 v[182:183], v19 offset:9216
    v_mfma_f32_16x16x32_bf16 v[124:127], v[156:159], v[140:143], v[124:127]
    ds_read_b64_tr_b16 v[184:185], v20 offset:8192
    ds_read_b64_tr_b16 v[186:187], v20 offset:9216
    ds_read_b64_tr_b16 v[188:189], v21 offset:8192
    ds_read_b64_tr_b16 v[190:191], v21 offset:9216
    s_waitcnt lgkmcnt(0)
    s_barrier
    v_mfma_f32_16x16x32_bf16 v[64:67], v[176:179], v[160:163], v[64:67]
    v_mfma_f32_16x16x32_bf16 v[68:71], v[176:179], v[164:167], v[68:71]
    v_mfma_f32_16x16x32_bf16 v[72:75], v[176:179], v[168:171], v[72:75]
    v_mfma_f32_16x16x32_bf16 v[76:79], v[176:179], v[172:175], v[76:79]
    v_mfma_f32_16x16x32_bf16 v[80:83], v[180:183], v[160:163], v[80:83]
    v_mfma_f32_16x16x32_bf16 v[84:87], v[180:183], v[164:167], v[84:87]
    v_mfma_f32_16x16x32_bf16 v[88:91], v[180:183], v[168:171], v[88:91]
    v_mfma_f32_16x16x32_bf16 v[92:95], v[180:183], v[172:175], v[92:95]
    v_mfma_f32_16x16x32_bf16 v[96:99], v[184:187], v[160:163], v[96:99]
    v_mfma_f32_16x16x32_bf16 v[100:103], v[184:187], v[164:167], v[100:103]
    v_mfma_f32_16x16x32_bf16 v[104:107], v[184:187], v[168:171], v[104:107]
    v_mfma_f32_16x16x32_bf16 v[108:111], v[184:187], v[172:175], v[108:111]
    v_mfma_f32_16x16x32_bf16 v[112:115], v[188:191], v[160:163], v[112:115]
    v_mfma_f32_16x16x32_bf16 v[116:119], v[188:191], v[164:167], v[116:119]
    ds_read_b64_tr_b16 v[144:145], v18 offset:32768
    ds_read_b64_tr_b16 v[146:147], v18 offset:33792
    ds_read_b128 v[128:131], v12 offset:32768
    ds_read_b128 v[132:135], v12 offset:34816
    v_mfma_f32_16x16x32_bf16 v[120:123], v[188:191], v[168:171], v[120:123]
    ds_read_b128 v[136:139], v12 offset:36864
    ds_read_b128 v[140:143], v12 offset:38912
    ds_read_b64_tr_b16 v[148:149], v19 offset:32768
    ds_read_b64_tr_b16 v[150:151], v19 offset:33792
    v_mfma_f32_16x16x32_bf16 v[124:127], v[188:191], v[172:175], v[124:127]
    ds_read_b64_tr_b16 v[152:153], v20 offset:32768
    ds_read_b64_tr_b16 v[154:155], v20 offset:33792
    ds_read_b64_tr_b16 v[156:157], v21 offset:32768
    ds_read_b64_tr_b16 v[158:159], v21 offset:33792
    s_waitcnt lgkmcnt(0)
    v_mfma_f32_16x16x32_bf16 v[64:67], v[144:147], v[128:131], v[64:67]
    v_mfma_f32_16x16x32_bf16 v[68:71], v[144:147], v[132:135], v[68:71]
    v_mfma_f32_16x16x32_bf16 v[72:75], v[144:147], v[136:139], v[72:75]
    v_mfma_f32_16x16x32_bf16 v[76:79], v[144:147], v[140:143], v[76:79]
    v_mfma_f32_16x16x32_bf16 v[80:83], v[148:151], v[128:131], v[80:83]
    v_mfma_f32_16x16x32_bf16 v[84:87], v[148:151], v[132:135], v[84:87]
    v_mfma_f32_16x16x32_bf16 v[88:91], v[148:151], v[136:139], v[88:91]
    v_mfma_f32_16x16x32_bf16 v[92:95], v[148:151], v[140:143], v[92:95]
    v_mfma_f32_16x16x32_bf16 v[96:99], v[152:155], v[128:131], v[96:99]
    v_mfma_f32_16x16x32_bf16 v[100:103], v[152:155], v[132:135], v[100:103]
    v_mfma_f32_16x16x32_bf16 v[104:107], v[152:155], v[136:139], v[104:107]
    v_mfma_f32_16x16x32_bf16 v[108:111], v[152:155], v[140:143], v[108:111]
    v_mfma_f32_16x16x32_bf16 v[112:115], v[156:159], v[128:131], v[112:115]
    v_mfma_f32_16x16x32_bf16 v[116:119], v[156:159], v[132:135], v[116:119]
    ds_read_b64_tr_b16 v[176:177], v18 offset:40960
    ds_read_b64_tr_b16 v[178:179], v18 offset:41984
    ds_read_b128 v[160:163], v13 offset:32768
    ds_read_b128 v[164:167], v13 offset:34816
    v_mfma_f32_16x16x32_bf16 v[120:123], v[156:159], v[136:139], v[120:123]
    ds_read_b128 v[168:171], v13 offset:36864
    ds_read_b128 v[172:175], v13 offset:38912
    ds_read_b64_tr_b16 v[180:181], v19 offset:40960
    ds_read_b64_tr_b16 v[182:183], v19 offset:41984
    v_mfma_f32_16x16x32_bf16 v[124:127], v[156:159], v[140:143], v[124:127]
    ds_read_b64_tr_b16 v[184:185], v20 offset:40960
    ds_read_b64_tr_b16 v[186:187], v20 offset:41984
    ds_read_b64_tr_b16 v[188:189], v21 offset:40960
    ds_read_b64_tr_b16 v[190:191], v21 offset:41984
    s_waitcnt lgkmcnt(0)
    s_barrier
    v_mfma_f32_16x16x32_bf16 v[64:67], v[176:179], v[160:163], v[64:67]
    v_mfma_f32_16x16x32_bf16 v[68:71], v[176:179], v[164:167], v[68:71]
    v_mfma_f32_16x16x32_bf16 v[72:75], v[176:179], v[168:171], v[72:75]
    v_mfma_f32_16x16x32_bf16 v[76:79], v[176:179], v[172:175], v[76:79]
    v_mfma_f32_16x16x32_bf16 v[80:83], v[180:183], v[160:163], v[80:83]
    v_mfma_f32_16x16x32_bf16 v[84:87], v[180:183], v[164:167], v[84:87]
    v_mfma_f32_16x16x32_bf16 v[88:91], v[180:183], v[168:171], v[88:91]
    v_mfma_f32_16x16x32_bf16 v[92:95], v[180:183], v[172:175], v[92:95]
    v_mfma_f32_16x16x32_bf16 v[96:99], v[184:187], v[160:163], v[96:99]
    v_mfma_f32_16x16x32_bf16 v[100:103], v[184:187], v[164:167], v[100:103]
    v_mfma_f32_16x16x32_bf16 v[104:107], v[184:187], v[168:171], v[104:107]
    v_mfma_f32_16x16x32_bf16 v[108:111], v[184:187], v[172:175], v[108:111]
    v_mfma_f32_16x16x32_bf16 v[112:115], v[188:191], v[160:163], v[112:115]
    v_mfma_f32_16x16x32_bf16 v[116:119], v[188:191], v[164:167], v[116:119]
    ds_read_b64_tr_b16 v[144:145], v14 offset:0
    ds_read_b64_tr_b16 v[146:147], v14 offset:1024
    ds_read_b128 v[128:131], v10 offset:0
    ds_read_b128 v[132:135], v10 offset:2048
    v_mfma_f32_16x16x32_bf16 v[120:123], v[188:191], v[168:171], v[120:123]
    ds_read_b128 v[136:139], v10 offset:4096
    ds_read_b128 v[140:143], v10 offset:6144
    ds_read_b64_tr_b16 v[148:149], v15 offset:0
    ds_read_b64_tr_b16 v[150:151], v15 offset:1024
    v_mfma_f32_16x16x32_bf16 v[124:127], v[188:191], v[172:175], v[124:127]
    ds_read_b64_tr_b16 v[152:153], v16 offset:0
    ds_read_b64_tr_b16 v[154:155], v16 offset:1024
    ds_read_b64_tr_b16 v[156:157], v17 offset:0
    ds_read_b64_tr_b16 v[158:159], v17 offset:1024
    s_waitcnt lgkmcnt(0)
    v_mfma_f32_16x16x32_bf16 v[64:67], v[144:147], v[128:131], v[64:67]
    v_mfma_f32_16x16x32_bf16 v[68:71], v[144:147], v[132:135], v[68:71]
    v_mfma_f32_16x16x32_bf16 v[72:75], v[144:147], v[136:139], v[72:75]
    v_mfma_f32_16x16x32_bf16 v[76:79], v[144:147], v[140:143], v[76:79]
    v_mfma_f32_16x16x32_bf16 v[80:83], v[148:151], v[128:131], v[80:83]
    v_mfma_f32_16x16x32_bf16 v[84:87], v[148:151], v[132:135], v[84:87]
    v_mfma_f32_16x16x32_bf16 v[88:91], v[148:151], v[136:139], v[88:91]
    v_mfma_f32_16x16x32_bf16 v[92:95], v[148:151], v[140:143], v[92:95]
    v_mfma_f32_16x16x32_bf16 v[96:99], v[152:155], v[128:131], v[96:99]
    v_mfma_f32_16x16x32_bf16 v[100:103], v[152:155], v[132:135], v[100:103]
    v_mfma_f32_16x16x32_bf16 v[104:107], v[152:155], v[136:139], v[104:107]
    v_mfma_f32_16x16x32_bf16 v[108:111], v[152:155], v[140:143], v[108:111]
    v_mfma_f32_16x16x32_bf16 v[112:115], v[156:159], v[128:131], v[112:115]
    v_mfma_f32_16x16x32_bf16 v[116:119], v[156:159], v[132:135], v[116:119]
    ds_read_b64_tr_b16 v[176:177], v14 offset:8192
    ds_read_b64_tr_b16 v[178:179], v14 offset:9216
    ds_read_b128 v[160:163], v11 offset:0
    ds_read_b128 v[164:167], v11 offset:2048
    v_mfma_f32_16x16x32_bf16 v[120:123], v[156:159], v[136:139], v[120:123]
    ds_read_b128 v[168:171], v11 offset:4096
    ds_read_b128 v[172:175], v11 offset:6144
    ds_read_b64_tr_b16 v[180:181], v15 offset:8192
    ds_read_b64_tr_b16 v[182:183], v15 offset:9216
    v_mfma_f32_16x16x32_bf16 v[124:127], v[156:159], v[140:143], v[124:127]
    ds_read_b64_tr_b16 v[184:185], v16 offset:8192
    ds_read_b64_tr_b16 v[186:187], v16 offset:9216
    ds_read_b64_tr_b16 v[188:189], v17 offset:8192
    ds_read_b64_tr_b16 v[190:191], v17 offset:9216
    s_waitcnt lgkmcnt(0)
    s_barrier
    v_mfma_f32_16x16x32_bf16 v[64:67], v[176:179], v[160:163], v[64:67]
    v_mfma_f32_16x16x32_bf16 v[68:71], v[176:179], v[164:167], v[68:71]
    v_mfma_f32_16x16x32_bf16 v[72:75], v[176:179], v[168:171], v[72:75]
    v_mfma_f32_16x16x32_bf16 v[76:79], v[176:179], v[172:175], v[76:79]
    v_mfma_f32_16x16x32_bf16 v[80:83], v[180:183], v[160:163], v[80:83]
    v_mfma_f32_16x16x32_bf16 v[84:87], v[180:183], v[164:167], v[84:87]
    v_mfma_f32_16x16x32_bf16 v[88:91], v[180:183], v[168:171], v[88:91]
    v_mfma_f32_16x16x32_bf16 v[92:95], v[180:183], v[172:175], v[92:95]
    v_mfma_f32_16x16x32_bf16 v[96:99], v[184:187], v[160:163], v[96:99]
    v_mfma_f32_16x16x32_bf16 v[100:103], v[184:187], v[164:167], v[100:103]
    v_mfma_f32_16x16x32_bf16 v[104:107], v[184:187], v[168:171], v[104:107]
    v_mfma_f32_16x16x32_bf16 v[108:111], v[184:187], v[172:175], v[108:111]
    v_mfma_f32_16x16x32_bf16 v[112:115], v[188:191], v[160:163], v[112:115]
    v_mfma_f32_16x16x32_bf16 v[116:119], v[188:191], v[164:167], v[116:119]
    ds_read_b64_tr_b16 v[144:145], v14 offset:32768
    ds_read_b64_tr_b16 v[146:147], v14 offset:33792
    ds_read_b128 v[128:131], v10 offset:32768
    ds_read_b128 v[132:135], v10 offset:34816
    v_mfma_f32_16x16x32_bf16 v[120:123], v[188:191], v[168:171], v[120:123]
    ds_read_b128 v[136:139], v10 offset:36864
    ds_read_b128 v[140:143], v10 offset:38912
    ds_read_b64_tr_b16 v[148:149], v15 offset:32768
    ds_read_b64_tr_b16 v[150:151], v15 offset:33792
    v_mfma_f32_16x16x32_bf16 v[124:127], v[188:191], v[172:175], v[124:127]
    ds_read_b64_tr_b16 v[152:153], v16 offset:32768
    ds_read_b64_tr_b16 v[154:155], v16 offset:33792
    ds_read_b64_tr_b16 v[156:157], v17 offset:32768
    ds_read_b64_tr_b16 v[158:159], v17 offset:33792
    s_waitcnt lgkmcnt(0)
    v_mfma_f32_16x16x32_bf16 v[64:67], v[144:147], v[128:131], v[64:67]
    v_mfma_f32_16x16x32_bf16 v[68:71], v[144:147], v[132:135], v[68:71]
    v_mfma_f32_16x16x32_bf16 v[72:75], v[144:147], v[136:139], v[72:75]
    v_mfma_f32_16x16x32_bf16 v[76:79], v[144:147], v[140:143], v[76:79]
    v_mfma_f32_16x16x32_bf16 v[80:83], v[148:151], v[128:131], v[80:83]
    v_mfma_f32_16x16x32_bf16 v[84:87], v[148:151], v[132:135], v[84:87]
    v_mfma_f32_16x16x32_bf16 v[88:91], v[148:151], v[136:139], v[88:91]
    v_mfma_f32_16x16x32_bf16 v[92:95], v[148:151], v[140:143], v[92:95]
    v_mfma_f32_16x16x32_bf16 v[96:99], v[152:155], v[128:131], v[96:99]
    v_mfma_f32_16x16x32_bf16 v[100:103], v[152:155], v[132:135], v[100:103]
    v_mfma_f32_16x16x32_bf16 v[104:107], v[152:155], v[136:139], v[104:107]
    v_mfma_f32_16x16x32_bf16 v[108:111], v[152:155], v[140:143], v[108:111]
    v_mfma_f32_16x16x32_bf16 v[112:115], v[156:159], v[128:131], v[112:115]
    v_mfma_f32_16x16x32_bf16 v[116:119], v[156:159], v[132:135], v[116:119]
    ds_read_b64_tr_b16 v[176:177], v14 offset:40960
    ds_read_b64_tr_b16 v[178:179], v14 offset:41984
    ds_read_b128 v[160:163], v11 offset:32768
    ds_read_b128 v[164:167], v11 offset:34816
    v_mfma_f32_16x16x32_bf16 v[120:123], v[156:159], v[136:139], v[120:123]
    ds_read_b128 v[168:171], v11 offset:36864
    ds_read_b128 v[172:175], v11 offset:38912
    ds_read_b64_tr_b16 v[180:181], v15 offset:40960
    ds_read_b64_tr_b16 v[182:183], v15 offset:41984
    v_mfma_f32_16x16x32_bf16 v[124:127], v[156:159], v[140:143], v[124:127]
    ds_read_b64_tr_b16 v[184:185], v16 offset:40960
    ds_read_b64_tr_b16 v[186:187], v16 offset:41984
    ds_read_b64_tr_b16 v[188:189], v17 offset:40960
    ds_read_b64_tr_b16 v[190:191], v17 offset:41984
    s_waitcnt lgkmcnt(0)
    s_barrier
    v_mfma_f32_16x16x32_bf16 v[64:67], v[176:179], v[160:163], v[64:67]
    ds_read_b64_tr_b16 v[144:145], v18 offset:0
    ds_read_b64_tr_b16 v[146:147], v18 offset:1024
    v_mfma_f32_16x16x32_bf16 v[68:71], v[176:179], v[164:167], v[68:71]
    ds_read_b128 v[128:131], v12 offset:0
    ds_read_b128 v[132:135], v12 offset:2048
    v_mfma_f32_16x16x32_bf16 v[72:75], v[176:179], v[168:171], v[72:75]
    ds_read_b128 v[136:139], v12 offset:4096
    ds_read_b128 v[140:143], v12 offset:6144
    v_mfma_f32_16x16x32_bf16 v[76:79], v[176:179], v[172:175], v[76:79]
    ds_read_b64_tr_b16 v[148:149], v19 offset:0
    ds_read_b64_tr_b16 v[150:151], v19 offset:1024
    v_mfma_f32_16x16x32_bf16 v[80:83], v[180:183], v[160:163], v[80:83]
    ds_read_b64_tr_b16 v[152:153], v20 offset:0
    ds_read_b64_tr_b16 v[154:155], v20 offset:1024
    v_mfma_f32_16x16x32_bf16 v[84:87], v[180:183], v[164:167], v[84:87]
    ds_read_b64_tr_b16 v[156:157], v21 offset:0
    ds_read_b64_tr_b16 v[158:159], v21 offset:1024
    v_mfma_f32_16x16x32_bf16 v[88:91], v[180:183], v[168:171], v[88:91]
    v_mfma_f32_16x16x32_bf16 v[92:95], v[180:183], v[172:175], v[92:95]
    v_mfma_f32_16x16x32_bf16 v[96:99], v[184:187], v[160:163], v[96:99]
    v_mfma_f32_16x16x32_bf16 v[100:103], v[184:187], v[164:167], v[100:103]
    v_mfma_f32_16x16x32_bf16 v[104:107], v[184:187], v[168:171], v[104:107]
    v_mfma_f32_16x16x32_bf16 v[108:111], v[184:187], v[172:175], v[108:111]
    v_mfma_f32_16x16x32_bf16 v[112:115], v[188:191], v[160:163], v[112:115]
    v_mfma_f32_16x16x32_bf16 v[116:119], v[188:191], v[164:167], v[116:119]
    v_mfma_f32_16x16x32_bf16 v[120:123], v[188:191], v[168:171], v[120:123]
    v_mfma_f32_16x16x32_bf16 v[124:127], v[188:191], v[172:175], v[124:127]
    s_waitcnt lgkmcnt(0)
    v_mfma_f32_16x16x32_bf16 v[64:67], v[144:147], v[128:131], v[64:67]
    ds_read_b64_tr_b16 v[176:177], v18 offset:8192
    ds_read_b64_tr_b16 v[178:179], v18 offset:9216
    v_mfma_f32_16x16x32_bf16 v[68:71], v[144:147], v[132:135], v[68:71]
    ds_read_b128 v[160:163], v13 offset:0
    ds_read_b128 v[164:167], v13 offset:2048
    v_mfma_f32_16x16x32_bf16 v[72:75], v[144:147], v[136:139], v[72:75]
    ds_read_b128 v[168:171], v13 offset:4096
    ds_read_b128 v[172:175], v13 offset:6144
    v_mfma_f32_16x16x32_bf16 v[76:79], v[144:147], v[140:143], v[76:79]
    ds_read_b64_tr_b16 v[180:181], v19 offset:8192
    ds_read_b64_tr_b16 v[182:183], v19 offset:9216
    v_mfma_f32_16x16x32_bf16 v[80:83], v[148:151], v[128:131], v[80:83]
    ds_read_b64_tr_b16 v[184:185], v20 offset:8192
    ds_read_b64_tr_b16 v[186:187], v20 offset:9216
    v_mfma_f32_16x16x32_bf16 v[84:87], v[148:151], v[132:135], v[84:87]
    ds_read_b64_tr_b16 v[188:189], v21 offset:8192
    ds_read_b64_tr_b16 v[190:191], v21 offset:9216
    v_mfma_f32_16x16x32_bf16 v[88:91], v[148:151], v[136:139], v[88:91]
    v_mfma_f32_16x16x32_bf16 v[92:95], v[148:151], v[140:143], v[92:95]
    v_mfma_f32_16x16x32_bf16 v[96:99], v[152:155], v[128:131], v[96:99]
    v_mfma_f32_16x16x32_bf16 v[100:103], v[152:155], v[132:135], v[100:103]
    v_mfma_f32_16x16x32_bf16 v[104:107], v[152:155], v[136:139], v[104:107]
    v_mfma_f32_16x16x32_bf16 v[108:111], v[152:155], v[140:143], v[108:111]
    v_mfma_f32_16x16x32_bf16 v[112:115], v[156:159], v[128:131], v[112:115]
    v_mfma_f32_16x16x32_bf16 v[116:119], v[156:159], v[132:135], v[116:119]
    v_mfma_f32_16x16x32_bf16 v[120:123], v[156:159], v[136:139], v[120:123]
    v_mfma_f32_16x16x32_bf16 v[124:127], v[156:159], v[140:143], v[124:127]
    s_waitcnt lgkmcnt(0)
    s_barrier
    v_mfma_f32_16x16x32_bf16 v[64:67], v[176:179], v[160:163], v[64:67]
    ds_read_b64_tr_b16 v[144:145], v18 offset:32768
    ds_read_b64_tr_b16 v[146:147], v18 offset:33792
    v_mfma_f32_16x16x32_bf16 v[68:71], v[176:179], v[164:167], v[68:71]
    ds_read_b128 v[128:131], v12 offset:32768
    ds_read_b128 v[132:135], v12 offset:34816
    v_mfma_f32_16x16x32_bf16 v[72:75], v[176:179], v[168:171], v[72:75]
    ds_read_b128 v[136:139], v12 offset:36864
    ds_read_b128 v[140:143], v12 offset:38912
    v_mfma_f32_16x16x32_bf16 v[76:79], v[176:179], v[172:175], v[76:79]
    ds_read_b64_tr_b16 v[148:149], v19 offset:32768
    ds_read_b64_tr_b16 v[150:151], v19 offset:33792
    v_mfma_f32_16x16x32_bf16 v[80:83], v[180:183], v[160:163], v[80:83]
    ds_read_b64_tr_b16 v[152:153], v20 offset:32768
    ds_read_b64_tr_b16 v[154:155], v20 offset:33792
    v_mfma_f32_16x16x32_bf16 v[84:87], v[180:183], v[164:167], v[84:87]
    ds_read_b64_tr_b16 v[156:157], v21 offset:32768
    ds_read_b64_tr_b16 v[158:159], v21 offset:33792
    v_mfma_f32_16x16x32_bf16 v[88:91], v[180:183], v[168:171], v[88:91]
    v_mfma_f32_16x16x32_bf16 v[92:95], v[180:183], v[172:175], v[92:95]
    v_mfma_f32_16x16x32_bf16 v[96:99], v[184:187], v[160:163], v[96:99]
    v_mfma_f32_16x16x32_bf16 v[100:103], v[184:187], v[164:167], v[100:103]
    v_mfma_f32_16x16x32_bf16 v[104:107], v[184:187], v[168:171], v[104:107]
    v_mfma_f32_16x16x32_bf16 v[108:111], v[184:187], v[172:175], v[108:111]
    v_mfma_f32_16x16x32_bf16 v[112:115], v[188:191], v[160:163], v[112:115]
    v_mfma_f32_16x16x32_bf16 v[116:119], v[188:191], v[164:167], v[116:119]
    v_mfma_f32_16x16x32_bf16 v[120:123], v[188:191], v[168:171], v[120:123]
    v_mfma_f32_16x16x32_bf16 v[124:127], v[188:191], v[172:175], v[124:127]
    s_waitcnt lgkmcnt(0)
    v_mfma_f32_16x16x32_bf16 v[64:67], v[144:147], v[128:131], v[64:67]
    ds_read_b64_tr_b16 v[176:177], v18 offset:40960
    ds_read_b64_tr_b16 v[178:179], v18 offset:41984
    v_mfma_f32_16x16x32_bf16 v[68:71], v[144:147], v[132:135], v[68:71]
    ds_read_b128 v[160:163], v13 offset:32768
    ds_read_b128 v[164:167], v13 offset:34816
    v_mfma_f32_16x16x32_bf16 v[72:75], v[144:147], v[136:139], v[72:75]
    ds_read_b128 v[168:171], v13 offset:36864
    ds_read_b128 v[172:175], v13 offset:38912
    v_mfma_f32_16x16x32_bf16 v[76:79], v[144:147], v[140:143], v[76:79]
    ds_read_b64_tr_b16 v[180:181], v19 offset:40960
    ds_read_b64_tr_b16 v[182:183], v19 offset:41984
    v_mfma_f32_16x16x32_bf16 v[80:83], v[148:151], v[128:131], v[80:83]
    ds_read_b64_tr_b16 v[184:185], v20 offset:40960
    ds_read_b64_tr_b16 v[186:187], v20 offset:41984
    v_mfma_f32_16x16x32_bf16 v[84:87], v[148:151], v[132:135], v[84:87]
    ds_read_b64_tr_b16 v[188:189], v21 offset:40960
    ds_read_b64_tr_b16 v[190:191], v21 offset:41984
    v_mfma_f32_16x16x32_bf16 v[88:91], v[148:151], v[136:139], v[88:91]
    v_mfma_f32_16x16x32_bf16 v[92:95], v[148:151], v[140:143], v[92:95]
    v_mfma_f32_16x16x32_bf16 v[96:99], v[152:155], v[128:131], v[96:99]
    v_mfma_f32_16x16x32_bf16 v[100:103], v[152:155], v[132:135], v[100:103]
    v_mfma_f32_16x16x32_bf16 v[104:107], v[152:155], v[136:139], v[104:107]
    v_mfma_f32_16x16x32_bf16 v[108:111], v[152:155], v[140:143], v[108:111]
    v_mfma_f32_16x16x32_bf16 v[112:115], v[156:159], v[128:131], v[112:115]
    v_mfma_f32_16x16x32_bf16 v[116:119], v[156:159], v[132:135], v[116:119]
    v_mfma_f32_16x16x32_bf16 v[120:123], v[156:159], v[136:139], v[120:123]
    v_mfma_f32_16x16x32_bf16 v[124:127], v[156:159], v[140:143], v[124:127]
    s_waitcnt lgkmcnt(0)
    s_barrier
    v_mfma_f32_16x16x32_bf16 v[64:67], v[176:179], v[160:163], v[64:67]
    ds_read_b64_tr_b16 v[144:145], v14 offset:0
    ds_read_b64_tr_b16 v[146:147], v14 offset:1024
    v_mfma_f32_16x16x32_bf16 v[68:71], v[176:179], v[164:167], v[68:71]
    ds_read_b128 v[128:131], v10 offset:0
    ds_read_b128 v[132:135], v10 offset:2048
    v_mfma_f32_16x16x32_bf16 v[72:75], v[176:179], v[168:171], v[72:75]
    ds_read_b128 v[136:139], v10 offset:4096
    ds_read_b128 v[140:143], v10 offset:6144
    v_mfma_f32_16x16x32_bf16 v[76:79], v[176:179], v[172:175], v[76:79]
    ds_read_b64_tr_b16 v[148:149], v15 offset:0
    ds_read_b64_tr_b16 v[150:151], v15 offset:1024
    v_mfma_f32_16x16x32_bf16 v[80:83], v[180:183], v[160:163], v[80:83]
    ds_read_b64_tr_b16 v[152:153], v16 offset:0
    ds_read_b64_tr_b16 v[154:155], v16 offset:1024
    v_mfma_f32_16x16x32_bf16 v[84:87], v[180:183], v[164:167], v[84:87]
    ds_read_b64_tr_b16 v[156:157], v17 offset:0
    ds_read_b64_tr_b16 v[158:159], v17 offset:1024
    v_mfma_f32_16x16x32_bf16 v[88:91], v[180:183], v[168:171], v[88:91]
    v_mfma_f32_16x16x32_bf16 v[92:95], v[180:183], v[172:175], v[92:95]
    v_mfma_f32_16x16x32_bf16 v[96:99], v[184:187], v[160:163], v[96:99]
    v_mfma_f32_16x16x32_bf16 v[100:103], v[184:187], v[164:167], v[100:103]
    v_mfma_f32_16x16x32_bf16 v[104:107], v[184:187], v[168:171], v[104:107]
    v_mfma_f32_16x16x32_bf16 v[108:111], v[184:187], v[172:175], v[108:111]
    v_mfma_f32_16x16x32_bf16 v[112:115], v[188:191], v[160:163], v[112:115]
    v_mfma_f32_16x16x32_bf16 v[116:119], v[188:191], v[164:167], v[116:119]
    v_mfma_f32_16x16x32_bf16 v[120:123], v[188:191], v[168:171], v[120:123]
    v_mfma_f32_16x16x32_bf16 v[124:127], v[188:191], v[172:175], v[124:127]
    s_waitcnt lgkmcnt(0)
    v_mfma_f32_16x16x32_bf16 v[64:67], v[144:147], v[128:131], v[64:67]
    ds_read_b64_tr_b16 v[176:177], v14 offset:8192
    ds_read_b64_tr_b16 v[178:179], v14 offset:9216
    v_mfma_f32_16x16x32_bf16 v[68:71], v[144:147], v[132:135], v[68:71]
    ds_read_b128 v[160:163], v11 offset:0
    ds_read_b128 v[164:167], v11 offset:2048
    v_mfma_f32_16x16x32_bf16 v[72:75], v[144:147], v[136:139], v[72:75]
    ds_read_b128 v[168:171], v11 offset:4096
    ds_read_b128 v[172:175], v11 offset:6144
    v_mfma_f32_16x16x32_bf16 v[76:79], v[144:147], v[140:143], v[76:79]
    ds_read_b64_tr_b16 v[180:181], v15 offset:8192
    ds_read_b64_tr_b16 v[182:183], v15 offset:9216
    v_mfma_f32_16x16x32_bf16 v[80:83], v[148:151], v[128:131], v[80:83]
    ds_read_b64_tr_b16 v[184:185], v16 offset:8192
    ds_read_b64_tr_b16 v[186:187], v16 offset:9216
    v_mfma_f32_16x16x32_bf16 v[84:87], v[148:151], v[132:135], v[84:87]
    ds_read_b64_tr_b16 v[188:189], v17 offset:8192
    ds_read_b64_tr_b16 v[190:191], v17 offset:9216
    v_mfma_f32_16x16x32_bf16 v[88:91], v[148:151], v[136:139], v[88:91]
    v_mfma_f32_16x16x32_bf16 v[92:95], v[148:151], v[140:143], v[92:95]
    v_mfma_f32_16x16x32_bf16 v[96:99], v[152:155], v[128:131], v[96:99]
    v_mfma_f32_16x16x32_bf16 v[100:103], v[152:155], v[132:135], v[100:103]
    v_mfma_f32_16x16x32_bf16 v[104:107], v[152:155], v[136:139], v[104:107]
    v_mfma_f32_16x16x32_bf16 v[108:111], v[152:155], v[140:143], v[108:111]
    v_mfma_f32_16x16x32_bf16 v[112:115], v[156:159], v[128:131], v[112:115]
    v_mfma_f32_16x16x32_bf16 v[116:119], v[156:159], v[132:135], v[116:119]
    v_mfma_f32_16x16x32_bf16 v[120:123], v[156:159], v[136:139], v[120:123]
    v_mfma_f32_16x16x32_bf16 v[124:127], v[156:159], v[140:143], v[124:127]
    s_waitcnt lgkmcnt(0)
    s_barrier
    v_mfma_f32_16x16x32_bf16 v[64:67], v[176:179], v[160:163], v[64:67]
    ds_read_b64_tr_b16 v[144:145], v14 offset:32768
    ds_read_b64_tr_b16 v[146:147], v14 offset:33792
    v_mfma_f32_16x16x32_bf16 v[68:71], v[176:179], v[164:167], v[68:71]
    ds_read_b128 v[128:131], v10 offset:32768
    ds_read_b128 v[132:135], v10 offset:34816
    v_mfma_f32_16x16x32_bf16 v[72:75], v[176:179], v[168:171], v[72:75]
    ds_read_b128 v[136:139], v10 offset:36864
    ds_read_b128 v[140:143], v10 offset:38912
    v_mfma_f32_16x16x32_bf16 v[76:79], v[176:179], v[172:175], v[76:79]
    ds_read_b64_tr_b16 v[148:149], v15 offset:32768
    ds_read_b64_tr_b16 v[150:151], v15 offset:33792
    v_mfma_f32_16x16x32_bf16 v[80:83], v[180:183], v[160:163], v[80:83]
    ds_read_b64_tr_b16 v[152:153], v16 offset:32768
    ds_read_b64_tr_b16 v[154:155], v16 offset:33792
    v_mfma_f32_16x16x32_bf16 v[84:87], v[180:183], v[164:167], v[84:87]
    ds_read_b64_tr_b16 v[156:157], v17 offset:32768
    ds_read_b64_tr_b16 v[158:159], v17 offset:33792
    v_mfma_f32_16x16x32_bf16 v[88:91], v[180:183], v[168:171], v[88:91]
    v_mfma_f32_16x16x32_bf16 v[92:95], v[180:183], v[172:175], v[92:95]
    v_mfma_f32_16x16x32_bf16 v[96:99], v[184:187], v[160:163], v[96:99]
    v_mfma_f32_16x16x32_bf16 v[100:103], v[184:187], v[164:167], v[100:103]
    v_mfma_f32_16x16x32_bf16 v[104:107], v[184:187], v[168:171], v[104:107]
    v_mfma_f32_16x16x32_bf16 v[108:111], v[184:187], v[172:175], v[108:111]
    v_mfma_f32_16x16x32_bf16 v[112:115], v[188:191], v[160:163], v[112:115]
    v_mfma_f32_16x16x32_bf16 v[116:119], v[188:191], v[164:167], v[116:119]
    v_mfma_f32_16x16x32_bf16 v[120:123], v[188:191], v[168:171], v[120:123]
    v_mfma_f32_16x16x32_bf16 v[124:127], v[188:191], v[172:175], v[124:127]
    s_waitcnt lgkmcnt(0)
    v_mfma_f32_16x16x32_bf16 v[64:67], v[144:147], v[128:131], v[64:67]
    ds_read_b64_tr_b16 v[176:177], v14 offset:40960
    ds_read_b64_tr_b16 v[178:179], v14 offset:41984
    v_mfma_f32_16x16x32_bf16 v[68:71], v[144:147], v[132:135], v[68:71]
    ds_read_b128 v[160:163], v11 offset:32768
    ds_read_b128 v[164:167], v11 offset:34816
    v_mfma_f32_16x16x32_bf16 v[72:75], v[144:147], v[136:139], v[72:75]
    ds_read_b128 v[168:171], v11 offset:36864
    ds_read_b128 v[172:175], v11 offset:38912
    v_mfma_f32_16x16x32_bf16 v[76:79], v[144:147], v[140:143], v[76:79]
    ds_read_b64_tr_b16 v[180:181], v15 offset:40960
    ds_read_b64_tr_b16 v[182:183], v15 offset:41984
    v_mfma_f32_16x16x32_bf16 v[80:83], v[148:151], v[128:131], v[80:83]
    ds_read_b64_tr_b16 v[184:185], v16 offset:40960
    ds_read_b64_tr_b16 v[186:187], v16 offset:41984
    v_mfma_f32_16x16x32_bf16 v[84:87], v[148:151], v[132:135], v[84:87]
    ds_read_b64_tr_b16 v[188:189], v17 offset:40960
    ds_read_b64_tr_b16 v[190:191], v17 offset:41984
    v_mfma_f32_16x16x32_bf16 v[88:91], v[148:151], v[136:139], v[88:91]
    v_mfma_f32_16x16x32_bf16 v[92:95], v[148:151], v[140:143], v[92:95]
    v_mfma_f32_16x16x32_bf16 v[96:99], v[152:155], v[128:131], v[96:99]
    v_mfma_f32_16x16x32_bf16 v[100:103], v[152:155], v[132:135], v[100:103]
    v_mfma_f32_16x16x32_bf16 v[104:107], v[152:155], v[136:139], v[104:107]
    v_mfma_f32_16x16x32_bf16 v[108:111], v[152:155], v[140:143], v[108:111]
    v_mfma_f32_16x16x32_bf16 v[112:115], v[156:159], v[128:131], v[112:115]
    v_mfma_f32_16x16x32_bf16 v[116:119], v[156:159], v[132:135], v[116:119]
    v_mfma_f32_16x16x32_bf16 v[120:123], v[156:159], v[136:139], v[120:123]
    v_mfma_f32_16x16x32_bf16 v[124:127], v[156:159], v[140:143], v[124:127]
    s_waitcnt lgkmcnt(0)
    s_barrier
    v_mfma_f32_16x16x32_bf16 v[64:67], v[176:179], v[160:163], v[64:67]
    ds_read_b64 v[192:193], v22 offset:0
    ds_read_b64 v[194:195], v22 offset:128
    v_mfma_f32_16x16x32_bf16 v[68:71], v[176:179], v[164:167], v[68:71]
    ds_read_b64 v[196:197], v22 offset:256
    ds_read_b64 v[198:199], v22 offset:384
    v_mfma_f32_16x16x32_bf16 v[72:75], v[176:179], v[168:171], v[72:75]
    ds_read_b64 v[32:33], v24 offset:0
    ds_read_b64 v[34:35], v24 offset:128
    v_mfma_f32_16x16x32_bf16 v[76:79], v[176:179], v[172:175], v[76:79]
    ds_read_b64 v[36:37], v24 offset:256
    ds_read_b64 v[38:39], v24 offset:384
    v_mfma_f32_16x16x32_bf16 v[80:83], v[180:183], v[160:163], v[80:83]
    ds_read_b32 v40, v23 offset:0
    ds_read_b32 v42, v23 offset:64
    v_mfma_f32_16x16x32_bf16 v[84:87], v[180:183], v[164:167], v[84:87]
    ds_read_b32 v44, v23 offset:128
    ds_read_b32 v46, v23 offset:192
    v_mfma_f32_16x16x32_bf16 v[88:91], v[180:183], v[168:171], v[88:91]
    v_mfma_f32_16x16x32_bf16 v[92:95], v[180:183], v[172:175], v[92:95]
    v_mfma_f32_16x16x32_bf16 v[96:99], v[184:187], v[160:163], v[96:99]
    v_mfma_f32_16x16x32_bf16 v[100:103], v[184:187], v[164:167], v[100:103]
    v_mfma_f32_16x16x32_bf16 v[104:107], v[184:187], v[168:171], v[104:107]
    v_mfma_f32_16x16x32_bf16 v[108:111], v[184:187], v[172:175], v[108:111]
    v_mfma_f32_16x16x32_bf16 v[112:115], v[188:191], v[160:163], v[112:115]
    v_mfma_f32_16x16x32_bf16 v[116:119], v[188:191], v[164:167], v[116:119]
    v_mfma_f32_16x16x32_bf16 v[120:123], v[188:191], v[168:171], v[120:123]
    v_mfma_f32_16x16x32_bf16 v[124:127], v[188:191], v[172:175], v[124:127]
    s_waitcnt lgkmcnt(0)
    v_mfma_f32_16x16x16_bf16 v[64:67], v[32:33], v[192:193], v[64:67]
    v_mfma_f32_16x16x16_bf16 v[68:71], v[32:33], v[194:195], v[68:71]
    v_mfma_f32_16x16x16_bf16 v[72:75], v[32:33], v[196:197], v[72:75]
    v_mfma_f32_16x16x16_bf16 v[76:79], v[32:33], v[198:199], v[76:79]
    v_mfma_f32_16x16x16_bf16 v[80:83], v[34:35], v[192:193], v[80:83]
    v_mfma_f32_16x16x16_bf16 v[84:87], v[34:35], v[194:195], v[84:87]
    v_mfma_f32_16x16x16_bf16 v[88:91], v[34:35], v[196:197], v[88:91]
    v_mfma_f32_16x16x16_bf16 v[92:95], v[34:35], v[198:199], v[92:95]
    v_mul_f32 v40, s37, v40
    v_mul_f32 v42, s37, v42
    v_mul_f32 v44, s37, v44
    v_mul_f32 v46, s37, v46
    v_pk_mul_f32 v[64:65], v[64:65], v[40:41] op_sel_hi:[1,0]
    v_pk_mul_f32 v[66:67], v[66:67], v[40:41] op_sel_hi:[1,0]
    v_cvt_pk_bf16_f32 v128, v64, v65
    v_cvt_pk_bf16_f32 v129, v66, v67
    v_pk_mul_f32 v[72:73], v[72:73], v[44:45] op_sel_hi:[1,0]
    v_pk_mul_f32 v[74:75], v[74:75], v[44:45] op_sel_hi:[1,0]
    v_cvt_pk_bf16_f32 v130, v72, v73
    v_cvt_pk_bf16_f32 v131, v74, v75
    s_mov_b64 exec, s[40:41]
    v_permlane16_swap_b32 v128, v130
    v_permlane16_swap_b32 v129, v131
    s_mov_b64 exec, -1
    buffer_store_dwordx4 v[128:131], v26, s[20:23], s36 offen offset:0 sc1
    v_pk_mul_f32 v[68:69], v[68:69], v[42:43] op_sel_hi:[1,0]
    v_pk_mul_f32 v[70:71], v[70:71], v[42:43] op_sel_hi:[1,0]
    v_cvt_pk_bf16_f32 v132, v68, v69
    v_cvt_pk_bf16_f32 v133, v70, v71
    v_pk_mul_f32 v[76:77], v[76:77], v[46:47] op_sel_hi:[1,0]
    v_pk_mul_f32 v[78:79], v[78:79], v[46:47] op_sel_hi:[1,0]
    v_cvt_pk_bf16_f32 v134, v76, v77
    v_cvt_pk_bf16_f32 v135, v78, v79
    s_mov_b64 exec, s[40:41]
    v_permlane16_swap_b32 v132, v134
    v_permlane16_swap_b32 v133, v135
    s_mov_b64 exec, -1
    buffer_store_dwordx4 v[132:135], v26, s[20:23], s36 offen offset:256 sc1
    v_mfma_f32_16x16x16_bf16 v[96:99], v[36:37], v[192:193], v[96:99]
    v_mfma_f32_16x16x16_bf16 v[100:103], v[36:37], v[194:195], v[100:103]
    v_mfma_f32_16x16x16_bf16 v[104:107], v[36:37], v[196:197], v[104:107]
    v_mfma_f32_16x16x16_bf16 v[108:111], v[36:37], v[198:199], v[108:111]
    v_pk_mul_f32 v[80:81], v[80:81], v[40:41] op_sel_hi:[1,0]
    v_pk_mul_f32 v[82:83], v[82:83], v[40:41] op_sel_hi:[1,0]
    v_cvt_pk_bf16_f32 v136, v80, v81
    v_cvt_pk_bf16_f32 v137, v82, v83
    v_pk_mul_f32 v[88:89], v[88:89], v[44:45] op_sel_hi:[1,0]
    v_pk_mul_f32 v[90:91], v[90:91], v[44:45] op_sel_hi:[1,0]
    v_cvt_pk_bf16_f32 v138, v88, v89
    v_cvt_pk_bf16_f32 v139, v90, v91
    s_mov_b64 exec, s[42:43]
    v_permlane16_swap_b32 v136, v138
    v_permlane16_swap_b32 v137, v139
    s_mov_b64 exec, -1
    buffer_store_dwordx4 v[136:139], v27, s[20:23], s36 offen offset:0 sc1
    v_pk_mul_f32 v[84:85], v[84:85], v[42:43] op_sel_hi:[1,0]
    v_pk_mul_f32 v[86:87], v[86:87], v[42:43] op_sel_hi:[1,0]
    v_cvt_pk_bf16_f32 v140, v84, v85
    v_cvt_pk_bf16_f32 v141, v86, v87
    v_pk_mul_f32 v[92:93], v[92:93], v[46:47] op_sel_hi:[1,0]
    v_pk_mul_f32 v[94:95], v[94:95], v[46:47] op_sel_hi:[1,0]
    v_cvt_pk_bf16_f32 v142, v92, v93
    v_cvt_pk_bf16_f32 v143, v94, v95
    s_mov_b64 exec, s[42:43]
    v_permlane16_swap_b32 v140, v142
    v_permlane16_swap_b32 v141, v143
    s_mov_b64 exec, -1
    buffer_store_dwordx4 v[140:143], v27, s[20:23], s36 offen offset:256 sc1
    v_mfma_f32_16x16x16_bf16 v[112:115], v[38:39], v[192:193], v[112:115]
    v_mfma_f32_16x16x16_bf16 v[116:119], v[38:39], v[194:195], v[116:119]
    v_mfma_f32_16x16x16_bf16 v[120:123], v[38:39], v[196:197], v[120:123]
    v_mfma_f32_16x16x16_bf16 v[124:127], v[38:39], v[198:199], v[124:127]
    v_pk_mul_f32 v[96:97], v[96:97], v[40:41] op_sel_hi:[1,0]
    v_pk_mul_f32 v[98:99], v[98:99], v[40:41] op_sel_hi:[1,0]
    v_cvt_pk_bf16_f32 v128, v96, v97
    v_cvt_pk_bf16_f32 v129, v98, v99
    v_pk_mul_f32 v[104:105], v[104:105], v[44:45] op_sel_hi:[1,0]
    v_pk_mul_f32 v[106:107], v[106:107], v[44:45] op_sel_hi:[1,0]
    v_cvt_pk_bf16_f32 v130, v104, v105
    v_cvt_pk_bf16_f32 v131, v106, v107
    s_mov_b64 exec, s[44:45]
    v_permlane16_swap_b32 v128, v130
    v_permlane16_swap_b32 v129, v131
    s_mov_b64 exec, -1
    buffer_store_dwordx4 v[128:131], v28, s[20:23], s36 offen offset:0 sc1
    v_pk_mul_f32 v[100:101], v[100:101], v[42:43] op_sel_hi:[1,0]
    v_pk_mul_f32 v[102:103], v[102:103], v[42:43] op_sel_hi:[1,0]
    v_cvt_pk_bf16_f32 v132, v100, v101
    v_cvt_pk_bf16_f32 v133, v102, v103
    v_pk_mul_f32 v[108:109], v[108:109], v[46:47] op_sel_hi:[1,0]
    v_pk_mul_f32 v[110:111], v[110:111], v[46:47] op_sel_hi:[1,0]
    v_cvt_pk_bf16_f32 v134, v108, v109
    v_cvt_pk_bf16_f32 v135, v110, v111
    s_mov_b64 exec, s[44:45]
    v_permlane16_swap_b32 v132, v134
    v_permlane16_swap_b32 v133, v135
    s_mov_b64 exec, -1
    buffer_store_dwordx4 v[132:135], v28, s[20:23], s36 offen offset:256 sc1
    v_pk_mul_f32 v[112:113], v[112:113], v[40:41] op_sel_hi:[1,0]
    v_pk_mul_f32 v[114:115], v[114:115], v[40:41] op_sel_hi:[1,0]
    v_cvt_pk_bf16_f32 v136, v112, v113
    v_cvt_pk_bf16_f32 v137, v114, v115
    v_pk_mul_f32 v[120:121], v[120:121], v[44:45] op_sel_hi:[1,0]
    v_pk_mul_f32 v[122:123], v[122:123], v[44:45] op_sel_hi:[1,0]
    v_cvt_pk_bf16_f32 v138, v120, v121
    v_cvt_pk_bf16_f32 v139, v122, v123
    s_mov_b64 exec, s[46:47]
    v_permlane16_swap_b32 v136, v138
    v_permlane16_swap_b32 v137, v139
    s_mov_b64 exec, -1
    buffer_store_dwordx4 v[136:139], v29, s[20:23], s36 offen offset:0 sc1
    v_pk_mul_f32 v[116:117], v[116:117], v[42:43] op_sel_hi:[1,0]
    v_pk_mul_f32 v[118:119], v[118:119], v[42:43] op_sel_hi:[1,0]
    v_cvt_pk_bf16_f32 v140, v116, v117
    v_cvt_pk_bf16_f32 v141, v118, v119
    v_pk_mul_f32 v[124:125], v[124:125], v[46:47] op_sel_hi:[1,0]
    v_pk_mul_f32 v[126:127], v[126:127], v[46:47] op_sel_hi:[1,0]
    v_cvt_pk_bf16_f32 v142, v124, v125
    v_cvt_pk_bf16_f32 v143, v126, v127
    s_mov_b64 exec, s[46:47]
    v_permlane16_swap_b32 v140, v142
    v_permlane16_swap_b32 v141, v143
    s_mov_b64 exec, -1
    buffer_store_dwordx4 v[140:143], v29, s[20:23], s36 offen offset:256 sc1
    s_branch Lc1e
Lc1v:
    s_sub_u32 s33, s30, 10
    s_lshl_b32 s33, s33, 7
    s_lshl_b32 s37, s35, 6
    s_add_u32 s33, s33, s37
    v_add_u32 v7, s33, v2
    v_lshrrev_b32 v5, 5, v0
    v_lshlrev_b32 v5, 6, v5
    v_mul_u32_u24 v4, 640, v6
    s_mul_i32 s37, s34, 2560
    s_add_u32 s37, s37, 5248000
    v_add3_u32 v5, v5, v4, s37
    v_mul_u32_u24 v9, 52429, v7
    v_lshrrev_b32 v9, 20, v9
    v_mul_u32_u24 v8, 20, v9
    v_sub_u32 v8, v7, v8
    v_mul_u32_u24 v9, 163840, v9
    v_lshl_add_u32 v9, v8, 4, v9
    v_and_b32 v8, 28, v8
    v_lshl_add_u32 v9, v8, 4, v9
    v_add_u32 v26, v9, v5
    v_add_u32 v7, 16, v7
    v_mul_u32_u24 v9, 52429, v7
    v_lshrrev_b32 v9, 20, v9
    v_mul_u32_u24 v8, 20, v9
    v_sub_u32 v8, v7, v8
    v_mul_u32_u24 v9, 163840, v9
    v_lshl_add_u32 v9, v8, 4, v9
    v_and_b32 v8, 28, v8
    v_lshl_add_u32 v9, v8, 4, v9
    v_add_u32 v27, v9, v5
    v_add_u32 v7, 16, v7
    v_mul_u32_u24 v9, 52429, v7
    v_lshrrev_b32 v9, 20, v9
    v_mul_u32_u24 v8, 20, v9
    v_sub_u32 v8, v7, v8
    v_mul_u32_u24 v9, 163840, v9
    v_lshl_add_u32 v9, v8, 4, v9
    v_and_b32 v8, 28, v8
    v_lshl_add_u32 v9, v8, 4, v9
    v_add_u32 v28, v9, v5
    v_add_u32 v7, 16, v7
    v_mul_u32_u24 v9, 52429, v7
    v_lshrrev_b32 v9, 20, v9
    v_mul_u32_u24 v8, 20, v9
    v_sub_u32 v8, v7, v8
    v_mul_u32_u24 v9, 163840, v9
    v_lshl_add_u32 v9, v8, 4, v9
    v_and_b32 v8, 28, v8
    v_lshl_add_u32 v9, v8, 4, v9
    v_add_u32 v29, v9, v5
    v_add_u32 v7, 16, v7
    s_cmp_ge_u32 s3, 2
    s_cbranch_scc1 Uw17
    v_mov_b32 v234, 0x3f803f80
    v_mov_b32 v236, 0
    v_mov_b32 v237, 0
    v_mov_b32 v238, 0
    v_mov_b32 v239, 0
    s_waitcnt vmcnt(0)
    v_dot2_f32_bf16 v236, v208, v234, v236
    v_dot2_f32_bf16 v238, v208, v208, v238
    v_dot2_f32_bf16 v237, v209, v234, v237
    v_dot2_f32_bf16 v239, v209, v209, v239
    v_dot2_f32_bf16 v236, v210, v234, v236
    v_dot2_f32_bf16 v238, v210, v210, v238
    v_dot2_f32_bf16 v237, v211, v234, v237
    v_dot2_f32_bf16 v239, v211, v211, v239
    v_dot2_f32_bf16 v236, v212, v234, v236
    v_dot2_f32_bf16 v238, v212, v212, v238
    v_dot2_f32_bf16 v237, v213, v234, v237
    v_dot2_f32_bf16 v239, v213, v213, v239
    v_dot2_f32_bf16 v236, v214, v234, v236
    v_dot2_f32_bf16 v238, v214, v214, v238
    v_dot2_f32_bf16 v237, v215, v234, v237
    v_dot2_f32_bf16 v239, v215, v215, v239
    v_dot2_f32_bf16 v236, v216, v234, v236
    v_dot2_f32_bf16 v238, v216, v216, v238
    v_dot2_f32_bf16 v237, v217, v234, v237
    v_dot2_f32_bf16 v239, v217, v217, v239
    v_dot2_f32_bf16 v236, v218, v234, v236
    v_dot2_f32_bf16 v238, v218, v218, v238
    v_dot2_f32_bf16 v237, v219, v234, v237
    v_dot2_f32_bf16 v239, v219, v219, v239
    v_dot2_f32_bf16 v236, v220, v234, v236
    v_dot2_f32_bf16 v238, v220, v220, v238
    v_dot2_f32_bf16 v237, v221, v234, v237
    v_dot2_f32_bf16 v239, v221, v221, v239
    v_dot2_f32_bf16 v236, v222, v234, v236
    v_dot2_f32_bf16 v238, v222, v222, v238
    v_dot2_f32_bf16 v237, v223, v234, v237
    v_dot2_f32_bf16 v239, v223, v223, v239
    v_dot2_f32_bf16 v236, v224, v234, v236
    v_dot2_f32_bf16 v238, v224, v224, v238
    v_dot2_f32_bf16 v237, v225, v234, v237
    v_dot2_f32_bf16 v239, v225, v225, v239
    v_dot2_f32_bf16 v236, v226, v234, v236
    v_dot2_f32_bf16 v238, v226, v226, v238
    v_dot2_f32_bf16 v237, v227, v234, v237
    v_dot2_f32_bf16 v239, v227, v227, v239
    s_nop 2
    v_add_f32 v236, v236, v237
    v_add_f32 v238, v238, v239
    s_nop 1
    v_add_f32_dpp v236, v236, v236 row_ror:8 row_mask:0xf bank_mask:0xf
    v_add_f32_dpp v238, v238, v238 row_ror:8 row_mask:0xf bank_mask:0xf
    s_nop 1
    v_add_f32_dpp v236, v236, v236 row_ror:4 row_mask:0xf bank_mask:0xf
    v_add_f32_dpp v238, v238, v238 row_ror:4 row_mask:0xf bank_mask:0xf
    s_nop 1
    v_add_f32_dpp v236, v236, v236 row_ror:2 row_mask:0xf bank_mask:0xf
    v_add_f32_dpp v238, v238, v238 row_ror:2 row_mask:0xf bank_mask:0xf
    s_nop 1
    v_add_f32_dpp v236, v236, v236 row_ror:1 row_mask:0xf bank_mask:0xf
    v_add_f32_dpp v238, v238, v238 row_ror:1 row_mask:0xf bank_mask:0xf
    v_mul_f32 v236, 0x3acccccd, v236
    v_mul_f32 v238, 0x3acccccd, v238
    v_fma_f32 v238, -v236, v236, v238
    v_max_f32 v238, 0, v238
    v_cvt_pk_bf16_f32 v238, v238, v238
    v_lshlrev_b32 v238, 16, v238
    v_add_f32 v238, 0x3727c5ac, v238
    v_cvt_pk_bf16_f32 v238, v238, v238
    v_lshlrev_b32 v238, 16, v238
    v_sqrt_f32 v238, v238
    v_mul_f32 v236, 0x3e800000, v236
    v_cvt_pk_bf16_f32 v238, v238, v238
    v_lshlrev_b32 v238, 16, v238
    v_cvt_pk_bf16_f32 v244, -v236, -v236
    v_rcp_f32 v246, v238
    v_mul_f32 v238, 0x3e800000, v238
    v_lshrrev_b32 v245, 16, v238
    v_and_b32 v230, 48, v0
    s_lshl_b32 s54, s52, 6
    s_add_u32 s54, s54, 28278784
    s_mov_b32 exec_lo, 0x00010001
    s_mov_b32 exec_hi, 0x00010001
    buffer_store_dwordx4 v[244:247], v230, s[20:23], s54 offen sc1
    s_mov_b64 exec, -1
    s_branch Uw18
Uw17:
    v_mov_b32 v234, 0x3f80
    v_mov_b32 v235, 0x3f800000
    v_mov_b32 v236, 0
    v_mov_b32 v237, 0
    v_mov_b32 v238, 0
    v_mov_b32 v239, 0
    v_mov_b32 v240, 0
    v_mov_b32 v241, 0
    v_mov_b32 v242, 0
    v_mov_b32 v243, 0
    s_waitcnt vmcnt(0)
    v_dot2_f32_bf16 v236, v208, v234, v236
    v_dot2_f32_bf16 v237, v208, v235, v237
    v_dot2_f32_bf16 v238, v209, v234, v238
    v_dot2_f32_bf16 v239, v209, v235, v239
    v_dot2_f32_bf16 v240, v210, v234, v240
    v_dot2_f32_bf16 v241, v210, v235, v241
    v_dot2_f32_bf16 v242, v211, v234, v242
    v_dot2_f32_bf16 v243, v211, v235, v243
    v_dot2_f32_bf16 v236, v212, v234, v236
    v_dot2_f32_bf16 v237, v212, v235, v237
    v_dot2_f32_bf16 v238, v213, v234, v238
    v_dot2_f32_bf16 v239, v213, v235, v239
    v_dot2_f32_bf16 v240, v214, v234, v240
    v_dot2_f32_bf16 v241, v214, v235, v241
    v_dot2_f32_bf16 v242, v215, v234, v242
    v_dot2_f32_bf16 v243, v215, v235, v243
    v_dot2_f32_bf16 v236, v216, v234, v236
    v_dot2_f32_bf16 v237, v216, v235, v237
    v_dot2_f32_bf16 v238, v217, v234, v238
    v_dot2_f32_bf16 v239, v217, v235, v239
    v_dot2_f32_bf16 v240, v218, v234, v240
    v_dot2_f32_bf16 v241, v218, v235, v241
    v_dot2_f32_bf16 v242, v219, v234, v242
    v_dot2_f32_bf16 v243, v219, v235, v243
    v_dot2_f32_bf16 v236, v220, v234, v236
    v_dot2_f32_bf16 v237, v220, v235, v237
    v_dot2_f32_bf16 v238, v221, v234, v238
    v_dot2_f32_bf16 v239, v221, v235, v239
    v_dot2_f32_bf16 v240, v222, v234, v240
    v_dot2_f32_bf16 v241, v222, v235, v241
    v_dot2_f32_bf16 v242, v223, v234, v242
    v_dot2_f32_bf16 v243, v223, v235, v243
    v_dot2_f32_bf16 v236, v224, v234, v236
    v_dot2_f32_bf16 v237, v224, v235, v237
    v_dot2_f32_bf16 v238, v225, v234, v238
    v_dot2_f32_bf16 v239, v225, v235, v239
    v_dot2_f32_bf16 v240, v226, v234, v240
    v_dot2_f32_bf16 v241, v226, v235, v241
    v_dot2_f32_bf16 v242, v227, v234, v242
    v_dot2_f32_bf16 v243, v227, v235, v243
    s_nop 2
    v_permlane32_swap_b32 v236, v240
    v_permlane32_swap_b32 v237, v241
    v_permlane32_swap_b32 v238, v242
    v_permlane32_swap_b32 v239, v243
    v_add_f32 v236, v236, v240
    v_add_f32 v237, v237, v241
    v_add_f32 v238, v238, v242
    v_add_f32 v239, v239, v243
    s_nop 0
    v_permlane16_swap_b32 v236, v238
    v_permlane16_swap_b32 v237, v239
    v_add_f32 v236, v236, v238
    v_add_f32 v237, v237, v239
    v_and_b32 v230, 7, v0
    v_lshlrev_b32 v230, 5, v230
    v_add_f32_dpp v236, v236, v236 row_ror:8 row_mask:0xf bank_mask:0xf
    v_add_f32_dpp v237, v237, v237 row_ror:8 row_mask:0xf bank_mask:0xf
    v_lshrrev_b32 v231, 4, v0
    v_lshl_add_u32 v230, v231, 3, v230
    s_mul_i32 s54, s52, 7680
    s_lshl_b32 s55, s53, 8
    s_add_u32 s54, s54, s55
    s_add_u32 s54, s54, 28311552
    buffer_store_dwordx2 v[236:237], v230, s[20:23], s54 offen sc1
Uw18:
    s_mov_b32 s24, s82
    s_mov_b32 s25, s83
    s_mov_b32 s26, 256
    s_mov_b32 s27, 0x20000
    v_mov_b32 v205, 0
    buffer_load_dword v204, v205, s[24:27], 0 offen sc1
    v_mov_b32 v206, 0
    buffer_load_dword v207, v206, s[20:23], s58 offen sc1
    s_barrier
    ds_read_b64_tr_b16 v[144:145], v14 offset:0
    ds_read_b64_tr_b16 v[146:147], v14 offset:1024
    ds_read_b128 v[128:131], v10 offset:0
    ds_read_b128 v[132:135], v10 offset:2048
    ds_read_b128 v[136:139], v10 offset:4096
    ds_read_b128 v[140:143], v10 offset:6144
    ds_read_b64_tr_b16 v[148:149], v15 offset:0
    ds_read_b64_tr_b16 v[150:151], v15 offset:1024
    ds_read_b64_tr_b16 v[152:153], v16 offset:0
    ds_read_b64_tr_b16 v[154:155], v16 offset:1024
    ds_read_b64_tr_b16 v[156:157], v17 offset:0
    ds_read_b64_tr_b16 v[158:159], v17 offset:1024
    s_waitcnt lgkmcnt(0)
    v_mfma_f32_16x16x32_bf16 v[64:67], v[128:131], v[144:147], 0
    v_mfma_f32_16x16x32_bf16 v[68:71], v[132:135], v[144:147], 0
    v_mfma_f32_16x16x32_bf16 v[72:75], v[136:139], v[144:147], 0
    v_mfma_f32_16x16x32_bf16 v[76:79], v[140:143], v[144:147], 0
    v_mfma_f32_16x16x32_bf16 v[80:83], v[128:131], v[148:151], 0
    v_mfma_f32_16x16x32_bf16 v[84:87], v[132:135], v[148:151], 0
    v_mfma_f32_16x16x32_bf16 v[88:91], v[136:139], v[148:151], 0
    v_mfma_f32_16x16x32_bf16 v[92:95], v[140:143], v[148:151], 0
    v_mfma_f32_16x16x32_bf16 v[96:99], v[128:131], v[152:155], 0
    v_mfma_f32_16x16x32_bf16 v[100:103], v[132:135], v[152:155], 0
    v_mfma_f32_16x16x32_bf16 v[104:107], v[136:139], v[152:155], 0
    v_mfma_f32_16x16x32_bf16 v[108:111], v[140:143], v[152:155], 0
    v_mfma_f32_16x16x32_bf16 v[112:115], v[128:131], v[156:159], 0
    v_mfma_f32_16x16x32_bf16 v[116:119], v[132:135], v[156:159], 0
    ds_read_b64_tr_b16 v[176:177], v14 offset:8192
    ds_read_b64_tr_b16 v[178:179], v14 offset:9216
    ds_read_b128 v[160:163], v11 offset:0
    ds_read_b128 v[164:167], v11 offset:2048
    v_mfma_f32_16x16x32_bf16 v[120:123], v[136:139], v[156:159], 0
    ds_read_b128 v[168:171], v11 offset:4096
    ds_read_b128 v[172:175], v11 offset:6144
    ds_read_b64_tr_b16 v[180:181], v15 offset:8192
    ds_read_b64_tr_b16 v[182:183], v15 offset:9216
    v_mfma_f32_16x16x32_bf16 v[124:127], v[140:143], v[156:159], 0
    ds_read_b64_tr_b16 v[184:185], v16 offset:8192
    ds_read_b64_tr_b16 v[186:187], v16 offset:9216
    ds_read_b64_tr_b16 v[188:189], v17 offset:8192
    ds_read_b64_tr_b16 v[190:191], v17 offset:9216
    s_waitcnt lgkmcnt(0)
    s_barrier
    v_mfma_f32_16x16x32_bf16 v[64:67], v[160:163], v[176:179], v[64:67]
    v_mfma_f32_16x16x32_bf16 v[68:71], v[164:167], v[176:179], v[68:71]
    v_mfma_f32_16x16x32_bf16 v[72:75], v[168:171], v[176:179], v[72:75]
    v_mfma_f32_16x16x32_bf16 v[76:79], v[172:175], v[176:179], v[76:79]
    v_mfma_f32_16x16x32_bf16 v[80:83], v[160:163], v[180:183], v[80:83]
    v_mfma_f32_16x16x32_bf16 v[84:87], v[164:167], v[180:183], v[84:87]
    v_mfma_f32_16x16x32_bf16 v[88:91], v[168:171], v[180:183], v[88:91]
    v_mfma_f32_16x16x32_bf16 v[92:95], v[172:175], v[180:183], v[92:95]
    v_mfma_f32_16x16x32_bf16 v[96:99], v[160:163], v[184:187], v[96:99]
    v_mfma_f32_16x16x32_bf16 v[100:103], v[164:167], v[184:187], v[100:103]
    v_mfma_f32_16x16x32_bf16 v[104:107], v[168:171], v[184:187], v[104:107]
    v_mfma_f32_16x16x32_bf16 v[108:111], v[172:175], v[184:187], v[108:111]
    v_mfma_f32_16x16x32_bf16 v[112:115], v[160:163], v[188:191], v[112:115]
    v_mfma_f32_16x16x32_bf16 v[116:119], v[164:167], v[188:191], v[116:119]
    ds_read_b64_tr_b16 v[144:145], v14 offset:32768
    ds_read_b64_tr_b16 v[146:147], v14 offset:33792
    ds_read_b128 v[128:131], v10 offset:32768
    ds_read_b128 v[132:135], v10 offset:34816
    v_mfma_f32_16x16x32_bf16 v[120:123], v[168:171], v[188:191], v[120:123]
    ds_read_b128 v[136:139], v10 offset:36864
    ds_read_b128 v[140:143], v10 offset:38912
    ds_read_b64_tr_b16 v[148:149], v15 offset:32768
    ds_read_b64_tr_b16 v[150:151], v15 offset:33792
    v_mfma_f32_16x16x32_bf16 v[124:127], v[172:175], v[188:191], v[124:127]
    ds_read_b64_tr_b16 v[152:153], v16 offset:32768
    ds_read_b64_tr_b16 v[154:155], v16 offset:33792
    ds_read_b64_tr_b16 v[156:157], v17 offset:32768
    ds_read_b64_tr_b16 v[158:159], v17 offset:33792
    s_waitcnt lgkmcnt(0)
    v_mfma_f32_16x16x32_bf16 v[64:67], v[128:131], v[144:147], v[64:67]
    v_mfma_f32_16x16x32_bf16 v[68:71], v[132:135], v[144:147], v[68:71]
    v_mfma_f32_16x16x32_bf16 v[72:75], v[136:139], v[144:147], v[72:75]
    v_mfma_f32_16x16x32_bf16 v[76:79], v[140:143], v[144:147], v[76:79]
    v_mfma_f32_16x16x32_bf16 v[80:83], v[128:131], v[148:151], v[80:83]
    v_mfma_f32_16x16x32_bf16 v[84:87], v[132:135], v[148:151], v[84:87]
    v_mfma_f32_16x16x32_bf16 v[88:91], v[136:139], v[148:151], v[88:91]
    v_mfma_f32_16x16x32_bf16 v[92:95], v[140:143], v[148:151], v[92:95]
    v_mfma_f32_16x16x32_bf16 v[96:99], v[128:131], v[152:155], v[96:99]
    v_mfma_f32_16x16x32_bf16 v[100:103], v[132:135], v[152:155], v[100:103]
    v_mfma_f32_16x16x32_bf16 v[104:107], v[136:139], v[152:155], v[104:107]
    v_mfma_f32_16x16x32_bf16 v[108:111], v[140:143], v[152:155], v[108:111]
    v_mfma_f32_16x16x32_bf16 v[112:115], v[128:131], v[156:159], v[112:115]
    v_mfma_f32_16x16x32_bf16 v[116:119], v[132:135], v[156:159], v[116:119]
    ds_read_b64_tr_b16 v[176:177], v14 offset:40960
    ds_read_b64_tr_b16 v[178:179], v14 offset:41984
    ds_read_b128 v[160:163], v11 offset:32768
    ds_read_b128 v[164:167], v11 offset:34816
    v_mfma_f32_16x16x32_bf16 v[120:123], v[136:139], v[156:159], v[120:123]
    ds_read_b128 v[168:171], v11 offset:36864
    ds_read_b128 v[172:175], v11 offset:38912
    ds_read_b64_tr_b16 v[180:181], v15 offset:40960
    ds_read_b64_tr_b16 v[182:183], v15 offset:41984
    v_mfma_f32_16x16x32_bf16 v[124:127], v[140:143], v[156:159], v[124:127]
    ds_read_b64_tr_b16 v[184:185], v16 offset:40960
    ds_read_b64_tr_b16 v[186:187], v16 offset:41984
    ds_read_b64_tr_b16 v[188:189], v17 offset:40960
    ds_read_b64_tr_b16 v[190:191], v17 offset:41984
    s_waitcnt lgkmcnt(0)
    s_waitcnt vmcnt(0)
    s_mov_b32 s60, 200000
Uz19:
    v_readfirstlane_b32 s100, v204
    s_nop 0
    s_cmp_lg_u32 s100, 0
    s_cbranch_scc1 Uz20
    buffer_load_dword v204, v205, s[24:27], 0 offen sc1
    s_waitcnt vmcnt(0)
    s_sub_u32 s60, s60, 1
    s_cbranch_scc0 Uz19
Uz20:
    s_mov_b32 s101, s100
    s_lshl_b32 s33, s2, 7
    s_add_u32 s33, s33, 28434432
    v_mov_b32 v202, s100
    v_lshlrev_b32 v203, 2, s28
    s_waitcnt vmcnt(0)
    s_mov_b64 exec, 1
    buffer_store_dword v202, v203, s[20:23], s33 offen sc1
    s_mov_b64 exec, -1
    s_barrier
    v_mfma_f32_16x16x32_bf16 v[64:67], v[160:163], v[176:179], v[64:67]
    v_mfma_f32_16x16x32_bf16 v[68:71], v[164:167], v[176:179], v[68:71]
    v_mfma_f32_16x16x32_bf16 v[72:75], v[168:171], v[176:179], v[72:75]
    v_mfma_f32_16x16x32_bf16 v[76:79], v[172:175], v[176:179], v[76:79]
    v_mfma_f32_16x16x32_bf16 v[80:83], v[160:163], v[180:183], v[80:83]
    v_mfma_f32_16x16x32_bf16 v[84:87], v[164:167], v[180:183], v[84:87]
    v_mfma_f32_16x16x32_bf16 v[88:91], v[168:171], v[180:183], v[88:91]
    v_mfma_f32_16x16x32_bf16 v[92:95], v[172:175], v[180:183], v[92:95]
    v_mfma_f32_16x16x32_bf16 v[96:99], v[160:163], v[184:187], v[96:99]
    v_mfma_f32_16x16x32_bf16 v[100:103], v[164:167], v[184:187], v[100:103]
    v_mfma_f32_16x16x32_bf16 v[104:107], v[168:171], v[184:187], v[104:107]
    v_mfma_f32_16x16x32_bf16 v[108:111], v[172:175], v[184:187], v[108:111]
    v_mfma_f32_16x16x32_bf16 v[112:115], v[160:163], v[188:191], v[112:115]
    v_mfma_f32_16x16x32_bf16 v[116:119], v[164:167], v[188:191], v[116:119]
    ds_read_b64_tr_b16 v[144:145], v18 offset:0
    ds_read_b64_tr_b16 v[146:147], v18 offset:1024
    ds_read_b128 v[128:131], v12 offset:0
    ds_read_b128 v[132:135], v12 offset:2048
    v_mfma_f32_16x16x32_bf16 v[120:123], v[168:171], v[188:191], v[120:123]
    ds_read_b128 v[136:139], v12 offset:4096
    ds_read_b128 v[140:143], v12 offset:6144
    ds_read_b64_tr_b16 v[148:149], v19 offset:0
    ds_read_b64_tr_b16 v[150:151], v19 offset:1024
    v_mfma_f32_16x16x32_bf16 v[124:127], v[172:175], v[188:191], v[124:127]
    ds_read_b64_tr_b16 v[152:153], v20 offset:0
    ds_read_b64_tr_b16 v[154:155], v20 offset:1024
    ds_read_b64_tr_b16 v[156:157], v21 offset:0
    ds_read_b64_tr_b16 v[158:159], v21 offset:1024
    s_waitcnt lgkmcnt(0)
    v_mfma_f32_16x16x32_bf16 v[64:67], v[128:131], v[144:147], v[64:67]
    v_mfma_f32_16x16x32_bf16 v[68:71], v[132:135], v[144:147], v[68:71]
    v_mfma_f32_16x16x32_bf16 v[72:75], v[136:139], v[144:147], v[72:75]
    v_mfma_f32_16x16x32_bf16 v[76:79], v[140:143], v[144:147], v[76:79]
    v_mfma_f32_16x16x32_bf16 v[80:83], v[128:131], v[148:151], v[80:83]
    v_mfma_f32_16x16x32_bf16 v[84:87], v[132:135], v[148:151], v[84:87]
    v_mfma_f32_16x16x32_bf16 v[88:91], v[136:139], v[148:151], v[88:91]
    v_mfma_f32_16x16x32_bf16 v[92:95], v[140:143], v[148:151], v[92:95]
    v_mfma_f32_16x16x32_bf16 v[96:99], v[128:131], v[152:155], v[96:99]
    v_mfma_f32_16x16x32_bf16 v[100:103], v[132:135], v[152:155], v[100:103]
    v_mfma_f32_16x16x32_bf16 v[104:107], v[136:139], v[152:155], v[104:107]
    v_mfma_f32_16x16x32_bf16 v[108:111], v[140:143], v[152:155], v[108:111]
    v_mfma_f32_16x16x32_bf16 v[112:115], v[128:131], v[156:159], v[112:115]
    v_mfma_f32_16x16x32_bf16 v[116:119], v[132:135], v[156:159], v[116:119]
    ds_read_b64_tr_b16 v[176:177], v18 offset:8192
    ds_read_b64_tr_b16 v[178:179], v18 offset:9216
    ds_read_b128 v[160:163], v13 offset:0
    ds_read_b128 v[164:167], v13 offset:2048
    v_mfma_f32_16x16x32_bf16 v[120:123], v[136:139], v[156:159], v[120:123]
    ds_read_b128 v[168:171], v13 offset:4096
    ds_read_b128 v[172:175], v13 offset:6144
    ds_read_b64_tr_b16 v[180:181], v19 offset:8192
    ds_read_b64_tr_b16 v[182:183], v19 offset:9216
    v_mfma_f32_16x16x32_bf16 v[124:127], v[140:143], v[156:159], v[124:127]
    ds_read_b64_tr_b16 v[184:185], v20 offset:8192
    ds_read_b64_tr_b16 v[186:187], v20 offset:9216
    ds_read_b64_tr_b16 v[188:189], v21 offset:8192
    ds_read_b64_tr_b16 v[190:191], v21 offset:9216
    s_waitcnt lgkmcnt(0)
    s_barrier
    v_mfma_f32_16x16x32_bf16 v[64:67], v[160:163], v[176:179], v[64:67]
    v_mfma_f32_16x16x32_bf16 v[68:71], v[164:167], v[176:179], v[68:71]
    v_mfma_f32_16x16x32_bf16 v[72:75], v[168:171], v[176:179], v[72:75]
    v_mfma_f32_16x16x32_bf16 v[76:79], v[172:175], v[176:179], v[76:79]
    v_mfma_f32_16x16x32_bf16 v[80:83], v[160:163], v[180:183], v[80:83]
    v_mfma_f32_16x16x32_bf16 v[84:87], v[164:167], v[180:183], v[84:87]
    v_mfma_f32_16x16x32_bf16 v[88:91], v[168:171], v[180:183], v[88:91]
    v_mfma_f32_16x16x32_bf16 v[92:95], v[172:175], v[180:183], v[92:95]
    v_mfma_f32_16x16x32_bf16 v[96:99], v[160:163], v[184:187], v[96:99]
    v_mfma_f32_16x16x32_bf16 v[100:103], v[164:167], v[184:187], v[100:103]
    v_mfma_f32_16x16x32_bf16 v[104:107], v[168:171], v[184:187], v[104:107]
    v_mfma_f32_16x16x32_bf16 v[108:111], v[172:175], v[184:187], v[108:111]
    v_mfma_f32_16x16x32_bf16 v[112:115], v[160:163], v[188:191], v[112:115]
    v_mfma_f32_16x16x32_bf16 v[116:119], v[164:167], v[188:191], v[116:119]
    ds_read_b64_tr_b16 v[144:145], v18 offset:32768
    ds_read_b64_tr_b16 v[146:147], v18 offset:33792
    ds_read_b128 v[128:131], v12 offset:32768
    ds_read_b128 v[132:135], v12 offset:34816
    v_mfma_f32_16x16x32_bf16 v[120:123], v[168:171], v[188:191], v[120:123]
    ds_read_b128 v[136:139], v12 offset:36864
    ds_read_b128 v[140:143], v12 offset:38912
    ds_read_b64_tr_b16 v[148:149], v19 offset:32768
    ds_read_b64_tr_b16 v[150:151], v19 offset:33792
    v_mfma_f32_16x16x32_bf16 v[124:127], v[172:175], v[188:191], v[124:127]
    ds_read_b64_tr_b16 v[152:153], v20 offset:32768
    ds_read_b64_tr_b16 v[154:155], v20 offset:33792
    ds_read_b64_tr_b16 v[156:157], v21 offset:32768
    ds_read_b64_tr_b16 v[158:159], v21 offset:33792
    s_waitcnt lgkmcnt(0)
    v_mfma_f32_16x16x32_bf16 v[64:67], v[128:131], v[144:147], v[64:67]
    v_mfma_f32_16x16x32_bf16 v[68:71], v[132:135], v[144:147], v[68:71]
    v_mfma_f32_16x16x32_bf16 v[72:75], v[136:139], v[144:147], v[72:75]
    v_mfma_f32_16x16x32_bf16 v[76:79], v[140:143], v[144:147], v[76:79]
    v_mfma_f32_16x16x32_bf16 v[80:83], v[128:131], v[148:151], v[80:83]
    v_mfma_f32_16x16x32_bf16 v[84:87], v[132:135], v[148:151], v[84:87]
    v_mfma_f32_16x16x32_bf16 v[88:91], v[136:139], v[148:151], v[88:91]
    v_mfma_f32_16x16x32_bf16 v[92:95], v[140:143], v[148:151], v[92:95]
    v_mfma_f32_16x16x32_bf16 v[96:99], v[128:131], v[152:155], v[96:99]
    v_mfma_f32_16x16x32_bf16 v[100:103], v[132:135], v[152:155], v[100:103]
    v_mfma_f32_16x16x32_bf16 v[104:107], v[136:139], v[152:155], v[104:107]
    v_mfma_f32_16x16x32_bf16 v[108:111], v[140:143], v[152:155], v[108:111]
    v_mfma_f32_16x16x32_bf16 v[112:115], v[128:131], v[156:159], v[112:115]
    v_mfma_f32_16x16x32_bf16 v[116:119], v[132:135], v[156:159], v[116:119]
    ds_read_b64_tr_b16 v[176:177], v18 offset:40960
    ds_read_b64_tr_b16 v[178:179], v18 offset:41984
    ds_read_b128 v[160:163], v13 offset:32768
    ds_read_b128 v[164:167], v13 offset:34816
    v_mfma_f32_16x16x32_bf16 v[120:123], v[136:139], v[156:159], v[120:123]
    ds_read_b128 v[168:171], v13 offset:36864
    ds_read_b128 v[172:175], v13 offset:38912
    ds_read_b64_tr_b16 v[180:181], v19 offset:40960
    ds_read_b64_tr_b16 v[182:183], v19 offset:41984
    v_mfma_f32_16x16x32_bf16 v[124:127], v[140:143], v[156:159], v[124:127]
    ds_read_b64_tr_b16 v[184:185], v20 offset:40960
    ds_read_b64_tr_b16 v[186:187], v20 offset:41984
    ds_read_b64_tr_b16 v[188:189], v21 offset:40960
    ds_read_b64_tr_b16 v[190:191], v21 offset:41984
    s_waitcnt lgkmcnt(0)
    s_barrier
    v_mfma_f32_16x16x32_bf16 v[64:67], v[160:163], v[176:179], v[64:67]
    v_mfma_f32_16x16x32_bf16 v[68:71], v[164:167], v[176:179], v[68:71]
    v_mfma_f32_16x16x32_bf16 v[72:75], v[168:171], v[176:179], v[72:75]
    v_mfma_f32_16x16x32_bf16 v[76:79], v[172:175], v[176:179], v[76:79]
    v_mfma_f32_16x16x32_bf16 v[80:83], v[160:163], v[180:183], v[80:83]
    v_mfma_f32_16x16x32_bf16 v[84:87], v[164:167], v[180:183], v[84:87]
    v_mfma_f32_16x16x32_bf16 v[88:91], v[168:171], v[180:183], v[88:91]
    v_mfma_f32_16x16x32_bf16 v[92:95], v[172:175], v[180:183], v[92:95]
    v_mfma_f32_16x16x32_bf16 v[96:99], v[160:163], v[184:187], v[96:99]
    v_mfma_f32_16x16x32_bf16 v[100:103], v[164:167], v[184:187], v[100:103]
    v_mfma_f32_16x16x32_bf16 v[104:107], v[168:171], v[184:187], v[104:107]
    v_mfma_f32_16x16x32_bf16 v[108:111], v[172:175], v[184:187], v[108:111]
    v_mfma_f32_16x16x32_bf16 v[112:115], v[160:163], v[188:191], v[112:115]
    v_mfma_f32_16x16x32_bf16 v[116:119], v[164:167], v[188:191], v[116:119]
    ds_read_b64_tr_b16 v[144:145], v14 offset:0
    ds_read_b64_tr_b16 v[146:147], v14 offset:1024
    ds_read_b128 v[128:131], v10 offset:0
    ds_read_b128 v[132:135], v10 offset:2048
    v_mfma_f32_16x16x32_bf16 v[120:123], v[168:171], v[188:191], v[120:123]
    ds_read_b128 v[136:139], v10 offset:4096
    ds_read_b128 v[140:143], v10 offset:6144
    ds_read_b64_tr_b16 v[148:149], v15 offset:0
    ds_read_b64_tr_b16 v[150:151], v15 offset:1024
    v_mfma_f32_16x16x32_bf16 v[124:127], v[172:175], v[188:191], v[124:127]
    ds_read_b64_tr_b16 v[152:153], v16 offset:0
    ds_read_b64_tr_b16 v[154:155], v16 offset:1024
    ds_read_b64_tr_b16 v[156:157], v17 offset:0
    ds_read_b64_tr_b16 v[158:159], v17 offset:1024
    s_waitcnt lgkmcnt(0)
    v_mfma_f32_16x16x32_bf16 v[64:67], v[128:131], v[144:147], v[64:67]
    v_mfma_f32_16x16x32_bf16 v[68:71], v[132:135], v[144:147], v[68:71]
    v_mfma_f32_16x16x32_bf16 v[72:75], v[136:139], v[144:147], v[72:75]
    v_mfma_f32_16x16x32_bf16 v[76:79], v[140:143], v[144:147], v[76:79]
    v_mfma_f32_16x16x32_bf16 v[80:83], v[128:131], v[148:151], v[80:83]
    v_mfma_f32_16x16x32_bf16 v[84:87], v[132:135], v[148:151], v[84:87]
    v_mfma_f32_16x16x32_bf16 v[88:91], v[136:139], v[148:151], v[88:91]
    v_mfma_f32_16x16x32_bf16 v[92:95], v[140:143], v[148:151], v[92:95]
    v_mfma_f32_16x16x32_bf16 v[96:99], v[128:131], v[152:155], v[96:99]
    v_mfma_f32_16x16x32_bf16 v[100:103], v[132:135], v[152:155], v[100:103]
    v_mfma_f32_16x16x32_bf16 v[104:107], v[136:139], v[152:155], v[104:107]
    v_mfma_f32_16x16x32_bf16 v[108:111], v[140:143], v[152:155], v[108:111]
    v_mfma_f32_16x16x32_bf16 v[112:115], v[128:131], v[156:159], v[112:115]
    v_mfma_f32_16x16x32_bf16 v[116:119], v[132:135], v[156:159], v[116:119]
    ds_read_b64_tr_b16 v[176:177], v14 offset:8192
    ds_read_b64_tr_b16 v[178:179], v14 offset:9216
    ds_read_b128 v[160:163], v11 offset:0
    ds_read_b128 v[164:167], v11 offset:2048
    v_mfma_f32_16x16x32_bf16 v[120:123], v[136:139], v[156:159], v[120:123]
    ds_read_b128 v[168:171], v11 offset:4096
    ds_read_b128 v[172:175], v11 offset:6144
    ds_read_b64_tr_b16 v[180:181], v15 offset:8192
    ds_read_b64_tr_b16 v[182:183], v15 offset:9216
    v_mfma_f32_16x16x32_bf16 v[124:127], v[140:143], v[156:159], v[124:127]
    ds_read_b64_tr_b16 v[184:185], v16 offset:8192
    ds_read_b64_tr_b16 v[186:187], v16 offset:9216
    ds_read_b64_tr_b16 v[188:189], v17 offset:8192
    ds_read_b64_tr_b16 v[190:191], v17 offset:9216
    s_waitcnt lgkmcnt(0)
    s_barrier
    v_mfma_f32_16x16x32_bf16 v[64:67], v[160:163], v[176:179], v[64:67]
    v_mfma_f32_16x16x32_bf16 v[68:71], v[164:167], v[176:179], v[68:71]
    v_mfma_f32_16x16x32_bf16 v[72:75], v[168:171], v[176:179], v[72:75]
    v_mfma_f32_16x16x32_bf16 v[76:79], v[172:175], v[176:179], v[76:79]
    v_mfma_f32_16x16x32_bf16 v[80:83], v[160:163], v[180:183], v[80:83]
    v_mfma_f32_16x16x32_bf16 v[84:87], v[164:167], v[180:183], v[84:87]
    v_mfma_f32_16x16x32_bf16 v[88:91], v[168:171], v[180:183], v[88:91]
    v_mfma_f32_16x16x32_bf16 v[92:95], v[172:175], v[180:183], v[92:95]
    v_mfma_f32_16x16x32_bf16 v[96:99], v[160:163], v[184:187], v[96:99]
    v_mfma_f32_16x16x32_bf16 v[100:103], v[164:167], v[184:187], v[100:103]
    v_mfma_f32_16x16x32_bf16 v[104:107], v[168:171], v[184:187], v[104:107]
    v_mfma_f32_16x16x32_bf16 v[108:111], v[172:175], v[184:187], v[108:111]
    v_mfma_f32_16x16x32_bf16 v[112:115], v[160:163], v[188:191], v[112:115]
    v_mfma_f32_16x16x32_bf16 v[116:119], v[164:167], v[188:191], v[116:119]
    ds_read_b64_tr_b16 v[144:145], v14 offset:32768
    ds_read_b64_tr_b16 v[146:147], v14 offset:33792
    ds_read_b128 v[128:131], v10 offset:32768
    ds_read_b128 v[132:135], v10 offset:34816
    v_mfma_f32_16x16x32_bf16 v[120:123], v[168:171], v[188:191], v[120:123]
    ds_read_b128 v[136:139], v10 offset:36864
    ds_read_b128 v[140:143], v10 offset:38912
    ds_read_b64_tr_b16 v[148:149], v15 offset:32768
    ds_read_b64_tr_b16 v[150:151], v15 offset:33792
    v_mfma_f32_16x16x32_bf16 v[124:127], v[172:175], v[188:191], v[124:127]
    ds_read_b64_tr_b16 v[152:153], v16 offset:32768
    ds_read_b64_tr_b16 v[154:155], v16 offset:33792
    ds_read_b64_tr_b16 v[156:157], v17 offset:32768
    ds_read_b64_tr_b16 v[158:159], v17 offset:33792
    s_waitcnt lgkmcnt(0)
    v_mfma_f32_16x16x32_bf16 v[64:67], v[128:131], v[144:147], v[64:67]
    v_mfma_f32_16x16x32_bf16 v[68:71], v[132:135], v[144:147], v[68:71]
    v_mfma_f32_16x16x32_bf16 v[72:75], v[136:139], v[144:147], v[72:75]
    v_mfma_f32_16x16x32_bf16 v[76:79], v[140:143], v[144:147], v[76:79]
    v_mfma_f32_16x16x32_bf16 v[80:83], v[128:131], v[148:151], v[80:83]
    v_mfma_f32_16x16x32_bf16 v[84:87], v[132:135], v[148:151], v[84:87]
    v_mfma_f32_16x16x32_bf16 v[88:91], v[136:139], v[148:151], v[88:91]
    v_mfma_f32_16x16x32_bf16 v[92:95], v[140:143], v[148:151], v[92:95]
    v_mfma_f32_16x16x32_bf16 v[96:99], v[128:131], v[152:155], v[96:99]
    v_mfma_f32_16x16x32_bf16 v[100:103], v[132:135], v[152:155], v[100:103]
    v_mfma_f32_16x16x32_bf16 v[104:107], v[136:139], v[152:155], v[104:107]
    v_mfma_f32_16x16x32_bf16 v[108:111], v[140:143], v[152:155], v[108:111]
    v_mfma_f32_16x16x32_bf16 v[112:115], v[128:131], v[156:159], v[112:115]
    v_mfma_f32_16x16x32_bf16 v[116:119], v[132:135], v[156:159], v[116:119]
    ds_read_b64_tr_b16 v[176:177], v14 offset:40960
    ds_read_b64_tr_b16 v[178:179], v14 offset:41984
    ds_read_b128 v[160:163], v11 offset:32768
    ds_read_b128 v[164:167], v11 offset:34816
    v_mfma_f32_16x16x32_bf16 v[120:123], v[136:139], v[156:159], v[120:123]
    ds_read_b128 v[168:171], v11 offset:36864
    ds_read_b128 v[172:175], v11 offset:38912
    ds_read_b64_tr_b16 v[180:181], v15 offset:40960
    ds_read_b64_tr_b16 v[182:183], v15 offset:41984
    v_mfma_f32_16x16x32_bf16 v[124:127], v[140:143], v[156:159], v[124:127]
    ds_read_b64_tr_b16 v[184:185], v16 offset:40960
    ds_read_b64_tr_b16 v[186:187], v16 offset:41984
    ds_read_b64_tr_b16 v[188:189], v17 offset:40960
    ds_read_b64_tr_b16 v[190:191], v17 offset:41984
    s_waitcnt lgkmcnt(0)
    s_barrier
    v_mfma_f32_16x16x32_bf16 v[64:67], v[160:163], v[176:179], v[64:67]
    ds_read_b64_tr_b16 v[144:145], v18 offset:0
    ds_read_b64_tr_b16 v[146:147], v18 offset:1024
    v_mfma_f32_16x16x32_bf16 v[68:71], v[164:167], v[176:179], v[68:71]
    ds_read_b128 v[128:131], v12 offset:0
    ds_read_b128 v[132:135], v12 offset:2048
    v_mfma_f32_16x16x32_bf16 v[72:75], v[168:171], v[176:179], v[72:75]
    ds_read_b128 v[136:139], v12 offset:4096
    ds_read_b128 v[140:143], v12 offset:6144
    v_mfma_f32_16x16x32_bf16 v[76:79], v[172:175], v[176:179], v[76:79]
    ds_read_b64_tr_b16 v[148:149], v19 offset:0
    ds_read_b64_tr_b16 v[150:151], v19 offset:1024
    v_mfma_f32_16x16x32_bf16 v[80:83], v[160:163], v[180:183], v[80:83]
    ds_read_b64_tr_b16 v[152:153], v20 offset:0
    ds_read_b64_tr_b16 v[154:155], v20 offset:1024
    v_mfma_f32_16x16x32_bf16 v[84:87], v[164:167], v[180:183], v[84:87]
    ds_read_b64_tr_b16 v[156:157], v21 offset:0
    ds_read_b64_tr_b16 v[158:159], v21 offset:1024
    v_mfma_f32_16x16x32_bf16 v[88:91], v[168:171], v[180:183], v[88:91]
    v_mfma_f32_16x16x32_bf16 v[92:95], v[172:175], v[180:183], v[92:95]
    v_mfma_f32_16x16x32_bf16 v[96:99], v[160:163], v[184:187], v[96:99]
    v_mfma_f32_16x16x32_bf16 v[100:103], v[164:167], v[184:187], v[100:103]
    v_mfma_f32_16x16x32_bf16 v[104:107], v[168:171], v[184:187], v[104:107]
    v_mfma_f32_16x16x32_bf16 v[108:111], v[172:175], v[184:187], v[108:111]
    v_mfma_f32_16x16x32_bf16 v[112:115], v[160:163], v[188:191], v[112:115]
    v_mfma_f32_16x16x32_bf16 v[116:119], v[164:167], v[188:191], v[116:119]
    v_mfma_f32_16x16x32_bf16 v[120:123], v[168:171], v[188:191], v[120:123]
    v_mfma_f32_16x16x32_bf16 v[124:127], v[172:175], v[188:191], v[124:127]
    s_waitcnt lgkmcnt(0)
    v_mfma_f32_16x16x32_bf16 v[64:67], v[128:131], v[144:147], v[64:67]
    ds_read_b64_tr_b16 v[176:177], v18 offset:8192
    ds_read_b64_tr_b16 v[178:179], v18 offset:9216
    v_mfma_f32_16x16x32_bf16 v[68:71], v[132:135], v[144:147], v[68:71]
    ds_read_b128 v[160:163], v13 offset:0
    ds_read_b128 v[164:167], v13 offset:2048
    v_mfma_f32_16x16x32_bf16 v[72:75], v[136:139], v[144:147], v[72:75]
    ds_read_b128 v[168:171], v13 offset:4096
    ds_read_b128 v[172:175], v13 offset:6144
    v_mfma_f32_16x16x32_bf16 v[76:79], v[140:143], v[144:147], v[76:79]
    ds_read_b64_tr_b16 v[180:181], v19 offset:8192
    ds_read_b64_tr_b16 v[182:183], v19 offset:9216
    v_mfma_f32_16x16x32_bf16 v[80:83], v[128:131], v[148:151], v[80:83]
    ds_read_b64_tr_b16 v[184:185], v20 offset:8192
    ds_read_b64_tr_b16 v[186:187], v20 offset:9216
    v_mfma_f32_16x16x32_bf16 v[84:87], v[132:135], v[148:151], v[84:87]
    ds_read_b64_tr_b16 v[188:189], v21 offset:8192
    ds_read_b64_tr_b16 v[190:191], v21 offset:9216
    v_mfma_f32_16x16x32_bf16 v[88:91], v[136:139], v[148:151], v[88:91]
    v_mfma_f32_16x16x32_bf16 v[92:95], v[140:143], v[148:151], v[92:95]
    v_mfma_f32_16x16x32_bf16 v[96:99], v[128:131], v[152:155], v[96:99]
    v_mfma_f32_16x16x32_bf16 v[100:103], v[132:135], v[152:155], v[100:103]
    v_mfma_f32_16x16x32_bf16 v[104:107], v[136:139], v[152:155], v[104:107]
    v_mfma_f32_16x16x32_bf16 v[108:111], v[140:143], v[152:155], v[108:111]
    v_mfma_f32_16x16x32_bf16 v[112:115], v[128:131], v[156:159], v[112:115]
    v_mfma_f32_16x16x32_bf16 v[116:119], v[132:135], v[156:159], v[116:119]
    v_mfma_f32_16x16x32_bf16 v[120:123], v[136:139], v[156:159], v[120:123]
    v_mfma_f32_16x16x32_bf16 v[124:127], v[140:143], v[156:159], v[124:127]
    s_waitcnt lgkmcnt(0)
    s_barrier
    v_mfma_f32_16x16x32_bf16 v[64:67], v[160:163], v[176:179], v[64:67]
    ds_read_b64_tr_b16 v[144:145], v18 offset:32768
    ds_read_b64_tr_b16 v[146:147], v18 offset:33792
    v_mfma_f32_16x16x32_bf16 v[68:71], v[164:167], v[176:179], v[68:71]
    ds_read_b128 v[128:131], v12 offset:32768
    ds_read_b128 v[132:135], v12 offset:34816
    v_mfma_f32_16x16x32_bf16 v[72:75], v[168:171], v[176:179], v[72:75]
    ds_read_b128 v[136:139], v12 offset:36864
    ds_read_b128 v[140:143], v12 offset:38912
    v_mfma_f32_16x16x32_bf16 v[76:79], v[172:175], v[176:179], v[76:79]
    ds_read_b64_tr_b16 v[148:149], v19 offset:32768
    ds_read_b64_tr_b16 v[150:151], v19 offset:33792
    v_mfma_f32_16x16x32_bf16 v[80:83], v[160:163], v[180:183], v[80:83]
    ds_read_b64_tr_b16 v[152:153], v20 offset:32768
    ds_read_b64_tr_b16 v[154:155], v20 offset:33792
    v_mfma_f32_16x16x32_bf16 v[84:87], v[164:167], v[180:183], v[84:87]
    ds_read_b64_tr_b16 v[156:157], v21 offset:32768
    ds_read_b64_tr_b16 v[158:159], v21 offset:33792
    v_mfma_f32_16x16x32_bf16 v[88:91], v[168:171], v[180:183], v[88:91]
    v_mfma_f32_16x16x32_bf16 v[92:95], v[172:175], v[180:183], v[92:95]
    v_mfma_f32_16x16x32_bf16 v[96:99], v[160:163], v[184:187], v[96:99]
    v_mfma_f32_16x16x32_bf16 v[100:103], v[164:167], v[184:187], v[100:103]
    v_mfma_f32_16x16x32_bf16 v[104:107], v[168:171], v[184:187], v[104:107]
    v_mfma_f32_16x16x32_bf16 v[108:111], v[172:175], v[184:187], v[108:111]
    v_mfma_f32_16x16x32_bf16 v[112:115], v[160:163], v[188:191], v[112:115]
    v_mfma_f32_16x16x32_bf16 v[116:119], v[164:167], v[188:191], v[116:119]
    v_mfma_f32_16x16x32_bf16 v[120:123], v[168:171], v[188:191], v[120:123]
    v_mfma_f32_16x16x32_bf16 v[124:127], v[172:175], v[188:191], v[124:127]
    s_waitcnt lgkmcnt(0)
    v_mfma_f32_16x16x32_bf16 v[64:67], v[128:131], v[144:147], v[64:67]
    ds_read_b64_tr_b16 v[176:177], v18 offset:40960
    ds_read_b64_tr_b16 v[178:179], v18 offset:41984
    v_mfma_f32_16x16x32_bf16 v[68:71], v[132:135], v[144:147], v[68:71]
    ds_read_b128 v[160:163], v13 offset:32768
    ds_read_b128 v[164:167], v13 offset:34816
    v_mfma_f32_16x16x32_bf16 v[72:75], v[136:139], v[144:147], v[72:75]
    ds_read_b128 v[168:171], v13 offset:36864
    ds_read_b128 v[172:175], v13 offset:38912
    v_mfma_f32_16x16x32_bf16 v[76:79], v[140:143], v[144:147], v[76:79]
    ds_read_b64_tr_b16 v[180:181], v19 offset:40960
    ds_read_b64_tr_b16 v[182:183], v19 offset:41984
    v_mfma_f32_16x16x32_bf16 v[80:83], v[128:131], v[148:151], v[80:83]
    ds_read_b64_tr_b16 v[184:185], v20 offset:40960
    ds_read_b64_tr_b16 v[186:187], v20 offset:41984
    v_mfma_f32_16x16x32_bf16 v[84:87], v[132:135], v[148:151], v[84:87]
    ds_read_b64_tr_b16 v[188:189], v21 offset:40960
    ds_read_b64_tr_b16 v[190:191], v21 offset:41984
    v_mfma_f32_16x16x32_bf16 v[88:91], v[136:139], v[148:151], v[88:91]
    v_mfma_f32_16x16x32_bf16 v[92:95], v[140:143], v[148:151], v[92:95]
    v_mfma_f32_16x16x32_bf16 v[96:99], v[128:131], v[152:155], v[96:99]
    v_mfma_f32_16x16x32_bf16 v[100:103], v[132:135], v[152:155], v[100:103]
    v_mfma_f32_16x16x32_bf16 v[104:107], v[136:139], v[152:155], v[104:107]
    v_mfma_f32_16x16x32_bf16 v[108:111], v[140:143], v[152:155], v[108:111]
    v_mfma_f32_16x16x32_bf16 v[112:115], v[128:131], v[156:159], v[112:115]
    v_mfma_f32_16x16x32_bf16 v[116:119], v[132:135], v[156:159], v[116:119]
    v_mfma_f32_16x16x32_bf16 v[120:123], v[136:139], v[156:159], v[120:123]
    v_mfma_f32_16x16x32_bf16 v[124:127], v[140:143], v[156:159], v[124:127]
    s_waitcnt lgkmcnt(0)
    s_barrier
    v_mfma_f32_16x16x32_bf16 v[64:67], v[160:163], v[176:179], v[64:67]
    ds_read_b64_tr_b16 v[144:145], v14 offset:0
    ds_read_b64_tr_b16 v[146:147], v14 offset:1024
    v_mfma_f32_16x16x32_bf16 v[68:71], v[164:167], v[176:179], v[68:71]
    ds_read_b128 v[128:131], v10 offset:0
    ds_read_b128 v[132:135], v10 offset:2048
    v_mfma_f32_16x16x32_bf16 v[72:75], v[168:171], v[176:179], v[72:75]
    ds_read_b128 v[136:139], v10 offset:4096
    ds_read_b128 v[140:143], v10 offset:6144
    v_mfma_f32_16x16x32_bf16 v[76:79], v[172:175], v[176:179], v[76:79]
    ds_read_b64_tr_b16 v[148:149], v15 offset:0
    ds_read_b64_tr_b16 v[150:151], v15 offset:1024
    v_mfma_f32_16x16x32_bf16 v[80:83], v[160:163], v[180:183], v[80:83]
    ds_read_b64_tr_b16 v[152:153], v16 offset:0
    ds_read_b64_tr_b16 v[154:155], v16 offset:1024
    v_mfma_f32_16x16x32_bf16 v[84:87], v[164:167], v[180:183], v[84:87]
    ds_read_b64_tr_b16 v[156:157], v17 offset:0
    ds_read_b64_tr_b16 v[158:159], v17 offset:1024
    v_mfma_f32_16x16x32_bf16 v[88:91], v[168:171], v[180:183], v[88:91]
    v_mfma_f32_16x16x32_bf16 v[92:95], v[172:175], v[180:183], v[92:95]
    v_mfma_f32_16x16x32_bf16 v[96:99], v[160:163], v[184:187], v[96:99]
    v_mfma_f32_16x16x32_bf16 v[100:103], v[164:167], v[184:187], v[100:103]
    v_mfma_f32_16x16x32_bf16 v[104:107], v[168:171], v[184:187], v[104:107]
    v_mfma_f32_16x16x32_bf16 v[108:111], v[172:175], v[184:187], v[108:111]
    v_mfma_f32_16x16x32_bf16 v[112:115], v[160:163], v[188:191], v[112:115]
    v_mfma_f32_16x16x32_bf16 v[116:119], v[164:167], v[188:191], v[116:119]
    v_mfma_f32_16x16x32_bf16 v[120:123], v[168:171], v[188:191], v[120:123]
    v_mfma_f32_16x16x32_bf16 v[124:127], v[172:175], v[188:191], v[124:127]
    s_waitcnt lgkmcnt(0)
    v_mfma_f32_16x16x32_bf16 v[64:67], v[128:131], v[144:147], v[64:67]
    ds_read_b64_tr_b16 v[176:177], v14 offset:8192
    ds_read_b64_tr_b16 v[178:179], v14 offset:9216
    v_mfma_f32_16x16x32_bf16 v[68:71], v[132:135], v[144:147], v[68:71]
    ds_read_b128 v[160:163], v11 offset:0
    ds_read_b128 v[164:167], v11 offset:2048
    v_mfma_f32_16x16x32_bf16 v[72:75], v[136:139], v[144:147], v[72:75]
    ds_read_b128 v[168:171], v11 offset:4096
    ds_read_b128 v[172:175], v11 offset:6144
    v_mfma_f32_16x16x32_bf16 v[76:79], v[140:143], v[144:147], v[76:79]
    ds_read_b64_tr_b16 v[180:181], v15 offset:8192
    ds_read_b64_tr_b16 v[182:183], v15 offset:9216
    v_mfma_f32_16x16x32_bf16 v[80:83], v[128:131], v[148:151], v[80:83]
    ds_read_b64_tr_b16 v[184:185], v16 offset:8192
    ds_read_b64_tr_b16 v[186:187], v16 offset:9216
    v_mfma_f32_16x16x32_bf16 v[84:87], v[132:135], v[148:151], v[84:87]
    ds_read_b64_tr_b16 v[188:189], v17 offset:8192
    ds_read_b64_tr_b16 v[190:191], v17 offset:9216
    v_mfma_f32_16x16x32_bf16 v[88:91], v[136:139], v[148:151], v[88:91]
    v_mfma_f32_16x16x32_bf16 v[92:95], v[140:143], v[148:151], v[92:95]
    v_mfma_f32_16x16x32_bf16 v[96:99], v[128:131], v[152:155], v[96:99]
    v_mfma_f32_16x16x32_bf16 v[100:103], v[132:135], v[152:155], v[100:103]
    v_mfma_f32_16x16x32_bf16 v[104:107], v[136:139], v[152:155], v[104:107]
    v_mfma_f32_16x16x32_bf16 v[108:111], v[140:143], v[152:155], v[108:111]
    v_mfma_f32_16x16x32_bf16 v[112:115], v[128:131], v[156:159], v[112:115]
    v_mfma_f32_16x16x32_bf16 v[116:119], v[132:135], v[156:159], v[116:119]
    v_mfma_f32_16x16x32_bf16 v[120:123], v[136:139], v[156:159], v[120:123]
    v_mfma_f32_16x16x32_bf16 v[124:127], v[140:143], v[156:159], v[124:127]
    s_waitcnt lgkmcnt(0)
    s_barrier
    v_mfma_f32_16x16x32_bf16 v[64:67], v[160:163], v[176:179], v[64:67]
    ds_read_b64_tr_b16 v[144:145], v14 offset:32768
    ds_read_b64_tr_b16 v[146:147], v14 offset:33792
    v_mfma_f32_16x16x32_bf16 v[68:71], v[164:167], v[176:179], v[68:71]
    ds_read_b128 v[128:131], v10 offset:32768
    ds_read_b128 v[132:135], v10 offset:34816
    v_mfma_f32_16x16x32_bf16 v[72:75], v[168:171], v[176:179], v[72:75]
    ds_read_b128 v[136:139], v10 offset:36864
    ds_read_b128 v[140:143], v10 offset:38912
    v_mfma_f32_16x16x32_bf16 v[76:79], v[172:175], v[176:179], v[76:79]
    ds_read_b64_tr_b16 v[148:149], v15 offset:32768
    ds_read_b64_tr_b16 v[150:151], v15 offset:33792
    v_mfma_f32_16x16x32_bf16 v[80:83], v[160:163], v[180:183], v[80:83]
    ds_read_b64_tr_b16 v[152:153], v16 offset:32768
    ds_read_b64_tr_b16 v[154:155], v16 offset:33792
    v_mfma_f32_16x16x32_bf16 v[84:87], v[164:167], v[180:183], v[84:87]
    ds_read_b64_tr_b16 v[156:157], v17 offset:32768
    ds_read_b64_tr_b16 v[158:159], v17 offset:33792
    v_mfma_f32_16x16x32_bf16 v[88:91], v[168:171], v[180:183], v[88:91]
    v_mfma_f32_16x16x32_bf16 v[92:95], v[172:175], v[180:183], v[92:95]
    v_mfma_f32_16x16x32_bf16 v[96:99], v[160:163], v[184:187], v[96:99]
    v_mfma_f32_16x16x32_bf16 v[100:103], v[164:167], v[184:187], v[100:103]
    v_mfma_f32_16x16x32_bf16 v[104:107], v[168:171], v[184:187], v[104:107]
    v_mfma_f32_16x16x32_bf16 v[108:111], v[172:175], v[184:187], v[108:111]
    v_mfma_f32_16x16x32_bf16 v[112:115], v[160:163], v[188:191], v[112:115]
    v_mfma_f32_16x16x32_bf16 v[116:119], v[164:167], v[188:191], v[116:119]
    v_mfma_f32_16x16x32_bf16 v[120:123], v[168:171], v[188:191], v[120:123]
    v_mfma_f32_16x16x32_bf16 v[124:127], v[172:175], v[188:191], v[124:127]
    s_waitcnt lgkmcnt(0)
    v_mfma_f32_16x16x32_bf16 v[64:67], v[128:131], v[144:147], v[64:67]
    ds_read_b64_tr_b16 v[176:177], v14 offset:40960
    ds_read_b64_tr_b16 v[178:179], v14 offset:41984
    v_mfma_f32_16x16x32_bf16 v[68:71], v[132:135], v[144:147], v[68:71]
    ds_read_b128 v[160:163], v11 offset:32768
    ds_read_b128 v[164:167], v11 offset:34816
    v_mfma_f32_16x16x32_bf16 v[72:75], v[136:139], v[144:147], v[72:75]
    ds_read_b128 v[168:171], v11 offset:36864
    ds_read_b128 v[172:175], v11 offset:38912
    v_mfma_f32_16x16x32_bf16 v[76:79], v[140:143], v[144:147], v[76:79]
    ds_read_b64_tr_b16 v[180:181], v15 offset:40960
    ds_read_b64_tr_b16 v[182:183], v15 offset:41984
    v_mfma_f32_16x16x32_bf16 v[80:83], v[128:131], v[148:151], v[80:83]
    ds_read_b64_tr_b16 v[184:185], v16 offset:40960
    ds_read_b64_tr_b16 v[186:187], v16 offset:41984
    v_mfma_f32_16x16x32_bf16 v[84:87], v[132:135], v[148:151], v[84:87]
    ds_read_b64_tr_b16 v[188:189], v17 offset:40960
    ds_read_b64_tr_b16 v[190:191], v17 offset:41984
    v_mfma_f32_16x16x32_bf16 v[88:91], v[136:139], v[148:151], v[88:91]
    v_mfma_f32_16x16x32_bf16 v[92:95], v[140:143], v[148:151], v[92:95]
    v_mfma_f32_16x16x32_bf16 v[96:99], v[128:131], v[152:155], v[96:99]
    v_mfma_f32_16x16x32_bf16 v[100:103], v[132:135], v[152:155], v[100:103]
    v_mfma_f32_16x16x32_bf16 v[104:107], v[136:139], v[152:155], v[104:107]
    v_mfma_f32_16x16x32_bf16 v[108:111], v[140:143], v[152:155], v[108:111]
    v_mfma_f32_16x16x32_bf16 v[112:115], v[128:131], v[156:159], v[112:115]
    v_mfma_f32_16x16x32_bf16 v[116:119], v[132:135], v[156:159], v[116:119]
    v_mfma_f32_16x16x32_bf16 v[120:123], v[136:139], v[156:159], v[120:123]
    v_mfma_f32_16x16x32_bf16 v[124:127], v[140:143], v[156:159], v[124:127]
    s_waitcnt lgkmcnt(0)
    s_barrier
    v_mfma_f32_16x16x32_bf16 v[64:67], v[160:163], v[176:179], v[64:67]
    ds_read_b64 v[192:193], v22 offset:0
    ds_read_b64 v[194:195], v22 offset:128
    v_mfma_f32_16x16x32_bf16 v[68:71], v[164:167], v[176:179], v[68:71]
    ds_read_b64 v[196:197], v22 offset:256
    ds_read_b64 v[198:199], v22 offset:384
    v_mfma_f32_16x16x32_bf16 v[72:75], v[168:171], v[176:179], v[72:75]
    ds_read_b64 v[32:33], v24 offset:0
    ds_read_b64 v[34:35], v24 offset:128
    v_mfma_f32_16x16x32_bf16 v[76:79], v[172:175], v[176:179], v[76:79]
    ds_read_b64 v[36:37], v24 offset:256
    ds_read_b64 v[38:39], v24 offset:384
    v_mfma_f32_16x16x32_bf16 v[80:83], v[160:163], v[180:183], v[80:83]
    ds_read_b128 v[40:43], v25 offset:0
    ds_read_b128 v[44:47], v25 offset:64
    v_mfma_f32_16x16x32_bf16 v[84:87], v[164:167], v[180:183], v[84:87]
    ds_read_b128 v[48:51], v25 offset:128
    ds_read_b128 v[52:55], v25 offset:192
    v_mfma_f32_16x16x32_bf16 v[88:91], v[168:171], v[180:183], v[88:91]
    v_mfma_f32_16x16x32_bf16 v[92:95], v[172:175], v[180:183], v[92:95]
    v_mfma_f32_16x16x32_bf16 v[96:99], v[160:163], v[184:187], v[96:99]
    v_mfma_f32_16x16x32_bf16 v[100:103], v[164:167], v[184:187], v[100:103]
    v_mfma_f32_16x16x32_bf16 v[104:107], v[168:171], v[184:187], v[104:107]
    v_mfma_f32_16x16x32_bf16 v[108:111], v[172:175], v[184:187], v[108:111]
    v_mfma_f32_16x16x32_bf16 v[112:115], v[160:163], v[188:191], v[112:115]
    v_mfma_f32_16x16x32_bf16 v[116:119], v[164:167], v[188:191], v[116:119]
    v_mfma_f32_16x16x32_bf16 v[120:123], v[168:171], v[188:191], v[120:123]
    v_mfma_f32_16x16x32_bf16 v[124:127], v[172:175], v[188:191], v[124:127]
    s_waitcnt lgkmcnt(0)
    v_mfma_f32_16x16x16_bf16 v[64:67], v[192:193], v[32:33], v[64:67]
    v_mfma_f32_16x16x16_bf16 v[68:71], v[194:195], v[32:33], v[68:71]
    v_mfma_f32_16x16x16_bf16 v[72:75], v[196:197], v[32:33], v[72:75]
    v_mfma_f32_16x16x16_bf16 v[76:79], v[198:199], v[32:33], v[76:79]
    v_mfma_f32_16x16x16_bf16 v[80:83], v[192:193], v[34:35], v[80:83]
    v_mfma_f32_16x16x16_bf16 v[84:87], v[194:195], v[34:35], v[84:87]
    v_mfma_f32_16x16x16_bf16 v[88:91], v[196:197], v[34:35], v[88:91]
    v_mfma_f32_16x16x16_bf16 v[92:95], v[198:199], v[34:35], v[92:95]
    s_nop 1
    v_pk_mul_f32 v[64:65], v[64:65], v[40:41]
    v_pk_mul_f32 v[66:67], v[66:67], v[42:43]
    v_cvt_pk_bf16_f32 v128, v64, v65
    v_cvt_pk_bf16_f32 v129, v66, v67
    v_pk_mul_f32 v[68:69], v[68:69], v[44:45]
    v_pk_mul_f32 v[70:71], v[70:71], v[46:47]
    v_cvt_pk_bf16_f32 v130, v68, v69
    v_cvt_pk_bf16_f32 v131, v70, v71
    s_nop 0
    v_permlane16_swap_b32 v128, v130
    v_permlane16_swap_b32 v129, v131
    buffer_store_dwordx4 v[128:131], v26, s[20:23], s36 offen offset:0 sc1
    v_pk_mul_f32 v[72:73], v[72:73], v[48:49]
    v_pk_mul_f32 v[74:75], v[74:75], v[50:51]
    v_cvt_pk_bf16_f32 v132, v72, v73
    v_cvt_pk_bf16_f32 v133, v74, v75
    v_pk_mul_f32 v[76:77], v[76:77], v[52:53]
    v_pk_mul_f32 v[78:79], v[78:79], v[54:55]
    v_cvt_pk_bf16_f32 v134, v76, v77
    v_cvt_pk_bf16_f32 v135, v78, v79
    s_nop 0
    v_permlane16_swap_b32 v132, v134
    v_permlane16_swap_b32 v133, v135
    buffer_store_dwordx4 v[132:135], v26, s[20:23], s36 offen offset:1280 sc1
    v_mfma_f32_16x16x16_bf16 v[96:99], v[192:193], v[36:37], v[96:99]
    v_mfma_f32_16x16x16_bf16 v[100:103], v[194:195], v[36:37], v[100:103]
    v_mfma_f32_16x16x16_bf16 v[104:107], v[196:197], v[36:37], v[104:107]
    v_mfma_f32_16x16x16_bf16 v[108:111], v[198:199], v[36:37], v[108:111]
    v_pk_mul_f32 v[80:81], v[80:81], v[40:41]
    v_pk_mul_f32 v[82:83], v[82:83], v[42:43]
    v_cvt_pk_bf16_f32 v136, v80, v81
    v_cvt_pk_bf16_f32 v137, v82, v83
    v_pk_mul_f32 v[84:85], v[84:85], v[44:45]
    v_pk_mul_f32 v[86:87], v[86:87], v[46:47]
    v_cvt_pk_bf16_f32 v138, v84, v85
    v_cvt_pk_bf16_f32 v139, v86, v87
    s_nop 0
    v_permlane16_swap_b32 v136, v138
    v_permlane16_swap_b32 v137, v139
    buffer_store_dwordx4 v[136:139], v27, s[20:23], s36 offen offset:0 sc1
    v_pk_mul_f32 v[88:89], v[88:89], v[48:49]
    v_pk_mul_f32 v[90:91], v[90:91], v[50:51]
    v_cvt_pk_bf16_f32 v140, v88, v89
    v_cvt_pk_bf16_f32 v141, v90, v91
    v_pk_mul_f32 v[92:93], v[92:93], v[52:53]
    v_pk_mul_f32 v[94:95], v[94:95], v[54:55]
    v_cvt_pk_bf16_f32 v142, v92, v93
    v_cvt_pk_bf16_f32 v143, v94, v95
    s_nop 0
    v_permlane16_swap_b32 v140, v142
    v_permlane16_swap_b32 v141, v143
    buffer_store_dwordx4 v[140:143], v27, s[20:23], s36 offen offset:1280 sc1
    v_mfma_f32_16x16x16_bf16 v[112:115], v[192:193], v[38:39], v[112:115]
    v_mfma_f32_16x16x16_bf16 v[116:119], v[194:195], v[38:39], v[116:119]
    v_mfma_f32_16x16x16_bf16 v[120:123], v[196:197], v[38:39], v[120:123]
    v_mfma_f32_16x16x16_bf16 v[124:127], v[198:199], v[38:39], v[124:127]
    v_pk_mul_f32 v[96:97], v[96:97], v[40:41]
    v_pk_mul_f32 v[98:99], v[98:99], v[42:43]
    v_cvt_pk_bf16_f32 v128, v96, v97
    v_cvt_pk_bf16_f32 v129, v98, v99
    v_pk_mul_f32 v[100:101], v[100:101], v[44:45]
    v_pk_mul_f32 v[102:103], v[102:103], v[46:47]
    v_cvt_pk_bf16_f32 v130, v100, v101
    v_cvt_pk_bf16_f32 v131, v102, v103
    s_nop 0
    v_permlane16_swap_b32 v128, v130
    v_permlane16_swap_b32 v129, v131
    buffer_store_dwordx4 v[128:131], v28, s[20:23], s36 offen offset:0 sc1
    v_pk_mul_f32 v[104:105], v[104:105], v[48:49]
    v_pk_mul_f32 v[106:107], v[106:107], v[50:51]
    v_cvt_pk_bf16_f32 v132, v104, v105
    v_cvt_pk_bf16_f32 v133, v106, v107
    v_pk_mul_f32 v[108:109], v[108:109], v[52:53]
    v_pk_mul_f32 v[110:111], v[110:111], v[54:55]
    v_cvt_pk_bf16_f32 v134, v108, v109
    v_cvt_pk_bf16_f32 v135, v110, v111
    s_nop 0
    v_permlane16_swap_b32 v132, v134
    v_permlane16_swap_b32 v133, v135
    buffer_store_dwordx4 v[132:135], v28, s[20:23], s36 offen offset:1280 sc1
    v_pk_mul_f32 v[112:113], v[112:113], v[40:41]
    v_pk_mul_f32 v[114:115], v[114:115], v[42:43]
    v_cvt_pk_bf16_f32 v136, v112, v113
    v_cvt_pk_bf16_f32 v137, v114, v115
    v_pk_mul_f32 v[116:117], v[116:117], v[44:45]
    v_pk_mul_f32 v[118:119], v[118:119], v[46:47]
    v_cvt_pk_bf16_f32 v138, v116, v117
    v_cvt_pk_bf16_f32 v139, v118, v119
    s_nop 0
    v_permlane16_swap_b32 v136, v138
    v_permlane16_swap_b32 v137, v139
    buffer_store_dwordx4 v[136:139], v29, s[20:23], s36 offen offset:0 sc1
    v_pk_mul_f32 v[120:121], v[120:121], v[48:49]
    v_pk_mul_f32 v[122:123], v[122:123], v[50:51]
    v_cvt_pk_bf16_f32 v140, v120, v121
    v_cvt_pk_bf16_f32 v141, v122, v123
    v_pk_mul_f32 v[124:125], v[124:125], v[52:53]
    v_pk_mul_f32 v[126:127], v[126:127], v[54:55]
    v_cvt_pk_bf16_f32 v142, v124, v125
    v_cvt_pk_bf16_f32 v143, v126, v127
    s_nop 0
    v_permlane16_swap_b32 v140, v142
    v_permlane16_swap_b32 v141, v143
    buffer_store_dwordx4 v[140:143], v29, s[20:23], s36 offen offset:1280 sc1
Lc1e:
    s_nop 1
Lc2:
    s_and_b32 s33, s32, 3
    s_lshl_b32 s29, s31, 2
    s_add_u32 s29, s29, s33
    s_lshr_b32 s30, s32, 2
    s_and_b32 s33, s32, 1
    s_lshl_b32 s62, s31, 1
    s_add_u32 s62, s62, s33
    s_lshr_b32 s63, s32, 1
    v_and_b32 v4, 15, v0
    v_lshrrev_b32 v5, 4, v0
    v_mul_u32_u24 v252, 1280, v4
    v_lshl_add_u32 v253, v5, 3, v252
    v_lshl_add_u32 v252, v5, 5, v252
    v_lshlrev_b32 v230, 5, v5
    v_lshlrev_b32 v231, 3, v5
    s_lshl_b32 s33, s29, 2
    s_add_u32 s33, s33, s28
    s_mul_i32 s59, s33, 20480
    s_mul_i32 s38, s30, 160
    s_add_u32 s59, s59, s38
    s_mov_b32 s12, s64
    s_mov_b32 s13, s65
    s_mov_b32 s14, 2621440
    s_mov_b32 s15, 0x20000
    s_mov_b32 s16, s78
    s_mov_b32 s17, s79
    s_mov_b32 s18, 1280
    s_mov_b32 s19, 0x20000
    s_mov_b32 s42, s38
    s_mov_b32 s24, s82
    s_mov_b32 s25, s83
    s_mov_b32 s26, 256
    s_mov_b32 s27, 0x20000
    v_and_b32 v227, 31, v0
    v_lshlrev_b32 v227, 3, v227
    v_and_b32 v2, 31, v0
    v_lshrrev_b32 v1, 5, v0
    v_lshlrev_b32 v3, 4, v2
    v_lshl_add_u32 v37, v1, 11, v3
    v_lshlrev_b32 v38, 4, v0
    v_and_b32 v39, 28, v0
    v_lshl_add_u32 v39, v39, 4, v3
    v_lshl_add_u32 v39, v1, 6, v39
    s_mul_i32 s33, s29, 163840
    s_lshl_b32 s34, s30, 1
    s_lshr_b32 s35, s28, 1
    s_add_u32 s34, s34, s35
    s_mul_i32 s34, s34, 10240
    s_add_u32 s34, s34, s33
    s_and_b32 s35, s28, 1
    s_lshl_b32 s36, s35, 10
    s_add_u32 s36, s36, s34
    s_lshl_b32 s37, s35, 9
    s_add_u32 s37, s37, s34
    s_add_u32 s37, s37, 4096
    s_xor_b32 s38, s35, 1
    s_lshl_b32 s39, s38, 9
    s_add_u32 s39, s39, s34
    s_add_u32 s39, s39, 4096
    s_lshl_b32 s38, s38, 10
    s_add_u32 s38, s38, s34
    s_mul_i32 s61, s35, 10240
    s_lshl_b32 s33, s28, 13
    s_add_u32 s33, s33, 102400
    v_add_u32 v228, s33, v38
    v_xor_b32 v229, 8192, v228
    v_mov_b32 v36, 0xdddddddd
    s_mov_b32 s40, 0xfffff
    s_mov_b32 s41, 0xfffff
    v_mov_b32 v40, 0
    v_mov_b32 v41, 0
    v_mov_b32 v42, 0
    v_mov_b32 v43, 0
    v_mov_b32 v44, 0
    v_mov_b32 v45, 0
    v_mov_b32 v46, 0
    v_mov_b32 v47, 0
    v_mov_b32 v48, 0
    v_mov_b32 v49, 0
    v_mov_b32 v50, 0
    v_mov_b32 v51, 0
    v_mov_b32 v52, 0
    v_mov_b32 v53, 0
    v_mov_b32 v54, 0
    v_mov_b32 v55, 0
    v_mov_b32 v56, 0
    v_mov_b32 v57, 0
    v_mov_b32 v58, 0
    v_mov_b32 v59, 0
    v_mov_b32 v60, 0
    v_mov_b32 v61, 0
    v_mov_b32 v62, 0
    v_mov_b32 v63, 0
    v_mov_b32 v64, 0
    v_mov_b32 v65, 0
    v_mov_b32 v66, 0
    v_mov_b32 v67, 0
    v_mov_b32 v68, 0
    v_mov_b32 v69, 0
    v_mov_b32 v70, 0
    v_mov_b32 v71, 0
    v_mov_b32 v72, 0
    v_mov_b32 v73, 0
    v_mov_b32 v74, 0
    v_mov_b32 v75, 0
    v_mov_b32 v76, 0
    v_mov_b32 v77, 0
    v_mov_b32 v78, 0
    v_mov_b32 v79, 0
    v_mov_b32 v80, 0
    v_mov_b32 v81, 0
    v_mov_b32 v82, 0
    v_mov_b32 v83, 0
    v_mov_b32 v84, 0
    v_mov_b32 v85, 0
    v_mov_b32 v86, 0
    v_mov_b32 v87, 0
    v_mov_b32 v88, 0
    v_mov_b32 v89, 0
    v_mov_b32 v90, 0
    v_mov_b32 v91, 0
    v_mov_b32 v92, 0
    v_mov_b32 v93, 0
    v_mov_b32 v94, 0
    v_mov_b32 v95, 0
    v_mov_b32 v96, 0
    v_mov_b32 v97, 0
    v_mov_b32 v98, 0
    v_mov_b32 v99, 0
    v_mov_b32 v100, 0
    v_mov_b32 v101, 0
    v_mov_b32 v102, 0
    v_mov_b32 v103, 0
    v_mov_b32 v152, 0
    v_mov_b32 v153, 0
    v_mov_b32 v154, 0
    v_mov_b32 v155, 0
    v_mov_b32 v156, 0
    v_mov_b32 v157, 0
    v_mov_b32 v158, 0
    v_mov_b32 v159, 0
    v_mov_b32 v160, 0
    v_mov_b32 v161, 0
    v_mov_b32 v162, 0
    v_mov_b32 v163, 0
    v_mov_b32 v164, 0
    v_mov_b32 v165, 0
    v_mov_b32 v166, 0
    v_mov_b32 v167, 0
    s_waitcnt vmcnt(0)
    s_atomic_swap s100, s[84:85], s58
    s_barrier
    v_and_b32 v224, 27, v0
    v_cmp_eq_u32 vcc, 24, v224
    v_mov_b32 v224, 0x3f803f80
    s_mov_b32 s43, 4
    v_cndmask_b32 v192, v40, v224, vcc
    v_mov_b32 v193, v192
    v_mov_b32 v194, v192
    v_mov_b32 v195, v192
    v_mov_b32 v196, v192
    v_mov_b32 v197, v192
    v_mov_b32 v198, v192
    v_mov_b32 v199, v192
    v_mov_b32 v200, v192
    v_mov_b32 v201, v192
    v_mov_b32 v202, v192
    v_mov_b32 v203, v192
    v_mov_b32 v204, v192
    v_mov_b32 v205, v192
    v_mov_b32 v206, v192
    v_mov_b32 v207, v192
    v_mov_b32 v208, v192
    v_mov_b32 v209, v192
    v_mov_b32 v210, v192
    v_mov_b32 v211, v192
    v_mov_b32 v212, v192
    v_mov_b32 v213, v192
    v_mov_b32 v214, v192
    v_mov_b32 v215, v192
    v_mov_b32 v216, v192
    v_mov_b32 v217, v192
    v_mov_b32 v218, v192
    v_mov_b32 v219, v192
    v_mov_b32 v220, v192
    v_mov_b32 v221, v192
    v_mov_b32 v222, v192
    v_mov_b32 v223, v192
    s_mov_b64 s[46:47], -1
    v_and_b32 v224, 31, v0
    v_lshrrev_b32 v225, 4, v224
    v_mul_u32_u24 v225, 20480, v225
    v_and_b32 v224, 15, v224
    v_lshl_add_u32 v136, v224, 4, v225
    v_lshl_add_u32 v224, v224, 3, v225
    v_lshl_add_u32 v225, v1, 8, v136
    s_lshl_b32 s33, s30, 4
    s_lshl_b32 s44, s28, 2
    s_add_u32 s33, s33, s44
    s_mul_i32 s33, s33, 20480
    s_add_u32 s33, s33, 10485760
    s_lshl_b32 s44, s29, 9
    s_add_u32 s44, s44, s33
    s_lshr_b32 s45, s29, 3
    s_lshl_b32 s45, s45, 10
    s_and_b32 s56, s29, 2
    s_lshl_b32 s56, s56, 8
    s_add_u32 s45, s45, s56
    s_and_b32 s56, s29, 4
    s_lshl_b32 s56, s56, 6
    s_add_u32 s45, s45, s56
    s_and_b32 s56, s29, 1
    s_lshl_b32 s56, s56, 7
    s_add_u32 s45, s45, s56
    s_add_u32 s45, s45, s33
    s_add_u32 s45, s45, 16384
    s_add_u32 s48, s44, 40960
    s_add_u32 s49, s45, 40960
    s_lshl_b32 s58, s30, 2
    s_add_u32 s58, s58, s28
    s_lshl_b32 s58, s58, 2
    s_lshr_b32 s56, s29, 3
    s_add_u32 s58, s58, s56
    s_mul_i32 s58, s58, 32
    s_and_b32 s56, s29, 7
    s_add_u32 s58, s58, s56
    s_lshl_b32 s58, s58, 2
    s_add_u32 s58, s58, 28729344
    v_cmp_gt_u32 vcc, 32, v0
    s_mul_i32 s33, s29, 20
    s_add_u32 s34, s33, 19
    s_lshr_b32 s33, s33, 6
    s_lshr_b32 s34, s34, 6
    s_sub_u32 s34, s34, s33
    s_lshl_b32 s34, s34, 12
    s_lshl_b32 s33, s33, 3
    s_add_u32 s33, s33, s30
    s_lshl_b32 s33, s33, 2
    s_and_b32 s56, s28, 2
    s_add_u32 s33, s33, s56
    s_lshl_b32 s33, s33, 7
    s_add_u32 s33, s33, 28598272
    v_lshrrev_b32 v136, 1, v0
    v_mul_u32_u24 v136, s34, v136
    v_and_b32 v137, 1, v0
    v_lshl_add_u32 v136, v137, 7, v136
    v_add_u32 v136, s33, v136
    s_mov_b32 s60, 200000
    s_mov_b32 exec_lo, 0xf
    s_mov_b32 exec_hi, 0x0
Up21:
    s_sleep 2
    buffer_load_dword v4, v136, s[20:23], 0 offen sc1
    s_sub_u32 s60, s60, 1
    s_cbranch_scc1 Ue22
    s_waitcnt vmcnt(0)
    v_xor_b32 v4, s100, v4
    v_cmp_ne_u32 vcc, 0, v4
    s_nop 1
    s_cmp_lg_u64 vcc, 0
    s_cbranch_scc1 Up21
Ue22:
    s_waitcnt vmcnt(0)
    s_mov_b64 exec, -1
    v_cmp_gt_u32 vcc, 32, v0
    buffer_load_dwordx4 v[4:7], v37, s[20:23], s38 offen offset:0 sc1
    buffer_load_dwordx4 v[8:11], v37, s[20:23], s38 offen offset:512 sc1
    buffer_load_dwordx4 v[12:15], v37, s[20:23], s36 offen offset:0 sc1
    buffer_load_dwordx4 v[16:19], v37, s[20:23], s36 offen offset:512 sc1
    buffer_load_dwordx4 v[20:23], v3, s[20:23], s39 offen sc1
    buffer_load_dwordx4 v[24:27], v3, s[20:23], s37 offen sc1
    v_add_u32 v37, s61, v37
    v_add_u32 v38, s61, v38
    v_add_u32 v39, s61, v39
    s_waitcnt vmcnt(0)
    v_cndmask_b32 v28, v20, v40, vcc
    v_cndmask_b32 v20, v40, v20, vcc
    v_cndmask_b32 v29, v21, v40, vcc
    v_cndmask_b32 v21, v40, v21, vcc
    v_cndmask_b32 v30, v22, v40, vcc
    v_cndmask_b32 v22, v40, v22, vcc
    v_cndmask_b32 v31, v23, v40, vcc
    v_cndmask_b32 v23, v40, v23, vcc
    v_cndmask_b32 v32, v24, v40, vcc
    v_cndmask_b32 v24, v40, v24, vcc
    v_cndmask_b32 v33, v25, v40, vcc
    v_cndmask_b32 v25, v40, v25, vcc
    v_cndmask_b32 v34, v26, v40, vcc
    v_cndmask_b32 v26, v40, v26, vcc
    v_cndmask_b32 v35, v27, v40, vcc
    v_cndmask_b32 v27, v40, v27, vcc
    s_barrier
    ds_read_b128 v[168:171], v37 offset:0
    ds_read_b128 v[184:187], v38 offset:4096
    ds_read_b128 v[172:175], v37 offset:512
    s_mov_b64 exec, s[40:41]
    ds_read_b128 v[192:195], v39 offset:5120
    ds_read_b128 v[196:199], v39 offset:5760
    ds_read_b128 v[200:203], v39 offset:6400
    ds_read_b128 v[204:207], v39 offset:7040
    s_mov_b64 exec, -1
    s_waitcnt lgkmcnt(4)
    v_mfma_f32_32x32x16_bf16 v[104:119], v[168:171], v[4:7], 0
    v_mfma_f32_32x32x8_bf16 v[104:119], v[184:185], v[20:21], v[104:119]
    s_waitcnt lgkmcnt(0)
    s_nop 9
    s_cmp_lg_u32 s43, 1
.p2align 6
Lattn:
    v_mfma_f32_32x32x16_bf16 v[120:135], v[168:171], v[8:11], 0
    v_exp_f32 v104, v104
    v_exp_f32 v105, v105
    v_exp_f32 v106, v106
    v_exp_f32 v107, v107
    v_mfma_f32_32x32x8_bf16 v[120:135], v[184:185], v[22:23], v[120:135]
    v_exp_f32 v108, v108
    v_exp_f32 v109, v109
    v_exp_f32 v110, v110
    v_exp_f32 v111, v111
    v_smfmac_f32_32x32x32_bf16 v[88:103], v[216:219], v[152:159], v36
    v_exp_f32 v112, v112
    v_exp_f32 v113, v113
    v_exp_f32 v114, v114
    v_exp_f32 v115, v115
    v_smfmac_f32_32x32x32_bf16 v[88:103], v[220:223], v[160:167], v36
    v_exp_f32 v116, v116
    v_exp_f32 v117, v117
    v_exp_f32 v118, v118
    v_exp_f32 v119, v119
    v_mfma_f32_32x32x16_bf16 v[136:151], v[168:171], v[12:15], 0
    v_exp_f32 v120, v120
    v_exp_f32 v121, v121
    v_exp_f32 v122, v122
    v_exp_f32 v123, v123
    v_mfma_f32_32x32x8_bf16 v[136:151], v[184:185], v[24:25], v[136:151]
    v_exp_f32 v124, v124
    v_exp_f32 v125, v125
    v_exp_f32 v126, v126
    v_exp_f32 v127, v127
    v_smfmac_f32_32x32x32_bf16 v[40:55], v[192:195], v[104:111], v36
    v_exp_f32 v128, v128
    v_exp_f32 v129, v129
    v_exp_f32 v130, v130
    v_exp_f32 v131, v131
    v_smfmac_f32_32x32x32_bf16 v[40:55], v[196:199], v[112:119], v36
    v_exp_f32 v132, v132
    v_exp_f32 v133, v133
    v_exp_f32 v134, v134
    v_exp_f32 v135, v135
    v_mfma_f32_32x32x16_bf16 v[152:167], v[168:171], v[16:19], 0
    v_exp_f32 v136, v136
    v_exp_f32 v137, v137
    v_exp_f32 v138, v138
    v_exp_f32 v139, v139
    v_mfma_f32_32x32x8_bf16 v[152:167], v[184:185], v[26:27], v[152:167]
    v_exp_f32 v140, v140
    v_exp_f32 v141, v141
    v_exp_f32 v142, v142
    v_exp_f32 v143, v143
    v_smfmac_f32_32x32x32_bf16 v[56:71], v[192:195], v[120:127], v36
    v_exp_f32 v144, v144
    v_exp_f32 v145, v145
    v_exp_f32 v146, v146
    v_exp_f32 v147, v147
    v_smfmac_f32_32x32x32_bf16 v[56:71], v[196:199], v[128:135], v36
    v_exp_f32 v148, v148
    v_exp_f32 v149, v149
    v_exp_f32 v150, v150
    v_exp_f32 v151, v151
    s_cbranch_scc0 Lat_f
Lat_fr:
    v_mfma_f32_32x32x16_bf16 v[104:119], v[172:175], v[4:7], 0
    ds_read_b128 v[176:179], v37 offset:1024
    ds_read_b128 v[180:183], v37 offset:1536
    s_mov_b64 exec, s[40:41]
    ds_read_b128 v[208:211], v39 offset:7680
    ds_read_b128 v[212:215], v39 offset:8320
    ds_read_b128 v[216:219], v39 offset:8960
    ds_read_b128 v[220:223], v39 offset:9600
    s_mov_b64 exec, -1
    v_exp_f32 v152, v152
    v_exp_f32 v153, v153
    v_exp_f32 v154, v154
    v_exp_f32 v155, v155
    v_mfma_f32_32x32x8_bf16 v[104:119], v[186:187], v[20:21], v[104:119]
    v_exp_f32 v156, v156
    v_exp_f32 v157, v157
    v_exp_f32 v158, v158
    v_exp_f32 v159, v159
    v_smfmac_f32_32x32x32_bf16 v[72:87], v[192:195], v[136:143], v36
    v_exp_f32 v160, v160
    v_exp_f32 v161, v161
    v_exp_f32 v162, v162
    v_exp_f32 v163, v163
    v_smfmac_f32_32x32x32_bf16 v[72:87], v[196:199], v[144:151], v36
    v_exp_f32 v164, v164
    v_exp_f32 v165, v165
    v_exp_f32 v166, v166
    v_exp_f32 v167, v167
    v_mfma_f32_32x32x16_bf16 v[120:135], v[172:175], v[8:11], 0
    v_exp_f32 v104, v104
    v_exp_f32 v105, v105
    v_exp_f32 v106, v106
    v_exp_f32 v107, v107
    v_mfma_f32_32x32x8_bf16 v[120:135], v[186:187], v[22:23], v[120:135]
    v_exp_f32 v108, v108
    v_exp_f32 v109, v109
    v_exp_f32 v110, v110
    v_exp_f32 v111, v111
    v_smfmac_f32_32x32x32_bf16 v[88:103], v[192:195], v[152:159], v36
    v_exp_f32 v112, v112
    v_exp_f32 v113, v113
    v_exp_f32 v114, v114
    v_exp_f32 v115, v115
    v_smfmac_f32_32x32x32_bf16 v[88:103], v[196:199], v[160:167], v36
    v_exp_f32 v116, v116
    v_exp_f32 v117, v117
    v_exp_f32 v118, v118
    v_exp_f32 v119, v119
    v_mfma_f32_32x32x16_bf16 v[136:151], v[172:175], v[12:15], 0
    v_exp_f32 v120, v120
    v_exp_f32 v121, v121
    v_exp_f32 v122, v122
    v_exp_f32 v123, v123
    v_mfma_f32_32x32x8_bf16 v[136:151], v[186:187], v[24:25], v[136:151]
    v_exp_f32 v124, v124
    v_exp_f32 v125, v125
    v_exp_f32 v126, v126
    v_exp_f32 v127, v127
    v_smfmac_f32_32x32x32_bf16 v[40:55], v[200:203], v[104:111], v36
    v_exp_f32 v128, v128
    v_exp_f32 v129, v129
    v_exp_f32 v130, v130
    v_exp_f32 v131, v131
    v_smfmac_f32_32x32x32_bf16 v[40:55], v[204:207], v[112:119], v36
    v_exp_f32 v132, v132
    v_exp_f32 v133, v133
    v_exp_f32 v134, v134
    v_exp_f32 v135, v135
    v_mfma_f32_32x32x16_bf16 v[152:167], v[172:175], v[16:19], 0
    v_exp_f32 v136, v136
    v_exp_f32 v137, v137
    v_exp_f32 v138, v138
    v_exp_f32 v139, v139
    v_mfma_f32_32x32x8_bf16 v[152:167], v[186:187], v[26:27], v[152:167]
    v_exp_f32 v140, v140
    v_exp_f32 v141, v141
    v_exp_f32 v142, v142
    v_exp_f32 v143, v143
    v_smfmac_f32_32x32x32_bf16 v[56:71], v[200:203], v[120:127], v36
    v_exp_f32 v144, v144
    v_exp_f32 v145, v145
    v_exp_f32 v146, v146
    v_exp_f32 v147, v147
    v_smfmac_f32_32x32x32_bf16 v[56:71], v[204:207], v[128:135], v36
    v_exp_f32 v148, v148
    v_exp_f32 v149, v149
    v_exp_f32 v150, v150
    v_exp_f32 v151, v151
    s_waitcnt lgkmcnt(0)
    v_mfma_f32_32x32x16_bf16 v[104:119], v[176:179], v[4:7], 0
    v_exp_f32 v152, v152
    v_exp_f32 v153, v153
    v_exp_f32 v154, v154
    v_exp_f32 v155, v155
    v_mfma_f32_32x32x8_bf16 v[104:119], v[184:185], v[28:29], v[104:119]
    v_exp_f32 v156, v156
    v_exp_f32 v157, v157
    v_exp_f32 v158, v158
    v_exp_f32 v159, v159
    v_smfmac_f32_32x32x32_bf16 v[72:87], v[200:203], v[136:143], v36
    v_exp_f32 v160, v160
    v_exp_f32 v161, v161
    v_exp_f32 v162, v162
    v_exp_f32 v163, v163
    v_smfmac_f32_32x32x32_bf16 v[72:87], v[204:207], v[144:151], v36
    v_exp_f32 v164, v164
    v_exp_f32 v165, v165
    v_exp_f32 v166, v166
    v_exp_f32 v167, v167
    v_mfma_f32_32x32x16_bf16 v[120:135], v[176:179], v[8:11], 0
    v_exp_f32 v104, v104
    v_exp_f32 v105, v105
    v_exp_f32 v106, v106
    v_exp_f32 v107, v107
    v_mfma_f32_32x32x8_bf16 v[120:135], v[184:185], v[30:31], v[120:135]
    v_exp_f32 v108, v108
    v_exp_f32 v109, v109
    v_exp_f32 v110, v110
    v_exp_f32 v111, v111
    v_smfmac_f32_32x32x32_bf16 v[88:103], v[200:203], v[152:159], v36
    v_exp_f32 v112, v112
    v_exp_f32 v113, v113
    v_exp_f32 v114, v114
    v_exp_f32 v115, v115
    v_smfmac_f32_32x32x32_bf16 v[88:103], v[204:207], v[160:167], v36
    v_exp_f32 v116, v116
    v_exp_f32 v117, v117
    v_exp_f32 v118, v118
    v_exp_f32 v119, v119
    v_mfma_f32_32x32x16_bf16 v[136:151], v[176:179], v[12:15], 0
    v_exp_f32 v120, v120
    v_exp_f32 v121, v121
    v_exp_f32 v122, v122
    v_exp_f32 v123, v123
    v_mfma_f32_32x32x8_bf16 v[136:151], v[184:185], v[32:33], v[136:151]
    v_exp_f32 v124, v124
    v_exp_f32 v125, v125
    v_exp_f32 v126, v126
    v_exp_f32 v127, v127
    v_smfmac_f32_32x32x32_bf16 v[40:55], v[208:211], v[104:111], v36
    v_exp_f32 v128, v128
    v_exp_f32 v129, v129
    v_exp_f32 v130, v130
    v_exp_f32 v131, v131
    v_smfmac_f32_32x32x32_bf16 v[40:55], v[212:215], v[112:119], v36
    v_exp_f32 v132, v132
    v_exp_f32 v133, v133
    v_exp_f32 v134, v134
    v_exp_f32 v135, v135
    v_mfma_f32_32x32x16_bf16 v[152:167], v[176:179], v[16:19], 0
    v_exp_f32 v136, v136
    v_exp_f32 v137, v137
    v_exp_f32 v138, v138
    v_exp_f32 v139, v139
    v_mfma_f32_32x32x8_bf16 v[152:167], v[184:185], v[34:35], v[152:167]
    v_exp_f32 v140, v140
    v_exp_f32 v141, v141
    v_exp_f32 v142, v142
    v_exp_f32 v143, v143
    v_smfmac_f32_32x32x32_bf16 v[56:71], v[208:211], v[120:127], v36
    v_exp_f32 v144, v144
    v_exp_f32 v145, v145
    v_exp_f32 v146, v146
    v_exp_f32 v147, v147
    v_smfmac_f32_32x32x32_bf16 v[56:71], v[212:215], v[128:135], v36
    v_exp_f32 v148, v148
    v_exp_f32 v149, v149
    v_exp_f32 v150, v150
    v_exp_f32 v151, v151
    v_mfma_f32_32x32x16_bf16 v[104:119], v[180:183], v[4:7], 0
    ds_read_b128 v[168:171], v37 offset:20480
    ds_read_b128 v[188:191], v38 offset:24576
    ds_read_b128 v[172:175], v37 offset:20992
    s_mov_b64 exec, s[40:41]
    ds_read_b128 v[192:195], v39 offset:25600
    ds_read_b128 v[196:199], v39 offset:26240
    ds_read_b128 v[200:203], v39 offset:26880
    ds_read_b128 v[204:207], v39 offset:27520
    s_mov_b64 exec, -1
    v_exp_f32 v152, v152
    v_exp_f32 v153, v153
    v_exp_f32 v154, v154
    v_exp_f32 v155, v155
    v_mfma_f32_32x32x8_bf16 v[104:119], v[186:187], v[28:29], v[104:119]
    v_exp_f32 v156, v156
    v_exp_f32 v157, v157
    v_exp_f32 v158, v158
    v_exp_f32 v159, v159
    v_smfmac_f32_32x32x32_bf16 v[72:87], v[208:211], v[136:143], v36
    v_exp_f32 v160, v160
    v_exp_f32 v161, v161
    v_exp_f32 v162, v162
    v_exp_f32 v163, v163
    v_smfmac_f32_32x32x32_bf16 v[72:87], v[212:215], v[144:151], v36
    v_exp_f32 v164, v164
    v_exp_f32 v165, v165
    v_exp_f32 v166, v166
    v_exp_f32 v167, v167
    v_mfma_f32_32x32x16_bf16 v[120:135], v[180:183], v[8:11], 0
    v_exp_f32 v104, v104
    v_exp_f32 v105, v105
    v_exp_f32 v106, v106
    v_exp_f32 v107, v107
    v_mfma_f32_32x32x8_bf16 v[120:135], v[186:187], v[30:31], v[120:135]
    v_exp_f32 v108, v108
    v_exp_f32 v109, v109
    v_exp_f32 v110, v110
    v_exp_f32 v111, v111
    v_smfmac_f32_32x32x32_bf16 v[88:103], v[208:211], v[152:159], v36
    v_exp_f32 v112, v112
    v_exp_f32 v113, v113
    v_exp_f32 v114, v114
    v_exp_f32 v115, v115
    v_smfmac_f32_32x32x32_bf16 v[88:103], v[212:215], v[160:167], v36
    v_exp_f32 v116, v116
    v_exp_f32 v117, v117
    v_exp_f32 v118, v118
    v_exp_f32 v119, v119
    v_mfma_f32_32x32x16_bf16 v[136:151], v[180:183], v[12:15], 0
    v_exp_f32 v120, v120
    v_exp_f32 v121, v121
    v_exp_f32 v122, v122
    v_exp_f32 v123, v123
    v_mfma_f32_32x32x8_bf16 v[136:151], v[186:187], v[32:33], v[136:151]
    v_exp_f32 v124, v124
    v_exp_f32 v125, v125
    v_exp_f32 v126, v126
    v_exp_f32 v127, v127
    v_smfmac_f32_32x32x32_bf16 v[40:55], v[216:219], v[104:111], v36
    v_exp_f32 v128, v128
    v_exp_f32 v129, v129
    v_exp_f32 v130, v130
    v_exp_f32 v131, v131
    v_smfmac_f32_32x32x32_bf16 v[40:55], v[220:223], v[112:119], v36
    v_exp_f32 v132, v132
    v_exp_f32 v133, v133
    v_exp_f32 v134, v134
    v_exp_f32 v135, v135
    v_mfma_f32_32x32x16_bf16 v[152:167], v[180:183], v[16:19], 0
    v_exp_f32 v136, v136
    v_exp_f32 v137, v137
    v_exp_f32 v138, v138
    v_exp_f32 v139, v139
    v_mfma_f32_32x32x8_bf16 v[152:167], v[186:187], v[34:35], v[152:167]
    v_exp_f32 v140, v140
    v_exp_f32 v141, v141
    v_exp_f32 v142, v142
    v_exp_f32 v143, v143
    v_smfmac_f32_32x32x32_bf16 v[56:71], v[216:219], v[120:127], v36
    v_exp_f32 v144, v144
    v_exp_f32 v145, v145
    v_exp_f32 v146, v146
    v_exp_f32 v147, v147
    v_smfmac_f32_32x32x32_bf16 v[56:71], v[220:223], v[128:135], v36
    v_exp_f32 v148, v148
    v_exp_f32 v149, v149
    v_exp_f32 v150, v150
    v_exp_f32 v151, v151
    s_waitcnt lgkmcnt(0)
    v_mfma_f32_32x32x16_bf16 v[104:119], v[168:171], v[4:7], 0
    v_exp_f32 v152, v152
    v_exp_f32 v153, v153
    v_exp_f32 v154, v154
    v_exp_f32 v155, v155
    v_mfma_f32_32x32x8_bf16 v[104:119], v[188:189], v[20:21], v[104:119]
    v_exp_f32 v156, v156
    v_exp_f32 v157, v157
    v_exp_f32 v158, v158
    v_exp_f32 v159, v159
    v_smfmac_f32_32x32x32_bf16 v[72:87], v[216:219], v[136:143], v36
    v_exp_f32 v160, v160
    v_exp_f32 v161, v161
    v_exp_f32 v162, v162
    v_exp_f32 v163, v163
    v_smfmac_f32_32x32x32_bf16 v[72:87], v[220:223], v[144:151], v36
    v_exp_f32 v164, v164
    v_exp_f32 v165, v165
    v_exp_f32 v166, v166
    v_exp_f32 v167, v167
    v_mfma_f32_32x32x16_bf16 v[120:135], v[168:171], v[8:11], 0
    v_exp_f32 v104, v104
    v_exp_f32 v105, v105
    v_exp_f32 v106, v106
    v_exp_f32 v107, v107
    v_mfma_f32_32x32x8_bf16 v[120:135], v[188:189], v[22:23], v[120:135]
    v_exp_f32 v108, v108
    v_exp_f32 v109, v109
    v_exp_f32 v110, v110
    v_exp_f32 v111, v111
    v_smfmac_f32_32x32x32_bf16 v[88:103], v[216:219], v[152:159], v36
    v_exp_f32 v112, v112
    v_exp_f32 v113, v113
    v_exp_f32 v114, v114
    v_exp_f32 v115, v115
    v_smfmac_f32_32x32x32_bf16 v[88:103], v[220:223], v[160:167], v36
    v_exp_f32 v116, v116
    v_exp_f32 v117, v117
    v_exp_f32 v118, v118
    v_exp_f32 v119, v119
    v_mfma_f32_32x32x16_bf16 v[136:151], v[168:171], v[12:15], 0
    v_exp_f32 v120, v120
    v_exp_f32 v121, v121
    v_exp_f32 v122, v122
    v_exp_f32 v123, v123
    v_mfma_f32_32x32x8_bf16 v[136:151], v[188:189], v[24:25], v[136:151]
    v_exp_f32 v124, v124
    v_exp_f32 v125, v125
    v_exp_f32 v126, v126
    v_exp_f32 v127, v127
    v_smfmac_f32_32x32x32_bf16 v[40:55], v[192:195], v[104:111], v36
    v_exp_f32 v128, v128
    v_exp_f32 v129, v129
    v_exp_f32 v130, v130
    v_exp_f32 v131, v131
    v_smfmac_f32_32x32x32_bf16 v[40:55], v[196:199], v[112:119], v36
    v_exp_f32 v132, v132
    v_exp_f32 v133, v133
    v_exp_f32 v134, v134
    v_exp_f32 v135, v135
    v_mfma_f32_32x32x16_bf16 v[152:167], v[168:171], v[16:19], 0
    v_exp_f32 v136, v136
    v_exp_f32 v137, v137
    v_exp_f32 v138, v138
    v_exp_f32 v139, v139
    v_mfma_f32_32x32x8_bf16 v[152:167], v[188:189], v[26:27], v[152:167]
    v_exp_f32 v140, v140
    v_exp_f32 v141, v141
    v_exp_f32 v142, v142
    v_exp_f32 v143, v143
    v_smfmac_f32_32x32x32_bf16 v[56:71], v[192:195], v[120:127], v36
    v_exp_f32 v144, v144
    v_exp_f32 v145, v145
    v_exp_f32 v146, v146
    v_exp_f32 v147, v147
    v_smfmac_f32_32x32x32_bf16 v[56:71], v[196:199], v[128:135], v36
    v_exp_f32 v148, v148
    v_exp_f32 v149, v149
    v_exp_f32 v150, v150
    v_exp_f32 v151, v151
    v_mfma_f32_32x32x16_bf16 v[104:119], v[172:175], v[4:7], 0
    ds_read_b128 v[176:179], v37 offset:21504
    ds_read_b128 v[180:183], v37 offset:22016
    s_mov_b64 exec, s[40:41]
    ds_read_b128 v[208:211], v39 offset:28160
    ds_read_b128 v[212:215], v39 offset:28800
    ds_read_b128 v[216:219], v39 offset:29440
    ds_read_b128 v[220:223], v39 offset:30080
    s_mov_b64 exec, -1
    v_exp_f32 v152, v152
    v_exp_f32 v153, v153
    v_exp_f32 v154, v154
    v_exp_f32 v155, v155
    v_mfma_f32_32x32x8_bf16 v[104:119], v[190:191], v[20:21], v[104:119]
    v_exp_f32 v156, v156
    v_exp_f32 v157, v157
    v_exp_f32 v158, v158
    v_exp_f32 v159, v159
    v_smfmac_f32_32x32x32_bf16 v[72:87], v[192:195], v[136:143], v36
    v_exp_f32 v160, v160
    v_exp_f32 v161, v161
    v_exp_f32 v162, v162
    v_exp_f32 v163, v163
    v_smfmac_f32_32x32x32_bf16 v[72:87], v[196:199], v[144:151], v36
    v_exp_f32 v164, v164
    v_exp_f32 v165, v165
    v_exp_f32 v166, v166
    v_exp_f32 v167, v167
    v_mfma_f32_32x32x16_bf16 v[120:135], v[172:175], v[8:11], 0
    v_exp_f32 v104, v104
    v_exp_f32 v105, v105
    v_exp_f32 v106, v106
    v_exp_f32 v107, v107
    v_mfma_f32_32x32x8_bf16 v[120:135], v[190:191], v[22:23], v[120:135]
    v_exp_f32 v108, v108
    v_exp_f32 v109, v109
    v_exp_f32 v110, v110
    v_exp_f32 v111, v111
    v_smfmac_f32_32x32x32_bf16 v[88:103], v[192:195], v[152:159], v36
    v_exp_f32 v112, v112
    v_exp_f32 v113, v113
    v_exp_f32 v114, v114
    v_exp_f32 v115, v115
    v_smfmac_f32_32x32x32_bf16 v[88:103], v[196:199], v[160:167], v36
    v_exp_f32 v116, v116
    v_exp_f32 v117, v117
    v_exp_f32 v118, v118
    v_exp_f32 v119, v119
    v_mfma_f32_32x32x16_bf16 v[136:151], v[172:175], v[12:15], 0
    v_exp_f32 v120, v120
    v_exp_f32 v121, v121
    v_exp_f32 v122, v122
    v_exp_f32 v123, v123
    v_mfma_f32_32x32x8_bf16 v[136:151], v[190:191], v[24:25], v[136:151]
    v_exp_f32 v124, v124
    v_exp_f32 v125, v125
    v_exp_f32 v126, v126
    v_exp_f32 v127, v127
    v_smfmac_f32_32x32x32_bf16 v[40:55], v[200:203], v[104:111], v36
    v_exp_f32 v128, v128
    v_exp_f32 v129, v129
    v_exp_f32 v130, v130
    v_exp_f32 v131, v131
    v_smfmac_f32_32x32x32_bf16 v[40:55], v[204:207], v[112:119], v36
    v_exp_f32 v132, v132
    v_exp_f32 v133, v133
    v_exp_f32 v134, v134
    v_exp_f32 v135, v135
    s_cbranch_scc0 Lat_x
    v_mfma_f32_32x32x16_bf16 v[152:167], v[172:175], v[16:19], 0
    v_exp_f32 v136, v136
    v_exp_f32 v137, v137
    v_exp_f32 v138, v138
    v_exp_f32 v139, v139
    v_mfma_f32_32x32x8_bf16 v[152:167], v[190:191], v[26:27], v[152:167]
    v_exp_f32 v140, v140
    v_exp_f32 v141, v141
    v_exp_f32 v142, v142
    v_exp_f32 v143, v143
    v_smfmac_f32_32x32x32_bf16 v[56:71], v[200:203], v[120:127], v36
    v_exp_f32 v144, v144
    v_exp_f32 v145, v145
    v_exp_f32 v146, v146
    v_exp_f32 v147, v147
    v_smfmac_f32_32x32x32_bf16 v[56:71], v[204:207], v[128:135], v36
    v_exp_f32 v148, v148
    v_exp_f32 v149, v149
    v_exp_f32 v150, v150
    v_exp_f32 v151, v151
    s_waitcnt lgkmcnt(0)
    v_mfma_f32_32x32x16_bf16 v[104:119], v[176:179], v[4:7], 0
    v_exp_f32 v152, v152
    v_exp_f32 v153, v153
    v_exp_f32 v154, v154
    v_exp_f32 v155, v155
    v_mfma_f32_32x32x8_bf16 v[104:119], v[188:189], v[28:29], v[104:119]
    v_exp_f32 v156, v156
    v_exp_f32 v157, v157
    v_exp_f32 v158, v158
    v_exp_f32 v159, v159
    v_smfmac_f32_32x32x32_bf16 v[72:87], v[200:203], v[136:143], v36
    v_exp_f32 v160, v160
    v_exp_f32 v161, v161
    v_exp_f32 v162, v162
    v_exp_f32 v163, v163
    v_smfmac_f32_32x32x32_bf16 v[72:87], v[204:207], v[144:151], v36
    v_exp_f32 v164, v164
    v_exp_f32 v165, v165
    v_exp_f32 v166, v166
    v_exp_f32 v167, v167
    v_mfma_f32_32x32x16_bf16 v[120:135], v[176:179], v[8:11], 0
    v_exp_f32 v104, v104
    v_exp_f32 v105, v105
    v_exp_f32 v106, v106
    v_exp_f32 v107, v107
    v_mfma_f32_32x32x8_bf16 v[120:135], v[188:189], v[30:31], v[120:135]
    v_exp_f32 v108, v108
    v_exp_f32 v109, v109
    v_exp_f32 v110, v110
    v_exp_f32 v111, v111
    v_smfmac_f32_32x32x32_bf16 v[88:103], v[200:203], v[152:159], v36
    v_exp_f32 v112, v112
    v_exp_f32 v113, v113
    v_exp_f32 v114, v114
    v_exp_f32 v115, v115
    v_smfmac_f32_32x32x32_bf16 v[88:103], v[204:207], v[160:167], v36
    v_exp_f32 v116, v116
    v_exp_f32 v117, v117
    v_exp_f32 v118, v118
    v_exp_f32 v119, v119
    v_mfma_f32_32x32x16_bf16 v[136:151], v[176:179], v[12:15], 0
    v_exp_f32 v120, v120
    v_exp_f32 v121, v121
    v_exp_f32 v122, v122
    v_exp_f32 v123, v123
    v_mfma_f32_32x32x8_bf16 v[136:151], v[188:189], v[32:33], v[136:151]
    v_exp_f32 v124, v124
    v_exp_f32 v125, v125
    v_exp_f32 v126, v126
    v_exp_f32 v127, v127
    v_smfmac_f32_32x32x32_bf16 v[40:55], v[208:211], v[104:111], v36
    v_exp_f32 v128, v128
    v_exp_f32 v129, v129
    v_exp_f32 v130, v130
    v_exp_f32 v131, v131
    v_smfmac_f32_32x32x32_bf16 v[40:55], v[212:215], v[112:119], v36
    v_exp_f32 v132, v132
    v_exp_f32 v133, v133
    v_exp_f32 v134, v134
    v_exp_f32 v135, v135
    v_mfma_f32_32x32x16_bf16 v[152:167], v[176:179], v[16:19], 0
    v_exp_f32 v136, v136
    v_exp_f32 v137, v137
    v_exp_f32 v138, v138
    v_exp_f32 v139, v139
    v_mfma_f32_32x32x8_bf16 v[152:167], v[188:189], v[34:35], v[152:167]
    v_exp_f32 v140, v140
    v_exp_f32 v141, v141
    v_exp_f32 v142, v142
    v_exp_f32 v143, v143
    v_smfmac_f32_32x32x32_bf16 v[56:71], v[208:211], v[120:127], v36
    v_exp_f32 v144, v144
    v_exp_f32 v145, v145
    v_exp_f32 v146, v146
    v_exp_f32 v147, v147
    v_smfmac_f32_32x32x32_bf16 v[56:71], v[212:215], v[128:135], v36
    v_exp_f32 v148, v148
    v_exp_f32 v149, v149
    v_exp_f32 v150, v150
    v_exp_f32 v151, v151
    s_cbranch_vccnz Lat_c
Lat_cr:
    v_mfma_f32_32x32x16_bf16 v[104:119], v[180:183], v[4:7], 0
    ds_read_b128 v[168:171], v37 offset:40960
    ds_read_b128 v[184:187], v38 offset:45056
    ds_read_b128 v[172:175], v37 offset:41472
    s_mov_b64 exec, s[40:41]
    ds_read_b128 v[192:195], v39 offset:46080
    ds_read_b128 v[196:199], v39 offset:46720
    ds_read_b128 v[200:203], v39 offset:47360
    ds_read_b128 v[204:207], v39 offset:48000
    s_mov_b64 exec, -1
    v_exp_f32 v152, v152
    v_exp_f32 v153, v153
    v_exp_f32 v154, v154
    v_exp_f32 v155, v155
    v_mfma_f32_32x32x8_bf16 v[104:119], v[190:191], v[28:29], v[104:119]
    v_exp_f32 v156, v156
    v_exp_f32 v157, v157
    v_exp_f32 v158, v158
    v_exp_f32 v159, v159
    v_smfmac_f32_32x32x32_bf16 v[72:87], v[208:211], v[136:143], v36
    v_exp_f32 v160, v160
    v_exp_f32 v161, v161
    v_exp_f32 v162, v162
    v_exp_f32 v163, v163
    v_smfmac_f32_32x32x32_bf16 v[72:87], v[212:215], v[144:151], v36
    v_exp_f32 v164, v164
    v_exp_f32 v165, v165
    v_exp_f32 v166, v166
    v_exp_f32 v167, v167
    v_mfma_f32_32x32x16_bf16 v[120:135], v[180:183], v[8:11], 0
    v_exp_f32 v104, v104
    v_exp_f32 v105, v105
    v_exp_f32 v106, v106
    v_exp_f32 v107, v107
    v_mfma_f32_32x32x8_bf16 v[120:135], v[190:191], v[30:31], v[120:135]
    v_exp_f32 v108, v108
    v_exp_f32 v109, v109
    v_exp_f32 v110, v110
    v_exp_f32 v111, v111
    v_smfmac_f32_32x32x32_bf16 v[88:103], v[208:211], v[152:159], v36
    v_exp_f32 v112, v112
    v_exp_f32 v113, v113
    v_exp_f32 v114, v114
    v_exp_f32 v115, v115
    v_smfmac_f32_32x32x32_bf16 v[88:103], v[212:215], v[160:167], v36
    v_exp_f32 v116, v116
    v_exp_f32 v117, v117
    v_exp_f32 v118, v118
    v_exp_f32 v119, v119
    v_mfma_f32_32x32x16_bf16 v[136:151], v[180:183], v[12:15], 0
    v_exp_f32 v120, v120
    v_exp_f32 v121, v121
    v_exp_f32 v122, v122
    v_exp_f32 v123, v123
    v_mfma_f32_32x32x8_bf16 v[136:151], v[190:191], v[32:33], v[136:151]
    v_exp_f32 v124, v124
    v_exp_f32 v125, v125
    v_exp_f32 v126, v126
    v_exp_f32 v127, v127
    v_smfmac_f32_32x32x32_bf16 v[40:55], v[216:219], v[104:111], v36
    v_exp_f32 v128, v128
    v_exp_f32 v129, v129
    v_exp_f32 v130, v130
    v_exp_f32 v131, v131
    v_smfmac_f32_32x32x32_bf16 v[40:55], v[220:223], v[112:119], v36
    v_exp_f32 v132, v132
    v_exp_f32 v133, v133
    v_exp_f32 v134, v134
    v_exp_f32 v135, v135
    v_mfma_f32_32x32x16_bf16 v[152:167], v[180:183], v[16:19], 0
    v_exp_f32 v136, v136
    v_exp_f32 v137, v137
    v_exp_f32 v138, v138
    v_exp_f32 v139, v139
    v_mfma_f32_32x32x8_bf16 v[152:167], v[190:191], v[34:35], v[152:167]
    v_exp_f32 v140, v140
    v_exp_f32 v141, v141
    v_exp_f32 v142, v142
    v_exp_f32 v143, v143
    v_smfmac_f32_32x32x32_bf16 v[56:71], v[216:219], v[120:127], v36
    v_exp_f32 v144, v144
    v_exp_f32 v145, v145
    v_exp_f32 v146, v146
    v_exp_f32 v147, v147
    v_smfmac_f32_32x32x32_bf16 v[56:71], v[220:223], v[128:135], v36
    v_exp_f32 v148, v148
    v_exp_f32 v149, v149
    v_exp_f32 v150, v150
    v_exp_f32 v151, v151
    s_waitcnt lgkmcnt(0)
    v_mfma_f32_32x32x16_bf16 v[104:119], v[168:171], v[4:7], 0
    v_exp_f32 v152, v152
    v_exp_f32 v153, v153
    v_exp_f32 v154, v154
    v_exp_f32 v155, v155
    v_mfma_f32_32x32x8_bf16 v[104:119], v[184:185], v[20:21], v[104:119]
    v_exp_f32 v156, v156
    v_exp_f32 v157, v157
    v_exp_f32 v158, v158
    v_exp_f32 v159, v159
    v_smfmac_f32_32x32x32_bf16 v[72:87], v[216:219], v[136:143], v36
    v_exp_f32 v160, v160
    v_exp_f32 v161, v161
    v_exp_f32 v162, v162
    v_exp_f32 v163, v163
    v_smfmac_f32_32x32x32_bf16 v[72:87], v[220:223], v[144:151], v36
    v_add_u32 v37, 40960, v37
    v_add_u32 v38, 40960, v38
    v_add_u32 v39, 40960, v39
    s_sub_u32 s43, s43, 1
    s_cmp_lg_u32 s43, 1
    v_exp_f32 v164, v164
    v_exp_f32 v165, v165
    v_exp_f32 v166, v166
    v_exp_f32 v167, v167
    s_branch Lattn
Lat_f:
    s_barrier
    s_branch Lat_fr
Lat_c:
    s_barrier
    s_mov_b64 vcc, 0
    s_branch Lat_cr
Lat_x:
    v_mfma_f32_32x32x16_bf16 v[152:167], v[172:175], v[16:19], 0
    v_exp_f32 v136, v136
    v_exp_f32 v137, v137
    v_exp_f32 v138, v138
    v_exp_f32 v139, v139
    v_mfma_f32_32x32x8_bf16 v[152:167], v[190:191], v[26:27], v[152:167]
    v_exp_f32 v140, v140
    v_exp_f32 v141, v141
    v_exp_f32 v142, v142
    v_exp_f32 v143, v143
    v_smfmac_f32_32x32x32_bf16 v[56:71], v[200:203], v[120:127], v36
    buffer_load_dwordx4 v[242:245], v252, s[12:15], s59 offen
    v_exp_f32 v144, v144
    v_exp_f32 v145, v145
    v_exp_f32 v146, v146
    v_exp_f32 v147, v147
    v_smfmac_f32_32x32x32_bf16 v[56:71], v[204:207], v[128:135], v36
    v_exp_f32 v148, v148
    v_exp_f32 v149, v149
    v_exp_f32 v150, v150
    v_exp_f32 v151, v151
    s_waitcnt lgkmcnt(0)
    v_mfma_f32_32x32x16_bf16 v[104:119], v[176:179], v[4:7], 0
    v_exp_f32 v152, v152
    v_exp_f32 v153, v153
    v_exp_f32 v154, v154
    v_exp_f32 v155, v155
    v_mfma_f32_32x32x8_bf16 v[104:119], v[188:189], v[28:29], v[104:119]
    v_exp_f32 v156, v156
    v_exp_f32 v157, v157
    v_exp_f32 v158, v158
    v_exp_f32 v159, v159
    v_smfmac_f32_32x32x32_bf16 v[72:87], v[200:203], v[136:143], v36
    buffer_load_dwordx4 v[246:249], v252, s[12:15], s59 offen offset:16
    v_exp_f32 v160, v160
    v_exp_f32 v161, v161
    v_exp_f32 v162, v162
    v_exp_f32 v163, v163
    v_smfmac_f32_32x32x32_bf16 v[72:87], v[204:207], v[144:151], v36
    v_exp_f32 v164, v164
    v_exp_f32 v165, v165
    v_exp_f32 v166, v166
    v_exp_f32 v167, v167
    s_barrier
    v_mfma_f32_32x32x16_bf16 v[120:135], v[176:179], v[8:11], 0
    v_exp_f32 v104, v104
    v_exp_f32 v105, v105
    v_exp_f32 v106, v106
    v_exp_f32 v107, v107
    v_mfma_f32_32x32x8_bf16 v[120:135], v[188:189], v[30:31], v[120:135]
    v_exp_f32 v108, v108
    v_exp_f32 v109, v109
    v_exp_f32 v110, v110
    v_exp_f32 v111, v111
    v_smfmac_f32_32x32x32_bf16 v[88:103], v[200:203], v[152:159], v36
    buffer_load_dwordx2 v[250:251], v253, s[12:15], s59 offen offset:128
    v_exp_f32 v112, v112
    v_exp_f32 v113, v113
    v_exp_f32 v114, v114
    v_exp_f32 v115, v115
    v_smfmac_f32_32x32x32_bf16 v[88:103], v[204:207], v[160:167], v36
    v_exp_f32 v116, v116
    v_exp_f32 v117, v117
    v_exp_f32 v118, v118
    v_exp_f32 v119, v119
    v_mfma_f32_32x32x16_bf16 v[136:151], v[176:179], v[12:15], 0
    v_exp_f32 v120, v120
    v_exp_f32 v121, v121
    v_exp_f32 v122, v122
    v_exp_f32 v123, v123
    v_mfma_f32_32x32x8_bf16 v[136:151], v[188:189], v[32:33], v[136:151]
    v_exp_f32 v124, v124
    v_exp_f32 v125, v125
    v_exp_f32 v126, v126
    v_exp_f32 v127, v127
    v_smfmac_f32_32x32x32_bf16 v[40:55], v[208:211], v[104:111], v36
    buffer_load_dwordx4 v[232:235], v230, s[16:19], s42 offen
    v_exp_f32 v128, v128
    v_exp_f32 v129, v129
    v_exp_f32 v130, v130
    v_exp_f32 v131, v131
    v_smfmac_f32_32x32x32_bf16 v[40:55], v[212:215], v[112:119], v36
    v_exp_f32 v132, v132
    v_exp_f32 v133, v133
    v_exp_f32 v134, v134
    v_exp_f32 v135, v135
    v_mfma_f32_32x32x16_bf16 v[152:167], v[176:179], v[16:19], 0
    v_exp_f32 v136, v136
    v_exp_f32 v137, v137
    v_exp_f32 v138, v138
    v_exp_f32 v139, v139
    v_mfma_f32_32x32x8_bf16 v[152:167], v[188:189], v[34:35], v[152:167]
    v_exp_f32 v140, v140
    v_exp_f32 v141, v141
    v_exp_f32 v142, v142
    v_exp_f32 v143, v143
    v_smfmac_f32_32x32x32_bf16 v[56:71], v[208:211], v[120:127], v36
    buffer_load_dwordx4 v[236:239], v230, s[16:19], s42 offen offset:16
    v_exp_f32 v144, v144
    v_exp_f32 v145, v145
    v_exp_f32 v146, v146
    v_exp_f32 v147, v147
    v_smfmac_f32_32x32x32_bf16 v[56:71], v[212:215], v[128:135], v36
    v_exp_f32 v148, v148
    v_exp_f32 v149, v149
    v_exp_f32 v150, v150
    v_exp_f32 v151, v151
    v_mfma_f32_32x32x16_bf16 v[104:119], v[180:183], v[4:7], 0
    v_exp_f32 v152, v152
    v_exp_f32 v153, v153
    v_exp_f32 v154, v154
    v_exp_f32 v155, v155
    v_mfma_f32_32x32x8_bf16 v[104:119], v[190:191], v[28:29], v[104:119]
    v_exp_f32 v156, v156
    v_exp_f32 v157, v157
    v_exp_f32 v158, v158
    v_exp_f32 v159, v159
    v_smfmac_f32_32x32x32_bf16 v[72:87], v[208:211], v[136:143], v36
    buffer_load_dwordx2 v[240:241], v231, s[16:19], s42 offen offset:128
    v_exp_f32 v160, v160
    v_exp_f32 v161, v161
    v_exp_f32 v162, v162
    v_exp_f32 v163, v163
    v_smfmac_f32_32x32x32_bf16 v[72:87], v[212:215], v[144:151], v36
    v_exp_f32 v164, v164
    v_exp_f32 v165, v165
    v_exp_f32 v166, v166
    v_exp_f32 v167, v167
    v_mfma_f32_32x32x16_bf16 v[120:135], v[180:183], v[8:11], 0
    v_exp_f32 v104, v104
    v_exp_f32 v105, v105
    v_exp_f32 v106, v106
    v_exp_f32 v107, v107
    v_mfma_f32_32x32x8_bf16 v[120:135], v[190:191], v[30:31], v[120:135]
    v_exp_f32 v108, v108
    v_exp_f32 v109, v109
    v_exp_f32 v110, v110
    v_exp_f32 v111, v111
    v_smfmac_f32_32x32x32_bf16 v[88:103], v[208:211], v[152:159], v36
    buffer_load_dword v226, v227, s[24:27], 0 offen offset:4 sc1
    v_exp_f32 v112, v112
    v_exp_f32 v113, v113
    v_exp_f32 v114, v114
    v_exp_f32 v115, v115
    v_smfmac_f32_32x32x32_bf16 v[88:103], v[212:215], v[160:167], v36
    v_exp_f32 v116, v116
    v_exp_f32 v117, v117
    v_exp_f32 v118, v118
    v_exp_f32 v119, v119
    v_mfma_f32_32x32x16_bf16 v[136:151], v[180:183], v[12:15], 0
    v_exp_f32 v120, v120
    v_exp_f32 v121, v121
    v_exp_f32 v122, v122
    v_exp_f32 v123, v123
    v_mfma_f32_32x32x8_bf16 v[136:151], v[190:191], v[32:33], v[136:151]
    v_exp_f32 v124, v124
    v_exp_f32 v125, v125
    v_exp_f32 v126, v126
    v_exp_f32 v127, v127
    v_smfmac_f32_32x32x32_bf16 v[40:55], v[216:219], v[104:111], v36
    v_exp_f32 v128, v128
    v_exp_f32 v129, v129
    v_exp_f32 v130, v130
    v_exp_f32 v131, v131
    v_smfmac_f32_32x32x32_bf16 v[40:55], v[220:223], v[112:119], v36
    v_exp_f32 v132, v132
    v_exp_f32 v133, v133
    v_exp_f32 v134, v134
    v_exp_f32 v135, v135
    v_mfma_f32_32x32x16_bf16 v[152:167], v[180:183], v[16:19], 0
    v_exp_f32 v136, v136
    v_exp_f32 v137, v137
    v_exp_f32 v138, v138
    v_exp_f32 v139, v139
    v_mfma_f32_32x32x8_bf16 v[152:167], v[190:191], v[34:35], v[152:167]
    v_exp_f32 v140, v140
    v_exp_f32 v141, v141
    v_exp_f32 v142, v142
    v_exp_f32 v143, v143
    v_smfmac_f32_32x32x32_bf16 v[56:71], v[216:219], v[120:127], v36
    v_exp_f32 v144, v144
    ds_write_b128 v228, v[40:43] offset:0
    v_exp_f32 v145, v145
    ds_write_b128 v228, v[44:47] offset:1024
    v_exp_f32 v146, v146
    ds_write_b128 v228, v[48:51] offset:2048
    v_exp_f32 v147, v147
    ds_write_b32 v228, v52 offset:3072
    v_smfmac_f32_32x32x32_bf16 v[56:71], v[220:223], v[128:135], v36
    v_exp_f32 v148, v148
    v_exp_f32 v149, v149
    v_exp_f32 v150, v150
    v_exp_f32 v151, v151
    v_exp_f32 v152, v152
    v_exp_f32 v153, v153
    v_exp_f32 v154, v154
    v_exp_f32 v155, v155
    v_exp_f32 v156, v156
    v_exp_f32 v157, v157
    v_exp_f32 v158, v158
    v_exp_f32 v159, v159
    v_smfmac_f32_32x32x32_bf16 v[72:87], v[216:219], v[136:143], v36
    v_exp_f32 v160, v160
    ds_write_b128 v228, v[56:59] offset:4096
    v_exp_f32 v161, v161
    ds_write_b128 v228, v[60:63] offset:5120
    v_exp_f32 v162, v162
    ds_write_b128 v228, v[64:67] offset:6144
    v_exp_f32 v163, v163
    ds_write_b32 v228, v68 offset:7168
    v_smfmac_f32_32x32x32_bf16 v[72:87], v[220:223], v[144:151], v36
    v_exp_f32 v164, v164
    v_exp_f32 v165, v165
    v_exp_f32 v166, v166
    v_exp_f32 v167, v167
    s_nop 0
    s_nop 0
    v_smfmac_f32_32x32x32_bf16 v[88:103], v[216:219], v[152:159], v36
    v_smfmac_f32_32x32x32_bf16 v[88:103], v[220:223], v[160:167], v36
    s_waitcnt lgkmcnt(0)
    s_barrier
    ds_read_b128 v[40:43], v229 offset:0
    ds_read_b128 v[44:47], v229 offset:1024
    ds_read_b128 v[48:51], v229 offset:2048
    ds_read_b32 v52, v229 offset:3072
    ds_read_b128 v[56:59], v229 offset:4096
    ds_read_b128 v[60:63], v229 offset:5120
    ds_read_b128 v[64:67], v229 offset:6144
    ds_read_b32 v68, v229 offset:7168
    s_waitcnt lgkmcnt(4)
    v_add_f32 v84, v84, v52
    v_pk_add_f32 v[72:73], v[72:73], v[40:41]
    v_pk_add_f32 v[74:75], v[74:75], v[42:43]
    v_pk_add_f32 v[76:77], v[76:77], v[44:45]
    v_pk_add_f32 v[78:79], v[78:79], v[46:47]
    v_pk_add_f32 v[80:81], v[80:81], v[48:49]
    v_pk_add_f32 v[82:83], v[82:83], v[50:51]
    s_waitcnt lgkmcnt(0)
    v_add_f32 v100, v100, v68
    v_pk_add_f32 v[88:89], v[88:89], v[56:57]
    v_pk_add_f32 v[90:91], v[90:91], v[58:59]
    v_pk_add_f32 v[92:93], v[92:93], v[60:61]
    v_pk_add_f32 v[94:95], v[94:95], v[62:63]
    v_pk_add_f32 v[96:97], v[96:97], v[64:65]
    v_pk_add_f32 v[98:99], v[98:99], v[66:67]
Lchk:
    v_rcp_f32 v136, v84
    s_nop 0
    v_pk_mul_f32 v[72:73], v[72:73], v[136:137] op_sel_hi:[1,0]
    v_pk_mul_f32 v[74:75], v[74:75], v[136:137] op_sel_hi:[1,0]
    v_pk_mul_f32 v[76:77], v[76:77], v[136:137] op_sel_hi:[1,0]
    v_pk_mul_f32 v[78:79], v[78:79], v[136:137] op_sel_hi:[1,0]
    v_pk_mul_f32 v[80:81], v[80:81], v[136:137] op_sel_hi:[1,0]
    v_pk_mul_f32 v[82:83], v[82:83], v[136:137] op_sel_hi:[1,0]
    v_cvt_pk_bf16_f32 v120, v72, v73
    v_cvt_pk_bf16_f32 v121, v74, v75
    v_cvt_pk_bf16_f32 v122, v76, v77
    v_cvt_pk_bf16_f32 v123, v78, v79
    v_cvt_pk_bf16_f32 v124, v80, v81
    v_cvt_pk_bf16_f32 v125, v82, v83
    buffer_store_dwordx4 v[120:123], v225, s[20:23], s44 offen sc1
    v_rcp_f32 v138, v100
    s_nop 0
    v_pk_mul_f32 v[88:89], v[88:89], v[138:139] op_sel_hi:[1,0]
    v_pk_mul_f32 v[90:91], v[90:91], v[138:139] op_sel_hi:[1,0]
    v_pk_mul_f32 v[92:93], v[92:93], v[138:139] op_sel_hi:[1,0]
    v_pk_mul_f32 v[94:95], v[94:95], v[138:139] op_sel_hi:[1,0]
    v_pk_mul_f32 v[96:97], v[96:97], v[138:139] op_sel_hi:[1,0]
    v_pk_mul_f32 v[98:99], v[98:99], v[138:139] op_sel_hi:[1,0]
    v_cvt_pk_bf16_f32 v128, v88, v89
    v_cvt_pk_bf16_f32 v129, v90, v91
    v_cvt_pk_bf16_f32 v130, v92, v93
    v_cvt_pk_bf16_f32 v131, v94, v95
    v_cvt_pk_bf16_f32 v132, v96, v97
    v_cvt_pk_bf16_f32 v133, v98, v99
    buffer_store_dwordx4 v[128:131], v225, s[20:23], s48 offen sc1
    s_mov_b32 exec_hi, 0
    buffer_store_dwordx2 v[124:125], v224, s[20:23], s45 offen sc1
    buffer_store_dwordx2 v[132:133], v224, s[20:23], s49 offen sc1
    s_mov_b64 exec, -1
    s_mov_b32 s36, 0x35800000
    s_mov_b32 s37, 0x71800000
    v_pk_add_f32 v[142:143], v[72:73], v[74:75]
    v_pk_add_f32 v[142:143], v[142:143], v[76:77]
    v_pk_add_f32 v[142:143], v[142:143], v[78:79]
    v_pk_add_f32 v[142:143], v[142:143], v[80:81]
    v_pk_add_f32 v[142:143], v[142:143], v[82:83]
    v_add_f32 v142, v142, v143
    v_fma_f32 v142, v142, 0, v84
    v_cmp_nle_f32 s[50:51], s36, v142
    v_cmp_nge_f32 s[52:53], s37, v142
    v_pk_add_f32 v[142:143], v[88:89], v[90:91]
    v_pk_add_f32 v[142:143], v[142:143], v[92:93]
    v_pk_add_f32 v[142:143], v[142:143], v[94:95]
    v_pk_add_f32 v[142:143], v[142:143], v[96:97]
    v_pk_add_f32 v[142:143], v[142:143], v[98:99]
    v_add_f32 v142, v142, v143
    v_fma_f32 v142, v142, 0, v100
    v_cmp_nle_f32 s[54:55], s36, v142
    v_cmp_nge_f32 s[56:57], s37, v142
    s_or_b64 s[50:51], s[50:51], s[52:53]
    s_or_b64 s[54:55], s[54:55], s[56:57]
    s_or_b64 s[50:51], s[50:51], s[54:55]
    s_and_b64 s[50:51], s[50:51], s[46:47]
    s_cbranch_scc1 Lfallback
    s_barrier
    s_waitcnt vmcnt(0)
    s_atomic_swap s100, s[84:85], s58
    s_lshl_b32 s33, s29, 9
    s_add_u32 s33, s33, 28729344
    s_add_u32 s86, s84, s33
    s_addc_u32 s87, s85, 0
    v_cmp_ne_u32 vcc, 8, v226
    v_mov_b32 v230, s100
    v_mov_b32 v231, 0
    s_cmp_eq_u64 vcc, 0
    s_cselect_b32 s26, 1, 0
    v_lshlrev_b32 v1, 4, v0
    v_and_b32 v4, 15, v0
    v_lshrrev_b32 v5, 4, v0
    s_lshl_b32 s33, s29, 2
    s_add_u32 s33, s33, s28
    s_mul_i32 s34, s33, 20480
    s_add_u32 s34, s34, 10485760
    v_add_u32 v6, 61440, v1
    v_lshlrev_b32 v7, 3, v0
    v_lshlrev_b32 v8, 4, v4
    v_lshl_add_u32 v9, v5, 9, v8
    v_lshrrev_b32 v10, 1, v5
    v_lshl_add_u32 v8, v10, 8, v8
    v_and_b32 v10, 1, v5
    v_lshl_add_u32 v8, v10, 3, v8
    s_mul_i32 s35, s33, 20480
    s_mul_i32 s36, s30, 2560
    s_add_u32 s35, s35, s36
    s_add_u32 s35, s35, 13107200
    v_lshrrev_b32 v10, 1, v5
    v_lshlrev_b32 v10, 2, v10
    v_lshl_add_u32 v10, v4, 3, v10
    s_lshl_b32 s37, s33, 10
    s_lshl_b32 s39, s30, 7
    s_add_u32 s37, s37, s39
    s_add_u32 s37, s37, 28131328
    v_mov_b32 v11, 0x3f803f80
    v_lshlrev_b32 v4, 3, v4
    s_mul_i32 s56, s63, 768
    s_add_u32 s56, s56, 28262400
    s_lshl_b32 s57, s63, 7
    s_add_u32 s57, s57, 28274688
    ds_read_b128 v[112:115], v1 offset:0
    ds_read_b128 v[116:119], v1 offset:1024
    ds_read_b128 v[120:123], v1 offset:2048
    ds_read_b128 v[124:127], v1 offset:3072
    ds_read_b128 v[128:131], v1 offset:4096
    ds_read_b128 v[132:135], v1 offset:5120
    ds_read_b128 v[136:139], v1 offset:6144
    ds_read_b128 v[140:143], v1 offset:7168
    ds_read_b128 v[144:147], v1 offset:8192
    ds_read_b128 v[148:151], v1 offset:9216
    v_lshlrev_b32 v12, 16, v242
    v_and_b32 v13, 0xffff0000, v242
    v_lshlrev_b32 v14, 16, v243
    v_and_b32 v15, 0xffff0000, v243
    v_lshlrev_b32 v16, 16, v244
    v_and_b32 v17, 0xffff0000, v244
    v_lshlrev_b32 v18, 16, v245
    v_and_b32 v19, 0xffff0000, v245
    v_lshlrev_b32 v20, 16, v246
    v_and_b32 v21, 0xffff0000, v246
    v_lshlrev_b32 v22, 16, v247
    v_and_b32 v23, 0xffff0000, v247
    v_lshlrev_b32 v24, 16, v248
    v_and_b32 v25, 0xffff0000, v248
    v_lshlrev_b32 v26, 16, v249
    v_and_b32 v27, 0xffff0000, v249
    v_lshlrev_b32 v28, 16, v250
    v_and_b32 v29, 0xffff0000, v250
    v_lshlrev_b32 v30, 16, v251
    v_and_b32 v31, 0xffff0000, v251
    v_and_b32 v251, 0xffff0000, v241
    v_lshlrev_b32 v250, 16, v241
    v_and_b32 v249, 0xffff0000, v240
    v_lshlrev_b32 v248, 16, v240
    v_and_b32 v247, 0xffff0000, v239
    v_lshlrev_b32 v246, 16, v239
    v_and_b32 v245, 0xffff0000, v238
    v_lshlrev_b32 v244, 16, v238
    v_and_b32 v243, 0xffff0000, v237
    v_lshlrev_b32 v242, 16, v237
    v_and_b32 v241, 0xffff0000, v236
    v_lshlrev_b32 v240, 16, v236
    v_and_b32 v239, 0xffff0000, v235
    v_lshlrev_b32 v238, 16, v235
    v_and_b32 v237, 0xffff0000, v234
    v_lshlrev_b32 v236, 16, v234
    v_and_b32 v235, 0xffff0000, v233
    v_lshlrev_b32 v234, 16, v233
    v_and_b32 v233, 0xffff0000, v232
    v_lshlrev_b32 v232, 16, v232
    s_cmp_lg_u32 s28, 0
    s_cbranch_scc1 Uh26
    s_mov_b32 s60, 200000
Up27:
    s_load_dwordx8 s[4:11], s[86:87], 0 glc
    s_load_dwordx8 s[40:47], s[86:87], 128 glc
    s_load_dwordx8 s[48:55], s[86:87], 256 glc
    s_load_dwordx8 s[12:19], s[86:87], 384 glc
Uf29:
    s_sub_u32 s60, s60, 1
    s_cbranch_scc1 Ue28
    s_waitcnt lgkmcnt(0)
    s_cmp_lg_u64 s[4:5], s[100:101]
    s_cbranch_scc1 Up27
    s_cmp_lg_u64 s[6:7], s[100:101]
    s_cbranch_scc1 Up27
    s_cmp_lg_u64 s[8:9], s[100:101]
    s_cbranch_scc1 Up27
    s_cmp_lg_u64 s[10:11], s[100:101]
    s_cbranch_scc1 Up27
    s_cmp_lg_u64 s[40:41], s[100:101]
    s_cbranch_scc1 Up27
    s_cmp_lg_u64 s[42:43], s[100:101]
    s_cbranch_scc1 Up27
    s_cmp_lg_u64 s[44:45], s[100:101]
    s_cbranch_scc1 Up27
    s_cmp_lg_u64 s[46:47], s[100:101]
    s_cbranch_scc1 Up27
    s_cmp_lg_u64 s[48:49], s[100:101]
    s_cbranch_scc1 Up27
    s_cmp_lg_u64 s[50:51], s[100:101]
    s_cbranch_scc1 Up27
    s_cmp_lg_u64 s[52:53], s[100:101]
    s_cbranch_scc1 Up27
    s_cmp_lg_u64 s[54:55], s[100:101]
    s_cbranch_scc1 Up27
    s_cmp_lg_u64 s[12:13], s[100:101]
    s_cbranch_scc1 Up27
    s_cmp_lg_u64 s[14:15], s[100:101]
    s_cbranch_scc1 Up27
    s_cmp_lg_u64 s[16:17], s[100:101]
    s_cbranch_scc1 Up27
    s_cmp_lg_u64 s[18:19], s[100:101]
    s_cbranch_scc1 Up27
Ue28:
    s_waitcnt lgkmcnt(0)
Uh26:
    s_barrier
    buffer_load_dwordx4 v[32:35], v1, s[20:23], s34 offen offset:0 sc1
    buffer_load_dwordx4 v[36:39], v1, s[20:23], s34 offen offset:1024 sc1
    buffer_load_dwordx4 v[40:43], v1, s[20:23], s34 offen offset:2048 sc1
    buffer_load_dwordx4 v[44:47], v1, s[20:23], s34 offen offset:3072 sc1
    s_add_u32 s34, s34, 4096
    buffer_load_dwordx4 v[48:51], v1, s[20:23], s34 offen offset:0 sc1
    buffer_load_dwordx4 v[52:55], v1, s[20:23], s34 offen offset:1024 sc1
    buffer_load_dwordx4 v[56:59], v1, s[20:23], s34 offen offset:2048 sc1
    buffer_load_dwordx4 v[60:63], v1, s[20:23], s34 offen offset:3072 sc1
    s_add_u32 s34, s34, 4096
    buffer_load_dwordx4 v[64:67], v1, s[20:23], s34 offen offset:0 sc1
    buffer_load_dwordx4 v[68:71], v1, s[20:23], s34 offen offset:1024 sc1
    buffer_load_dwordx4 v[72:75], v1, s[20:23], s34 offen offset:2048 sc1
    s_waitcnt vmcnt(10) lgkmcnt(5)
    v_mfma_f32_16x16x32_bf16 v[12:15], v[112:115], v[32:35], v[12:15]
    ds_read_b128 v[152:155], v1 offset:10240
    buffer_load_dwordx4 v[76:79], v1, s[20:23], s34 offen offset:3072 sc1
    s_add_u32 s34, s34, 4096
    v_mfma_f32_16x16x32_bf16 v[16:19], v[116:119], v[32:35], v[16:19]
    ds_read_b128 v[156:159], v1 offset:11264
    v_mfma_f32_16x16x32_bf16 v[20:23], v[120:123], v[32:35], v[20:23]
    ds_read_b128 v[160:163], v1 offset:12288
    v_mfma_f32_16x16x32_bf16 v[24:27], v[124:127], v[32:35], v[24:27]
    ds_read_b128 v[164:167], v1 offset:13312
    v_mfma_f32_16x16x32_bf16 v[28:31], v[128:131], v[32:35], v[28:31]
    ds_read_b128 v[168:171], v1 offset:14336
    s_waitcnt vmcnt(10) lgkmcnt(5)
    v_mfma_f32_16x16x32_bf16 v[12:15], v[132:135], v[36:39], v[12:15]
    ds_read_b128 v[172:175], v1 offset:15360
    buffer_load_dwordx4 v[80:83], v1, s[20:23], s34 offen offset:0 sc1
    v_mfma_f32_16x16x32_bf16 v[16:19], v[136:139], v[36:39], v[16:19]
    ds_read_b128 v[176:179], v1 offset:16384
    v_mfma_f32_16x16x32_bf16 v[20:23], v[140:143], v[36:39], v[20:23]
    ds_read_b128 v[180:183], v1 offset:17408
    v_mfma_f32_16x16x32_bf16 v[24:27], v[144:147], v[36:39], v[24:27]
    ds_read_b128 v[184:187], v1 offset:18432
    v_mfma_f32_16x16x32_bf16 v[28:31], v[148:151], v[36:39], v[28:31]
    ds_read_b128 v[188:191], v1 offset:19456
    s_waitcnt vmcnt(10) lgkmcnt(5)
    v_mfma_f32_16x16x32_bf16 v[12:15], v[152:155], v[40:43], v[12:15]
    ds_read_b128 v[112:115], v1 offset:20480
    buffer_load_dwordx4 v[84:87], v1, s[20:23], s34 offen offset:1024 sc1
    v_mfma_f32_16x16x32_bf16 v[16:19], v[156:159], v[40:43], v[16:19]
    ds_read_b128 v[116:119], v1 offset:21504
    v_mfma_f32_16x16x32_bf16 v[20:23], v[160:163], v[40:43], v[20:23]
    ds_read_b128 v[120:123], v1 offset:22528
    v_mfma_f32_16x16x32_bf16 v[24:27], v[164:167], v[40:43], v[24:27]
    ds_read_b128 v[124:127], v1 offset:23552
    v_mfma_f32_16x16x32_bf16 v[28:31], v[168:171], v[40:43], v[28:31]
    ds_read_b128 v[128:131], v1 offset:24576
    s_waitcnt vmcnt(10) lgkmcnt(5)
    v_mfma_f32_16x16x32_bf16 v[12:15], v[172:175], v[44:47], v[12:15]
    ds_read_b128 v[132:135], v1 offset:25600
    buffer_load_dwordx4 v[88:91], v1, s[20:23], s34 offen offset:2048 sc1
    v_mfma_f32_16x16x32_bf16 v[16:19], v[176:179], v[44:47], v[16:19]
    ds_read_b128 v[136:139], v1 offset:26624
    v_mfma_f32_16x16x32_bf16 v[20:23], v[180:183], v[44:47], v[20:23]
    ds_read_b128 v[140:143], v1 offset:27648
    v_mfma_f32_16x16x32_bf16 v[24:27], v[184:187], v[44:47], v[24:27]
    ds_read_b128 v[144:147], v1 offset:28672
    v_mfma_f32_16x16x32_bf16 v[28:31], v[188:191], v[44:47], v[28:31]
    ds_read_b128 v[148:151], v1 offset:29696
    s_waitcnt vmcnt(10) lgkmcnt(5)
    v_mfma_f32_16x16x32_bf16 v[12:15], v[112:115], v[48:51], v[12:15]
    ds_read_b128 v[152:155], v1 offset:30720
    buffer_load_dwordx4 v[92:95], v1, s[20:23], s34 offen offset:3072 sc1
    s_add_u32 s34, s34, 4096
    v_mfma_f32_16x16x32_bf16 v[16:19], v[116:119], v[48:51], v[16:19]
    ds_read_b128 v[156:159], v1 offset:31744
    v_mfma_f32_16x16x32_bf16 v[20:23], v[120:123], v[48:51], v[20:23]
    ds_read_b128 v[160:163], v1 offset:32768
    v_mfma_f32_16x16x32_bf16 v[24:27], v[124:127], v[48:51], v[24:27]
    ds_read_b128 v[164:167], v1 offset:33792
    v_mfma_f32_16x16x32_bf16 v[28:31], v[128:131], v[48:51], v[28:31]
    ds_read_b128 v[168:171], v1 offset:34816
    s_waitcnt vmcnt(10) lgkmcnt(5)
    v_mfma_f32_16x16x32_bf16 v[12:15], v[132:135], v[52:55], v[12:15]
    ds_read_b128 v[172:175], v1 offset:35840
    buffer_load_dwordx2 v[96:97], v7, s[20:23], s34 offen offset:0 sc1
    buffer_load_dwordx2 v[98:99], v7, s[20:23], s34 offen offset:512 sc1
    v_mfma_f32_16x16x32_bf16 v[16:19], v[136:139], v[52:55], v[16:19]
    ds_read_b128 v[176:179], v1 offset:36864
    v_mfma_f32_16x16x32_bf16 v[20:23], v[140:143], v[52:55], v[20:23]
    ds_read_b128 v[180:183], v1 offset:37888
    v_mfma_f32_16x16x32_bf16 v[24:27], v[144:147], v[52:55], v[24:27]
    ds_read_b128 v[184:187], v1 offset:38912
    v_mfma_f32_16x16x32_bf16 v[28:31], v[148:151], v[52:55], v[28:31]
    ds_read_b128 v[188:191], v1 offset:39936
    s_waitcnt vmcnt(11) lgkmcnt(5)
    v_mfma_f32_16x16x32_bf16 v[12:15], v[152:155], v[56:59], v[12:15]
    ds_read_b128 v[112:115], v1 offset:40960
    buffer_load_dwordx2 v[100:101], v7, s[20:23], s34 offen offset:1024 sc1
    buffer_load_dwordx2 v[102:103], v7, s[20:23], s34 offen offset:1536 sc1
    v_mfma_f32_16x16x32_bf16 v[16:19], v[156:159], v[56:59], v[16:19]
    ds_read_b128 v[116:119], v1 offset:41984
    v_mfma_f32_16x16x32_bf16 v[20:23], v[160:163], v[56:59], v[20:23]
    ds_read_b128 v[120:123], v1 offset:43008
    v_mfma_f32_16x16x32_bf16 v[24:27], v[164:167], v[56:59], v[24:27]
    ds_read_b128 v[124:127], v1 offset:44032
    v_mfma_f32_16x16x32_bf16 v[28:31], v[168:171], v[56:59], v[28:31]
    ds_read_b128 v[128:131], v1 offset:45056
    s_waitcnt vmcnt(12) lgkmcnt(5)
    v_mfma_f32_16x16x32_bf16 v[12:15], v[172:175], v[60:63], v[12:15]
    ds_read_b128 v[132:135], v1 offset:46080
    buffer_load_dwordx2 v[104:105], v7, s[20:23], s34 offen offset:2048 sc1
    buffer_load_dwordx2 v[106:107], v7, s[20:23], s34 offen offset:2560 sc1
    v_mfma_f32_16x16x32_bf16 v[16:19], v[176:179], v[60:63], v[16:19]
    ds_read_b128 v[136:139], v1 offset:47104
    v_mfma_f32_16x16x32_bf16 v[20:23], v[180:183], v[60:63], v[20:23]
    ds_read_b128 v[140:143], v1 offset:48128
    v_mfma_f32_16x16x32_bf16 v[24:27], v[184:187], v[60:63], v[24:27]
    ds_read_b128 v[144:147], v1 offset:49152
    v_mfma_f32_16x16x32_bf16 v[28:31], v[188:191], v[60:63], v[28:31]
    ds_read_b128 v[148:151], v1 offset:50176
    s_waitcnt vmcnt(13) lgkmcnt(5)
    v_mfma_f32_16x16x32_bf16 v[12:15], v[112:115], v[64:67], v[12:15]
    ds_read_b128 v[152:155], v1 offset:51200
    buffer_load_dwordx2 v[108:109], v7, s[20:23], s34 offen offset:3072 sc1
    buffer_load_dwordx2 v[110:111], v7, s[20:23], s34 offen offset:3584 sc1
    s_add_u32 s34, s34, 4096
    v_mfma_f32_16x16x32_bf16 v[16:19], v[116:119], v[64:67], v[16:19]
    ds_read_b128 v[156:159], v1 offset:52224
    v_mfma_f32_16x16x32_bf16 v[20:23], v[120:123], v[64:67], v[20:23]
    ds_read_b128 v[160:163], v1 offset:53248
    v_mfma_f32_16x16x32_bf16 v[24:27], v[124:127], v[64:67], v[24:27]
    ds_read_b128 v[164:167], v1 offset:54272
    v_mfma_f32_16x16x32_bf16 v[28:31], v[128:131], v[64:67], v[28:31]
    ds_read_b128 v[168:171], v1 offset:55296
    s_waitcnt vmcnt(14) lgkmcnt(5)
    v_mfma_f32_16x16x32_bf16 v[12:15], v[132:135], v[68:71], v[12:15]
    ds_read_b128 v[172:175], v1 offset:56320
    buffer_load_dwordx2 v[212:213], v4, s[20:23], s56 offen offset:0 sc1
    v_mfma_f32_16x16x32_bf16 v[16:19], v[136:139], v[68:71], v[16:19]
    ds_read_b128 v[176:179], v1 offset:57344
    v_mfma_f32_16x16x32_bf16 v[20:23], v[140:143], v[68:71], v[20:23]
    ds_read_b128 v[180:183], v1 offset:58368
    v_mfma_f32_16x16x32_bf16 v[24:27], v[144:147], v[68:71], v[24:27]
    ds_read_b128 v[184:187], v1 offset:59392
    v_mfma_f32_16x16x32_bf16 v[28:31], v[148:151], v[68:71], v[28:31]
    ds_read_b128 v[188:191], v1 offset:60416
    s_waitcnt vmcnt(14) lgkmcnt(5)
    v_mfma_f32_16x16x32_bf16 v[12:15], v[152:155], v[72:75], v[12:15]
    ds_read_b128 v[112:115], v6 offset:0
    buffer_load_dwordx2 v[214:215], v4, s[20:23], s56 offen offset:128 sc1
    v_mfma_f32_16x16x32_bf16 v[16:19], v[156:159], v[72:75], v[16:19]
    ds_read_b128 v[116:119], v6 offset:1024
    v_mfma_f32_16x16x32_bf16 v[20:23], v[160:163], v[72:75], v[20:23]
    ds_read_b128 v[120:123], v6 offset:2048
    v_mfma_f32_16x16x32_bf16 v[24:27], v[164:167], v[72:75], v[24:27]
    ds_read_b128 v[124:127], v6 offset:3072
    v_mfma_f32_16x16x32_bf16 v[28:31], v[168:171], v[72:75], v[28:31]
    ds_read_b128 v[128:131], v6 offset:4096
    s_waitcnt vmcnt(14) lgkmcnt(5)
    v_mfma_f32_16x16x32_bf16 v[12:15], v[172:175], v[76:79], v[12:15]
    ds_read_b128 v[132:135], v6 offset:5120
    buffer_load_dwordx2 v[216:217], v4, s[20:23], s56 offen offset:256 sc1
    v_mfma_f32_16x16x32_bf16 v[16:19], v[176:179], v[76:79], v[16:19]
    ds_read_b128 v[136:139], v6 offset:6144
    v_mfma_f32_16x16x32_bf16 v[20:23], v[180:183], v[76:79], v[20:23]
    ds_read_b128 v[140:143], v6 offset:7168
    v_mfma_f32_16x16x32_bf16 v[24:27], v[184:187], v[76:79], v[24:27]
    ds_read_b128 v[144:147], v6 offset:8192
    v_mfma_f32_16x16x32_bf16 v[28:31], v[188:191], v[76:79], v[28:31]
    ds_read_b128 v[148:151], v6 offset:9216
    s_waitcnt vmcnt(14) lgkmcnt(5)
    v_mfma_f32_16x16x32_bf16 v[12:15], v[112:115], v[80:83], v[12:15]
    ds_read_b128 v[152:155], v6 offset:10240
    buffer_load_dwordx2 v[218:219], v4, s[20:23], s56 offen offset:384 sc1
    v_mfma_f32_16x16x32_bf16 v[16:19], v[116:119], v[80:83], v[16:19]
    ds_read_b128 v[156:159], v6 offset:11264
    v_mfma_f32_16x16x32_bf16 v[20:23], v[120:123], v[80:83], v[20:23]
    ds_read_b128 v[160:163], v6 offset:12288
    v_mfma_f32_16x16x32_bf16 v[24:27], v[124:127], v[80:83], v[24:27]
    ds_read_b128 v[164:167], v6 offset:13312
    v_mfma_f32_16x16x32_bf16 v[28:31], v[128:131], v[80:83], v[28:31]
    ds_read_b128 v[168:171], v6 offset:14336
    s_waitcnt vmcnt(14) lgkmcnt(5)
    v_mfma_f32_16x16x32_bf16 v[12:15], v[132:135], v[84:87], v[12:15]
    ds_read_b128 v[172:175], v6 offset:15360
    buffer_load_dwordx2 v[220:221], v4, s[20:23], s56 offen offset:512 sc1
    v_mfma_f32_16x16x32_bf16 v[16:19], v[136:139], v[84:87], v[16:19]
    ds_read_b128 v[176:179], v6 offset:16384
    v_mfma_f32_16x16x32_bf16 v[20:23], v[140:143], v[84:87], v[20:23]
    ds_read_b128 v[180:183], v6 offset:17408
    v_mfma_f32_16x16x32_bf16 v[24:27], v[144:147], v[84:87], v[24:27]
    ds_read_b128 v[184:187], v6 offset:18432
    v_mfma_f32_16x16x32_bf16 v[28:31], v[148:151], v[84:87], v[28:31]
    ds_read_b128 v[188:191], v6 offset:19456
    s_waitcnt vmcnt(14) lgkmcnt(5)
    v_mfma_f32_16x16x32_bf16 v[12:15], v[152:155], v[88:91], v[12:15]
    ds_read_b128 v[112:115], v6 offset:20480
    buffer_load_dwordx2 v[222:223], v4, s[20:23], s56 offen offset:640 sc1
    v_mfma_f32_16x16x32_bf16 v[16:19], v[156:159], v[88:91], v[16:19]
    ds_read_b128 v[116:119], v6 offset:21504
    v_mfma_f32_16x16x32_bf16 v[20:23], v[160:163], v[88:91], v[20:23]
    ds_read_b128 v[120:123], v6 offset:22528
    v_mfma_f32_16x16x32_bf16 v[24:27], v[164:167], v[88:91], v[24:27]
    ds_read_b128 v[124:127], v6 offset:23552
    v_mfma_f32_16x16x32_bf16 v[28:31], v[168:171], v[88:91], v[28:31]
    ds_read_b128 v[128:131], v6 offset:24576
    s_waitcnt vmcnt(14) lgkmcnt(5)
    v_mfma_f32_16x16x32_bf16 v[12:15], v[172:175], v[92:95], v[12:15]
    ds_read_b128 v[132:135], v6 offset:25600
    buffer_load_dwordx2 v[224:225], v4, s[20:23], s57 offen sc1
    v_mfma_f32_16x16x32_bf16 v[16:19], v[176:179], v[92:95], v[16:19]
    ds_read_b128 v[136:139], v6 offset:26624
    v_mfma_f32_16x16x32_bf16 v[20:23], v[180:183], v[92:95], v[20:23]
    ds_read_b128 v[140:143], v6 offset:27648
    v_mfma_f32_16x16x32_bf16 v[24:27], v[184:187], v[92:95], v[24:27]
    ds_read_b128 v[144:147], v6 offset:28672
    v_mfma_f32_16x16x32_bf16 v[28:31], v[188:191], v[92:95], v[28:31]
    ds_read_b128 v[148:151], v6 offset:29696
    s_waitcnt vmcnt(13) lgkmcnt(5)
    v_mfma_f32_16x16x32_bf16 v[12:15], v[112:115], v[96:99], v[12:15]
    ds_read_b128 v[152:155], v6 offset:30720
    v_mfma_f32_16x16x32_bf16 v[16:19], v[116:119], v[96:99], v[16:19]
    ds_read_b128 v[156:159], v6 offset:31744
    v_mfma_f32_16x16x32_bf16 v[20:23], v[120:123], v[96:99], v[20:23]
    ds_read_b128 v[160:163], v6 offset:32768
    v_mfma_f32_16x16x32_bf16 v[24:27], v[124:127], v[96:99], v[24:27]
    ds_read_b128 v[164:167], v6 offset:33792
    v_mfma_f32_16x16x32_bf16 v[28:31], v[128:131], v[96:99], v[28:31]
    ds_read_b128 v[168:171], v6 offset:34816
    s_waitcnt vmcnt(11) lgkmcnt(5)
    v_mfma_f32_16x16x32_bf16 v[12:15], v[132:135], v[100:103], v[12:15]
    ds_read_b128 v[172:175], v6 offset:35840
    v_mfma_f32_16x16x32_bf16 v[16:19], v[136:139], v[100:103], v[16:19]
    ds_read_b128 v[176:179], v6 offset:36864
    v_mfma_f32_16x16x32_bf16 v[20:23], v[140:143], v[100:103], v[20:23]
    ds_read_b128 v[180:183], v6 offset:37888
    v_mfma_f32_16x16x32_bf16 v[24:27], v[144:147], v[100:103], v[24:27]
    ds_read_b128 v[184:187], v6 offset:38912
    v_mfma_f32_16x16x32_bf16 v[28:31], v[148:151], v[100:103], v[28:31]
    ds_read_b128 v[188:191], v6 offset:39936
    s_waitcnt vmcnt(9) lgkmcnt(5)
    v_mfma_f32_16x16x32_bf16 v[12:15], v[152:155], v[104:107], v[12:15]
    v_mfma_f32_16x16x32_bf16 v[16:19], v[156:159], v[104:107], v[16:19]
    v_mfma_f32_16x16x32_bf16 v[20:23], v[160:163], v[104:107], v[20:23]
    v_mfma_f32_16x16x32_bf16 v[24:27], v[164:167], v[104:107], v[24:27]
    v_mfma_f32_16x16x32_bf16 v[28:31], v[168:171], v[104:107], v[28:31]
    s_waitcnt vmcnt(7) lgkmcnt(0)
    v_mfma_f32_16x16x32_bf16 v[12:15], v[172:175], v[108:111], v[12:15]
    v_mfma_f32_16x16x32_bf16 v[16:19], v[176:179], v[108:111], v[16:19]
    v_mfma_f32_16x16x32_bf16 v[20:23], v[180:183], v[108:111], v[20:23]
    v_mfma_f32_16x16x32_bf16 v[24:27], v[184:187], v[108:111], v[24:27]
    v_mfma_f32_16x16x32_bf16 v[28:31], v[188:191], v[108:111], v[28:31]
    s_nop 3
    v_cvt_pk_bf16_f32 v192, v12, v13
    v_cvt_pk_bf16_f32 v193, v14, v15
    v_dot2_f32_bf16 v2, v192, v11, 0
    v_dot2_f32_bf16 v3, v192, v192, 0
    v_cvt_pk_bf16_f32 v194, v16, v17
    v_dot2_f32_bf16 v2, v193, v11, v2
    v_dot2_f32_bf16 v3, v193, v193, v3
    v_cvt_pk_bf16_f32 v195, v18, v19
    v_dot2_f32_bf16 v2, v194, v11, v2
    v_dot2_f32_bf16 v3, v194, v194, v3
    buffer_store_dwordx4 v[192:195], v9, s[20:23], s35 offen sc1
    v_cvt_pk_bf16_f32 v196, v20, v21
    v_dot2_f32_bf16 v2, v195, v11, v2
    v_dot2_f32_bf16 v3, v195, v195, v3
    v_cvt_pk_bf16_f32 v197, v22, v23
    v_dot2_f32_bf16 v2, v196, v11, v2
    v_dot2_f32_bf16 v3, v196, v196, v3
    v_cvt_pk_bf16_f32 v198, v24, v25
    v_dot2_f32_bf16 v2, v197, v11, v2
    v_dot2_f32_bf16 v3, v197, v197, v3
    v_cvt_pk_bf16_f32 v199, v26, v27
    v_dot2_f32_bf16 v2, v198, v11, v2
    v_dot2_f32_bf16 v3, v198, v198, v3
    buffer_store_dwordx4 v[196:199], v9, s[20:23], s35 offen offset:256 sc1
    v_cvt_pk_bf16_f32 v200, v28, v29
    v_dot2_f32_bf16 v2, v199, v11, v2
    v_dot2_f32_bf16 v3, v199, v199, v3
    v_cvt_pk_bf16_f32 v201, v30, v31
    v_dot2_f32_bf16 v2, v200, v11, v2
    v_dot2_f32_bf16 v3, v200, v200, v3
    v_dot2_f32_bf16 v2, v201, v11, v2
    v_dot2_f32_bf16 v3, v201, v201, v3
    buffer_store_dwordx2 v[200:201], v8, s[20:23], s35 offen offset:2048 sc1
    s_nop 1
    v_permlane32_swap_b32 v2, v3
    v_add_f32 v2, v2, v3
    v_mov_b32 v3, v2
    s_nop 1
    v_permlane16_swap_b32 v2, v3
    v_add_f32 v2, v2, v3
    buffer_store_dword v2, v10, s[20:23], s37 offen sc1
    s_barrier
    v_lshlrev_b32 v4, 16, v192
    v_and_b32 v5, 0xffff0000, v192
    v_pk_add_f32 v[232:233], v[232:233], v[4:5]
    v_lshlrev_b32 v4, 16, v193
    v_and_b32 v5, 0xffff0000, v193
    v_pk_add_f32 v[234:235], v[234:235], v[4:5]
    v_lshlrev_b32 v4, 16, v194
    v_and_b32 v5, 0xffff0000, v194
    v_pk_add_f32 v[236:237], v[236:237], v[4:5]
    v_lshlrev_b32 v4, 16, v195
    v_and_b32 v5, 0xffff0000, v195
    v_pk_add_f32 v[238:239], v[238:239], v[4:5]
    v_lshlrev_b32 v4, 16, v196
    v_and_b32 v5, 0xffff0000, v196
    v_pk_add_f32 v[240:241], v[240:241], v[4:5]
    v_lshlrev_b32 v4, 16, v197
    v_and_b32 v5, 0xffff0000, v197
    v_pk_add_f32 v[242:243], v[242:243], v[4:5]
    v_lshlrev_b32 v4, 16, v198
    v_and_b32 v5, 0xffff0000, v198
    v_pk_add_f32 v[244:245], v[244:245], v[4:5]
    v_lshlrev_b32 v4, 16, v199
    v_and_b32 v5, 0xffff0000, v199
    v_pk_add_f32 v[246:247], v[246:247], v[4:5]
    v_lshlrev_b32 v4, 16, v200
    v_and_b32 v5, 0xffff0000, v200
    v_pk_add_f32 v[248:249], v[248:249], v[4:5]
    v_lshlrev_b32 v4, 16, v201
    v_and_b32 v5, 0xffff0000, v201
    v_pk_add_f32 v[250:251], v[250:251], v[4:5]
    s_lshl_b32 s55, s29, 2
    s_add_u32 s55, s55, s28
    s_and_b32 s33, s55, 1
    s_lshl_b32 s33, s33, 3
    s_lshr_b32 s55, s55, 1
    s_lshl_b32 s55, s55, 5
    s_add_u32 s55, s55, s33
    s_add_u32 s55, s55, s30
    s_lshl_b32 s55, s55, 2
    s_add_u32 s55, s55, 28860416
    s_cmp_eq_u32 s26, 0
    s_waitcnt vmcnt(0)
    s_mov_b64 exec, 1
    s_cbranch_scc1 Ug30
    buffer_store_dword v230, v231, s[20:23], s55 offen
    s_branch Ug31
Ug30:
    buffer_store_dword v230, v231, s[20:23], s55 offen sc1
Ug31:
    s_mov_b64 exec, -1
    v_add_u32 v9, 102400, v1
    v_add_u32 v10, 57344, v1
    v_and_b32 v2, 15, v0
    v_lshrrev_b32 v3, 4, v0
    v_lshlrev_b32 v6, 3, v2
    v_lshl_add_u32 v8, v3, 8, v6
    s_lshl_b32 s33, s62, 2
    s_add_u32 s33, s33, s28
    s_mul_i32 s34, s33, 40960
    s_add_u32 s34, s34, 13107200
    s_add_u32 s35, s34, 20480
    s_lshl_b32 s38, s33, 11
    s_add_u32 s38, s38, 28131328
    s_mul_i32 s36, s33, 110592
    s_add_u32 s36, s36, 15728640
    s_lshl_b32 s37, s63, 9
    s_add_u32 s39, s36, s37
    s_add_u32 s39, s39, 49152
    s_lshl_b32 s37, s63, 10
    s_add_u32 s36, s36, s37
    s_lshl_b32 s58, s33, 4
    s_add_u32 s58, s58, s63
    s_lshl_b32 s58, s58, 2
    s_add_u32 s58, s58, 28991488
    ds_read_b128 v[168:171], v9 offset:0
    ds_read_b128 v[172:175], v9 offset:1024
    ds_read_b128 v[176:179], v9 offset:2048
    ds_read_b128 v[180:183], v9 offset:3072
    ds_read_b128 v[184:187], v9 offset:4096
    ds_read_b128 v[188:191], v9 offset:5120
    ds_read_b128 v[192:195], v9 offset:6144
    ds_read_b128 v[196:199], v9 offset:7168
    ds_read_b128 v[200:203], v9 offset:8192
    s_lshl_b32 s37, s33, 7
    s_add_u32 s37, s37, 28860416
    v_lshl_add_u32 v4, v0, 2, s37
    s_mov_b32 s60, 200000
    s_mov_b32 exec_lo, 0xffff
    s_mov_b32 exec_hi, 0x0
Up32:
    buffer_load_dword v5, v4, s[20:23], 0 offen sc1
    s_sub_u32 s60, s60, 1
    s_cbranch_scc1 Ue33
    s_waitcnt vmcnt(0)
    v_xor_b32 v5, s100, v5
    v_cmp_ne_u32 vcc, 0, v5
    s_nop 1
    s_cmp_lg_u64 vcc, 0
    s_cbranch_scc1 Up32
Ue33:
    s_waitcnt vmcnt(0)
    s_mov_b64 exec, -1
    s_mov_b32 s44, 0xc0135761
    s_mov_b32 s45, 0xbdd2d3e8
    buffer_load_dwordx4 v[88:91], v1, s[20:23], s34 offen offset:0 sc1
    buffer_load_dwordx4 v[92:95], v1, s[20:23], s35 offen offset:0 sc1
    buffer_load_dwordx4 v[96:99], v1, s[20:23], s34 offen offset:1024 sc1
    buffer_load_dwordx4 v[100:103], v1, s[20:23], s35 offen offset:1024 sc1
    buffer_load_dwordx4 v[104:107], v1, s[20:23], s34 offen offset:2048 sc1
    buffer_load_dwordx4 v[108:111], v1, s[20:23], s35 offen offset:2048 sc1
    buffer_load_dwordx4 v[112:115], v1, s[20:23], s34 offen offset:3072 sc1
    s_add_u32 s34, s34, 4096
    buffer_load_dwordx4 v[116:119], v1, s[20:23], s35 offen offset:3072 sc1
    s_add_u32 s35, s35, 4096
    buffer_load_dwordx4 v[120:123], v1, s[20:23], s34 offen offset:0 sc1
    buffer_load_dwordx4 v[124:127], v1, s[20:23], s35 offen offset:0 sc1
    buffer_load_dwordx4 v[128:131], v1, s[20:23], s34 offen offset:1024 sc1
    buffer_load_dwordx4 v[132:135], v1, s[20:23], s35 offen offset:1024 sc1
    s_waitcnt vmcnt(10) lgkmcnt(5)
    v_mfma_f32_16x16x32_bf16 v[32:35], v[168:171], v[88:91], 0
    ds_read_b128 v[204:207], v9 offset:9216
    v_mfma_f32_16x16x32_bf16 v[60:63], v[168:171], v[92:95], 0
    v_mfma_f32_16x16x32_bf16 v[36:39], v[172:175], v[88:91], 0
    ds_read_b128 v[208:211], v9 offset:10240
    v_mfma_f32_16x16x32_bf16 v[64:67], v[172:175], v[92:95], 0
    buffer_load_dwordx4 v[136:139], v1, s[20:23], s34 offen offset:2048 sc1
    v_mfma_f32_16x16x32_bf16 v[40:43], v[176:179], v[88:91], 0
    ds_read_b128 v[168:171], v9 offset:11264
    v_mfma_f32_16x16x32_bf16 v[68:71], v[176:179], v[92:95], 0
    v_mfma_f32_16x16x32_bf16 v[44:47], v[180:183], v[88:91], 0
    ds_read_b128 v[172:175], v9 offset:12288
    v_mfma_f32_16x16x32_bf16 v[72:75], v[180:183], v[92:95], 0
    s_waitcnt lgkmcnt(6)
    v_mfma_f32_16x16x32_bf16 v[48:51], v[184:187], v[88:91], 0
    ds_read_b128 v[176:179], v9 offset:13312
    v_mfma_f32_16x16x32_bf16 v[76:79], v[184:187], v[92:95], 0
    buffer_load_dwordx4 v[140:143], v1, s[20:23], s35 offen offset:2048 sc1
    v_mfma_f32_16x16x32_bf16 v[52:55], v[188:191], v[88:91], 0
    ds_read_b128 v[180:183], v9 offset:14336
    v_mfma_f32_16x16x32_bf16 v[80:83], v[188:191], v[92:95], 0
    v_mfma_f32_16x16x32_bf16 v[56:59], v[192:195], v[88:91], 0
    ds_read_b128 v[184:187], v9 offset:15360
    v_mfma_f32_16x16x32_bf16 v[84:87], v[192:195], v[92:95], 0
    buffer_load_dwordx4 v[144:147], v1, s[20:23], s34 offen offset:3072 sc1
    s_add_u32 s34, s34, 4096
    s_waitcnt vmcnt(11) lgkmcnt(5)
    v_mfma_f32_16x16x32_bf16 v[32:35], v[196:199], v[96:99], v[32:35]
    ds_read_b128 v[188:191], v9 offset:16384
    v_mfma_f32_16x16x32_bf16 v[60:63], v[196:199], v[100:103], v[60:63]
    buffer_load_dwordx2 v[12:13], v8, s[20:23], s38 offen offset:0 sc1
    v_mfma_f32_16x16x32_bf16 v[36:39], v[200:203], v[96:99], v[36:39]
    ds_read_b128 v[192:195], v9 offset:17408
    v_mfma_f32_16x16x32_bf16 v[64:67], v[200:203], v[100:103], v[64:67]
    buffer_load_dwordx4 v[148:151], v1, s[20:23], s35 offen offset:3072 sc1
    s_add_u32 s35, s35, 4096
    v_mfma_f32_16x16x32_bf16 v[40:43], v[204:207], v[96:99], v[40:43]
    ds_read_b128 v[196:199], v9 offset:18432
    v_mfma_f32_16x16x32_bf16 v[68:71], v[204:207], v[100:103], v[68:71]
    buffer_load_dwordx2 v[14:15], v8, s[20:23], s38 offen offset:128 sc1
    v_mfma_f32_16x16x32_bf16 v[44:47], v[208:211], v[96:99], v[44:47]
    ds_read_b128 v[200:203], v9 offset:19456
    v_mfma_f32_16x16x32_bf16 v[72:75], v[208:211], v[100:103], v[72:75]
    buffer_load_dwordx2 v[22:23], v8, s[20:23], s38 offen offset:1024 sc1
    s_waitcnt lgkmcnt(6)
    v_mfma_f32_16x16x32_bf16 v[48:51], v[168:171], v[96:99], v[48:51]
    ds_read_b128 v[204:207], v9 offset:20480
    v_mfma_f32_16x16x32_bf16 v[76:79], v[168:171], v[100:103], v[76:79]
    buffer_load_dwordx4 v[152:155], v1, s[20:23], s34 offen offset:0 sc1
    v_mfma_f32_16x16x32_bf16 v[52:55], v[172:175], v[96:99], v[52:55]
    ds_read_b128 v[208:211], v9 offset:21504
    v_mfma_f32_16x16x32_bf16 v[80:83], v[172:175], v[100:103], v[80:83]
    buffer_load_dwordx2 v[24:25], v8, s[20:23], s38 offen offset:1152 sc1
    v_mfma_f32_16x16x32_bf16 v[56:59], v[176:179], v[96:99], v[56:59]
    ds_read_b128 v[168:171], v9 offset:22528
    v_mfma_f32_16x16x32_bf16 v[84:87], v[176:179], v[100:103], v[84:87]
    s_waitcnt vmcnt(15) lgkmcnt(5)
    v_mfma_f32_16x16x32_bf16 v[32:35], v[180:183], v[104:107], v[32:35]
    ds_read_b128 v[172:175], v9 offset:23552
    v_mfma_f32_16x16x32_bf16 v[60:63], v[180:183], v[108:111], v[60:63]
    v_mfma_f32_16x16x32_bf16 v[36:39], v[184:187], v[104:107], v[36:39]
    ds_read_b128 v[176:179], v9 offset:24576
    v_mfma_f32_16x16x32_bf16 v[64:67], v[184:187], v[108:111], v[64:67]
    buffer_load_dwordx4 v[156:159], v1, s[20:23], s35 offen offset:0 sc1
    v_mfma_f32_16x16x32_bf16 v[40:43], v[188:191], v[104:107], v[40:43]
    ds_read_b128 v[180:183], v9 offset:25600
    v_mfma_f32_16x16x32_bf16 v[68:71], v[188:191], v[108:111], v[68:71]
    v_mfma_f32_16x16x32_bf16 v[44:47], v[192:195], v[104:107], v[44:47]
    ds_read_b128 v[184:187], v9 offset:26624
    v_mfma_f32_16x16x32_bf16 v[72:75], v[192:195], v[108:111], v[72:75]
    s_waitcnt lgkmcnt(6)
    v_mfma_f32_16x16x32_bf16 v[48:51], v[196:199], v[104:107], v[48:51]
    ds_read_b128 v[188:191], v9 offset:27648
    v_mfma_f32_16x16x32_bf16 v[76:79], v[196:199], v[108:111], v[76:79]
    buffer_load_dwordx4 v[160:163], v1, s[20:23], s34 offen offset:1024 sc1
    v_mfma_f32_16x16x32_bf16 v[52:55], v[200:203], v[104:107], v[52:55]
    ds_read_b128 v[192:195], v9 offset:28672
    v_mfma_f32_16x16x32_bf16 v[80:83], v[200:203], v[108:111], v[80:83]
    v_mfma_f32_16x16x32_bf16 v[56:59], v[204:207], v[104:107], v[56:59]
    ds_read_b128 v[196:199], v9 offset:29696
    v_mfma_f32_16x16x32_bf16 v[84:87], v[204:207], v[108:111], v[84:87]
    buffer_load_dwordx4 v[164:167], v1, s[20:23], s35 offen offset:1024 sc1
    s_waitcnt vmcnt(16) lgkmcnt(5)
    v_mfma_f32_16x16x32_bf16 v[32:35], v[208:211], v[112:115], v[32:35]
    ds_read_b128 v[200:203], v9 offset:30720
    v_mfma_f32_16x16x32_bf16 v[60:63], v[208:211], v[116:119], v[60:63]
    v_mfma_f32_16x16x32_bf16 v[36:39], v[168:171], v[112:115], v[36:39]
    ds_read_b128 v[204:207], v9 offset:31744
    v_mfma_f32_16x16x32_bf16 v[64:67], v[168:171], v[116:119], v[64:67]
    buffer_load_dwordx4 v[88:91], v1, s[20:23], s34 offen offset:2048 sc1
    v_mfma_f32_16x16x32_bf16 v[40:43], v[172:175], v[112:115], v[40:43]
    ds_read_b128 v[208:211], v9 offset:32768
    v_mfma_f32_16x16x32_bf16 v[68:71], v[172:175], v[116:119], v[68:71]
    v_mfma_f32_16x16x32_bf16 v[44:47], v[176:179], v[112:115], v[44:47]
    ds_read_b128 v[168:171], v9 offset:33792
    v_mfma_f32_16x16x32_bf16 v[72:75], v[176:179], v[116:119], v[72:75]
    s_waitcnt lgkmcnt(6)
    v_mfma_f32_16x16x32_bf16 v[48:51], v[180:183], v[112:115], v[48:51]
    ds_read_b128 v[172:175], v9 offset:34816
    v_mfma_f32_16x16x32_bf16 v[76:79], v[180:183], v[116:119], v[76:79]
    buffer_load_dwordx4 v[92:95], v1, s[20:23], s35 offen offset:2048 sc1
    v_mfma_f32_16x16x32_bf16 v[52:55], v[184:187], v[112:115], v[52:55]
    ds_read_b128 v[176:179], v9 offset:35840
    v_mfma_f32_16x16x32_bf16 v[80:83], v[184:187], v[116:119], v[80:83]
    v_mfma_f32_16x16x32_bf16 v[56:59], v[188:191], v[112:115], v[56:59]
    ds_read_b128 v[180:183], v9 offset:36864
    v_mfma_f32_16x16x32_bf16 v[84:87], v[188:191], v[116:119], v[84:87]
    s_waitcnt vmcnt(16) lgkmcnt(5)
    v_mfma_f32_16x16x32_bf16 v[32:35], v[192:195], v[120:123], v[32:35]
    ds_read_b128 v[184:187], v9 offset:37888
    v_mfma_f32_16x16x32_bf16 v[60:63], v[192:195], v[124:127], v[60:63]
    v_mfma_f32_16x16x32_bf16 v[36:39], v[196:199], v[120:123], v[36:39]
    ds_read_b128 v[188:191], v9 offset:38912
    v_mfma_f32_16x16x32_bf16 v[64:67], v[196:199], v[124:127], v[64:67]
    buffer_load_dwordx4 v[96:99], v1, s[20:23], s34 offen offset:3072 sc1
    s_add_u32 s34, s34, 4096
    v_mfma_f32_16x16x32_bf16 v[40:43], v[200:203], v[120:123], v[40:43]
    ds_read_b128 v[192:195], v9 offset:39936
    v_mfma_f32_16x16x32_bf16 v[68:71], v[200:203], v[124:127], v[68:71]
    v_mfma_f32_16x16x32_bf16 v[44:47], v[204:207], v[120:123], v[44:47]
    ds_read_b128 v[196:199], v9 offset:40960
    v_mfma_f32_16x16x32_bf16 v[72:75], v[204:207], v[124:127], v[72:75]
    s_waitcnt lgkmcnt(6)
    v_mfma_f32_16x16x32_bf16 v[48:51], v[208:211], v[120:123], v[48:51]
    ds_read_b128 v[200:203], v9 offset:41984
    v_mfma_f32_16x16x32_bf16 v[76:79], v[208:211], v[124:127], v[76:79]
    buffer_load_dwordx4 v[100:103], v1, s[20:23], s35 offen offset:3072 sc1
    s_add_u32 s35, s35, 4096
    v_mfma_f32_16x16x32_bf16 v[52:55], v[168:171], v[120:123], v[52:55]
    ds_read_b128 v[204:207], v9 offset:43008
    v_mfma_f32_16x16x32_bf16 v[80:83], v[168:171], v[124:127], v[80:83]
    v_mfma_f32_16x16x32_bf16 v[56:59], v[172:175], v[120:123], v[56:59]
    ds_read_b128 v[208:211], v9 offset:44032
    v_mfma_f32_16x16x32_bf16 v[84:87], v[172:175], v[124:127], v[84:87]
    buffer_load_dwordx4 v[104:107], v1, s[20:23], s34 offen offset:0 sc1
    s_waitcnt vmcnt(17) lgkmcnt(5)
    v_mfma_f32_16x16x32_bf16 v[32:35], v[176:179], v[128:131], v[32:35]
    ds_read_b128 v[168:171], v9 offset:45056
    v_mfma_f32_16x16x32_bf16 v[60:63], v[176:179], v[132:135], v[60:63]
    v_mfma_f32_16x16x32_bf16 v[36:39], v[180:183], v[128:131], v[36:39]
    ds_read_b128 v[172:175], v9 offset:46080
    v_mfma_f32_16x16x32_bf16 v[64:67], v[180:183], v[132:135], v[64:67]
    buffer_load_dwordx4 v[108:111], v1, s[20:23], s35 offen offset:0 sc1
    v_mfma_f32_16x16x32_bf16 v[40:43], v[184:187], v[128:131], v[40:43]
    ds_read_b128 v[176:179], v9 offset:47104
    v_mfma_f32_16x16x32_bf16 v[68:71], v[184:187], v[132:135], v[68:71]
    v_mfma_f32_16x16x32_bf16 v[44:47], v[188:191], v[128:131], v[44:47]
    ds_read_b128 v[180:183], v9 offset:48128
    v_mfma_f32_16x16x32_bf16 v[72:75], v[188:191], v[132:135], v[72:75]
    s_waitcnt lgkmcnt(6)
    v_mfma_f32_16x16x32_bf16 v[48:51], v[192:195], v[128:131], v[48:51]
    ds_read_b128 v[184:187], v9 offset:49152
    v_mfma_f32_16x16x32_bf16 v[76:79], v[192:195], v[132:135], v[76:79]
    buffer_load_dwordx4 v[112:115], v1, s[20:23], s34 offen offset:1024 sc1
    v_mfma_f32_16x16x32_bf16 v[52:55], v[196:199], v[128:131], v[52:55]
    ds_read_b128 v[188:191], v9 offset:50176
    v_mfma_f32_16x16x32_bf16 v[80:83], v[196:199], v[132:135], v[80:83]
    v_mfma_f32_16x16x32_bf16 v[56:59], v[200:203], v[128:131], v[56:59]
    ds_read_b128 v[192:195], v9 offset:51200
    v_mfma_f32_16x16x32_bf16 v[84:87], v[200:203], v[132:135], v[84:87]
    s_waitcnt vmcnt(17) lgkmcnt(5)
    v_mfma_f32_16x16x32_bf16 v[32:35], v[204:207], v[136:139], v[32:35]
    ds_read_b128 v[196:199], v9 offset:52224
    v_mfma_f32_16x16x32_bf16 v[60:63], v[204:207], v[140:143], v[60:63]
    v_mfma_f32_16x16x32_bf16 v[36:39], v[208:211], v[136:139], v[36:39]
    ds_read_b128 v[200:203], v9 offset:53248
    v_mfma_f32_16x16x32_bf16 v[64:67], v[208:211], v[140:143], v[64:67]
    buffer_load_dwordx4 v[116:119], v1, s[20:23], s35 offen offset:1024 sc1
    v_mfma_f32_16x16x32_bf16 v[40:43], v[168:171], v[136:139], v[40:43]
    ds_read_b128 v[204:207], v9 offset:54272
    v_mfma_f32_16x16x32_bf16 v[68:71], v[168:171], v[140:143], v[68:71]
    v_mfma_f32_16x16x32_bf16 v[44:47], v[172:175], v[136:139], v[44:47]
    ds_read_b128 v[208:211], v9 offset:55296
    v_mfma_f32_16x16x32_bf16 v[72:75], v[172:175], v[140:143], v[72:75]
    s_waitcnt lgkmcnt(6)
    v_mfma_f32_16x16x32_bf16 v[48:51], v[176:179], v[136:139], v[48:51]
    ds_read_b128 v[168:171], v9 offset:56320
    v_mfma_f32_16x16x32_bf16 v[76:79], v[176:179], v[140:143], v[76:79]
    buffer_load_dwordx4 v[120:123], v1, s[20:23], s34 offen offset:2048 sc1
    s_barrier
    v_mfma_f32_16x16x32_bf16 v[52:55], v[180:183], v[136:139], v[52:55]
    ds_read_b128 v[172:175], v1 offset:0
    v_mfma_f32_16x16x32_bf16 v[80:83], v[180:183], v[140:143], v[80:83]
    v_mfma_f32_16x16x32_bf16 v[56:59], v[184:187], v[136:139], v[56:59]
    ds_read_b128 v[176:179], v1 offset:1024
    v_mfma_f32_16x16x32_bf16 v[84:87], v[184:187], v[140:143], v[84:87]
    buffer_load_dwordx4 v[124:127], v1, s[20:23], s35 offen offset:2048 sc1
    s_waitcnt vmcnt(17) lgkmcnt(5)
    v_mfma_f32_16x16x32_bf16 v[32:35], v[188:191], v[144:147], v[32:35]
    ds_read_b128 v[180:183], v1 offset:2048
    v_mfma_f32_16x16x32_bf16 v[60:63], v[188:191], v[148:151], v[60:63]
    v_mfma_f32_16x16x32_bf16 v[36:39], v[192:195], v[144:147], v[36:39]
    ds_read_b128 v[184:187], v1 offset:3072
    v_mfma_f32_16x16x32_bf16 v[64:67], v[192:195], v[148:151], v[64:67]
    buffer_load_dwordx4 v[128:131], v1, s[20:23], s34 offen offset:3072 sc1
    s_add_u32 s34, s34, 4096
    v_mfma_f32_16x16x32_bf16 v[40:43], v[196:199], v[144:147], v[40:43]
    ds_read_b128 v[188:191], v1 offset:4096
    v_mfma_f32_16x16x32_bf16 v[68:71], v[196:199], v[148:151], v[68:71]
    v_mfma_f32_16x16x32_bf16 v[44:47], v[200:203], v[144:147], v[44:47]
    ds_read_b128 v[192:195], v1 offset:5120
    v_mfma_f32_16x16x32_bf16 v[72:75], v[200:203], v[148:151], v[72:75]
    s_waitcnt lgkmcnt(6)
    v_mfma_f32_16x16x32_bf16 v[48:51], v[204:207], v[144:147], v[48:51]
    ds_read_b128 v[196:199], v1 offset:6144
    v_mfma_f32_16x16x32_bf16 v[76:79], v[204:207], v[148:151], v[76:79]
    buffer_load_dwordx4 v[132:135], v1, s[20:23], s35 offen offset:3072 sc1
    s_add_u32 s35, s35, 4096
    v_mfma_f32_16x16x32_bf16 v[52:55], v[208:211], v[144:147], v[52:55]
    ds_read_b128 v[200:203], v1 offset:7168
    v_mfma_f32_16x16x32_bf16 v[80:83], v[208:211], v[148:151], v[80:83]
    v_mfma_f32_16x16x32_bf16 v[56:59], v[168:171], v[144:147], v[56:59]
    ds_read_b128 v[204:207], v1 offset:8192
    v_mfma_f32_16x16x32_bf16 v[84:87], v[168:171], v[148:151], v[84:87]
    s_waitcnt vmcnt(14) lgkmcnt(5)
    v_mfma_f32_16x16x32_bf16 v[32:35], v[172:175], v[152:155], v[32:35]
    ds_read_b128 v[208:211], v1 offset:9216
    v_mfma_f32_16x16x32_bf16 v[60:63], v[172:175], v[156:159], v[60:63]
    v_mfma_f32_16x16x32_bf16 v[36:39], v[176:179], v[152:155], v[36:39]
    ds_read_b128 v[168:171], v1 offset:10240
    v_mfma_f32_16x16x32_bf16 v[64:67], v[176:179], v[156:159], v[64:67]
    buffer_load_dwordx4 v[136:139], v1, s[20:23], s34 offen offset:0 sc1
    v_mfma_f32_16x16x32_bf16 v[40:43], v[180:183], v[152:155], v[40:43]
    ds_read_b128 v[172:175], v1 offset:11264
    v_mfma_f32_16x16x32_bf16 v[68:71], v[180:183], v[156:159], v[68:71]
    v_mfma_f32_16x16x32_bf16 v[44:47], v[184:187], v[152:155], v[44:47]
    ds_read_b128 v[176:179], v1 offset:12288
    v_mfma_f32_16x16x32_bf16 v[72:75], v[184:187], v[156:159], v[72:75]
    s_waitcnt lgkmcnt(6)
    v_mfma_f32_16x16x32_bf16 v[48:51], v[188:191], v[152:155], v[48:51]
    ds_read_b128 v[180:183], v1 offset:13312
    v_mfma_f32_16x16x32_bf16 v[76:79], v[188:191], v[156:159], v[76:79]
    buffer_load_dwordx4 v[140:143], v1, s[20:23], s35 offen offset:0 sc1
    v_mfma_f32_16x16x32_bf16 v[52:55], v[192:195], v[152:155], v[52:55]
    ds_read_b128 v[184:187], v1 offset:14336
    v_mfma_f32_16x16x32_bf16 v[80:83], v[192:195], v[156:159], v[80:83]
    v_mfma_f32_16x16x32_bf16 v[56:59], v[196:199], v[152:155], v[56:59]
    ds_read_b128 v[188:191], v1 offset:15360
    v_mfma_f32_16x16x32_bf16 v[84:87], v[196:199], v[156:159], v[84:87]
    buffer_load_dwordx4 v[144:147], v1, s[20:23], s34 offen offset:1024 sc1
    s_waitcnt vmcnt(15) lgkmcnt(5)
    v_mfma_f32_16x16x32_bf16 v[32:35], v[200:203], v[160:163], v[32:35]
    ds_read_b128 v[192:195], v1 offset:16384
    v_mfma_f32_16x16x32_bf16 v[60:63], v[200:203], v[164:167], v[60:63]
    v_mfma_f32_16x16x32_bf16 v[36:39], v[204:207], v[160:163], v[36:39]
    ds_read_b128 v[196:199], v1 offset:17408
    v_mfma_f32_16x16x32_bf16 v[64:67], v[204:207], v[164:167], v[64:67]
    buffer_load_dwordx4 v[148:151], v1, s[20:23], s35 offen offset:1024 sc1
    v_mfma_f32_16x16x32_bf16 v[40:43], v[208:211], v[160:163], v[40:43]
    ds_read_b128 v[200:203], v1 offset:18432
    v_mfma_f32_16x16x32_bf16 v[68:71], v[208:211], v[164:167], v[68:71]
    v_mfma_f32_16x16x32_bf16 v[44:47], v[168:171], v[160:163], v[44:47]
    ds_read_b128 v[204:207], v1 offset:19456
    v_mfma_f32_16x16x32_bf16 v[72:75], v[168:171], v[164:167], v[72:75]
    s_waitcnt lgkmcnt(6)
    v_mfma_f32_16x16x32_bf16 v[48:51], v[172:175], v[160:163], v[48:51]
    ds_read_b128 v[208:211], v1 offset:20480
    v_mfma_f32_16x16x32_bf16 v[76:79], v[172:175], v[164:167], v[76:79]
    buffer_load_dwordx4 v[152:155], v1, s[20:23], s34 offen offset:2048 sc1
    v_mfma_f32_16x16x32_bf16 v[52:55], v[176:179], v[160:163], v[52:55]
    ds_read_b128 v[168:171], v1 offset:21504
    v_mfma_f32_16x16x32_bf16 v[80:83], v[176:179], v[164:167], v[80:83]
    v_mfma_f32_16x16x32_bf16 v[56:59], v[180:183], v[160:163], v[56:59]
    ds_read_b128 v[172:175], v1 offset:22528
    v_mfma_f32_16x16x32_bf16 v[84:87], v[180:183], v[164:167], v[84:87]
    s_barrier
    s_waitcnt vmcnt(15) lgkmcnt(5)
    v_mfma_f32_16x16x32_bf16 v[32:35], v[184:187], v[88:91], v[32:35]
    ds_read_b128 v[176:179], v1 offset:23552
    v_mfma_f32_16x16x32_bf16 v[60:63], v[184:187], v[92:95], v[60:63]
    v_mfma_f32_16x16x32_bf16 v[36:39], v[188:191], v[88:91], v[36:39]
    ds_read_b128 v[180:183], v1 offset:24576
    v_mfma_f32_16x16x32_bf16 v[64:67], v[188:191], v[92:95], v[64:67]
    buffer_load_dwordx4 v[156:159], v1, s[20:23], s35 offen offset:2048 sc1
    v_mfma_f32_16x16x32_bf16 v[40:43], v[192:195], v[88:91], v[40:43]
    ds_read_b128 v[184:187], v1 offset:25600
    v_mfma_f32_16x16x32_bf16 v[68:71], v[192:195], v[92:95], v[68:71]
    v_mfma_f32_16x16x32_bf16 v[44:47], v[196:199], v[88:91], v[44:47]
    ds_read_b128 v[188:191], v1 offset:26624
    v_mfma_f32_16x16x32_bf16 v[72:75], v[196:199], v[92:95], v[72:75]
    s_waitcnt lgkmcnt(6)
    v_mfma_f32_16x16x32_bf16 v[48:51], v[200:203], v[88:91], v[48:51]
    ds_read_b128 v[192:195], v1 offset:27648
    v_mfma_f32_16x16x32_bf16 v[76:79], v[200:203], v[92:95], v[76:79]
    buffer_load_dwordx4 v[160:163], v1, s[20:23], s34 offen offset:3072 sc1
    s_add_u32 s34, s34, 4096
    v_mfma_f32_16x16x32_bf16 v[52:55], v[204:207], v[88:91], v[52:55]
    ds_read_b128 v[196:199], v1 offset:28672
    v_mfma_f32_16x16x32_bf16 v[80:83], v[204:207], v[92:95], v[80:83]
    v_mfma_f32_16x16x32_bf16 v[56:59], v[208:211], v[88:91], v[56:59]
    ds_read_b128 v[200:203], v1 offset:29696
    v_mfma_f32_16x16x32_bf16 v[84:87], v[208:211], v[92:95], v[84:87]
    buffer_load_dwordx4 v[164:167], v1, s[20:23], s35 offen offset:3072 sc1
    s_add_u32 s35, s35, 4096
    s_waitcnt vmcnt(16) lgkmcnt(5)
    v_mfma_f32_16x16x32_bf16 v[32:35], v[168:171], v[96:99], v[32:35]
    ds_read_b128 v[204:207], v1 offset:30720
    v_mfma_f32_16x16x32_bf16 v[60:63], v[168:171], v[100:103], v[60:63]
    v_add_f32 v12, v12, v14
    v_mfma_f32_16x16x32_bf16 v[36:39], v[172:175], v[96:99], v[36:39]
    ds_read_b128 v[208:211], v1 offset:31744
    v_mfma_f32_16x16x32_bf16 v[64:67], v[172:175], v[100:103], v[64:67]
    v_add_f32 v13, v13, v15
    v_mfma_f32_16x16x32_bf16 v[40:43], v[176:179], v[96:99], v[40:43]
    ds_read_b128 v[168:171], v1 offset:32768
    v_mfma_f32_16x16x32_bf16 v[68:71], v[176:179], v[100:103], v[68:71]
    v_add_f32 v22, v22, v24
    v_mfma_f32_16x16x32_bf16 v[44:47], v[180:183], v[96:99], v[44:47]
    ds_read_b128 v[172:175], v1 offset:33792
    v_mfma_f32_16x16x32_bf16 v[72:75], v[180:183], v[100:103], v[72:75]
    v_add_f32 v23, v23, v25
    s_waitcnt lgkmcnt(6)
    v_mfma_f32_16x16x32_bf16 v[48:51], v[184:187], v[96:99], v[48:51]
    ds_read_b128 v[176:179], v1 offset:34816
    v_mfma_f32_16x16x32_bf16 v[76:79], v[184:187], v[100:103], v[76:79]
    v_permlane32_swap_b32 v12, v22
    v_mfma_f32_16x16x32_bf16 v[52:55], v[188:191], v[96:99], v[52:55]
    ds_read_b128 v[180:183], v1 offset:35840
    v_mfma_f32_16x16x32_bf16 v[80:83], v[188:191], v[100:103], v[80:83]
    v_permlane32_swap_b32 v13, v23
    v_mfma_f32_16x16x32_bf16 v[56:59], v[192:195], v[96:99], v[56:59]
    ds_read_b128 v[184:187], v1 offset:36864
    v_mfma_f32_16x16x32_bf16 v[84:87], v[192:195], v[100:103], v[84:87]
    v_add_f32 v12, v12, v22
    s_waitcnt vmcnt(14) lgkmcnt(5)
    v_mfma_f32_16x16x32_bf16 v[32:35], v[196:199], v[104:107], v[32:35]
    ds_read_b128 v[188:191], v1 offset:37888
    v_mfma_f32_16x16x32_bf16 v[60:63], v[196:199], v[108:111], v[60:63]
    v_add_f32 v13, v13, v23
    v_mfma_f32_16x16x32_bf16 v[36:39], v[200:203], v[104:107], v[36:39]
    ds_read_b128 v[192:195], v1 offset:38912
    v_mfma_f32_16x16x32_bf16 v[64:67], v[200:203], v[108:111], v[64:67]
    v_mov_b32 v14, v12
    v_mfma_f32_16x16x32_bf16 v[40:43], v[204:207], v[104:107], v[40:43]
    ds_read_b128 v[196:199], v1 offset:39936
    v_mfma_f32_16x16x32_bf16 v[68:71], v[204:207], v[108:111], v[68:71]
    v_mov_b32 v15, v13
    v_mfma_f32_16x16x32_bf16 v[44:47], v[208:211], v[104:107], v[44:47]
    ds_read_b128 v[200:203], v1 offset:40960
    v_mfma_f32_16x16x32_bf16 v[72:75], v[208:211], v[108:111], v[72:75]
    v_permlane16_swap_b32 v12, v14
    s_waitcnt lgkmcnt(6)
    v_mfma_f32_16x16x32_bf16 v[48:51], v[168:171], v[104:107], v[48:51]
    ds_read_b128 v[204:207], v1 offset:41984
    v_mfma_f32_16x16x32_bf16 v[76:79], v[168:171], v[108:111], v[76:79]
    v_permlane16_swap_b32 v13, v15
    v_mfma_f32_16x16x32_bf16 v[52:55], v[172:175], v[104:107], v[52:55]
    ds_read_b128 v[208:211], v1 offset:43008
    v_mfma_f32_16x16x32_bf16 v[80:83], v[172:175], v[108:111], v[80:83]
    v_add_f32 v12, v12, v14
    v_mfma_f32_16x16x32_bf16 v[56:59], v[176:179], v[104:107], v[56:59]
    ds_read_b128 v[168:171], v1 offset:44032
    v_mfma_f32_16x16x32_bf16 v[84:87], v[176:179], v[108:111], v[84:87]
    v_add_f32 v13, v13, v15
    s_waitcnt vmcnt(12) lgkmcnt(5)
    v_mfma_f32_16x16x32_bf16 v[32:35], v[180:183], v[112:115], v[32:35]
    ds_read_b128 v[172:175], v1 offset:45056
    v_mfma_f32_16x16x32_bf16 v[60:63], v[180:183], v[116:119], v[60:63]
    v_mul_f32 v12, 0x3acccccd, v12
    v_mfma_f32_16x16x32_bf16 v[36:39], v[184:187], v[112:115], v[36:39]
    ds_read_b128 v[176:179], v1 offset:46080
    v_mfma_f32_16x16x32_bf16 v[64:67], v[184:187], v[116:119], v[64:67]
    v_mul_f32 v13, 0x3acccccd, v13
    v_mfma_f32_16x16x32_bf16 v[40:43], v[188:191], v[112:115], v[40:43]
    ds_read_b128 v[180:183], v1 offset:47104
    v_mfma_f32_16x16x32_bf16 v[68:71], v[188:191], v[116:119], v[68:71]
    v_fma_f32 v13, -v12, v12, v13
    v_mfma_f32_16x16x32_bf16 v[44:47], v[192:195], v[112:115], v[44:47]
    ds_read_b128 v[184:187], v1 offset:48128
    v_mfma_f32_16x16x32_bf16 v[72:75], v[192:195], v[116:119], v[72:75]
    v_max_f32 v13, 0, v13
    s_waitcnt lgkmcnt(6)
    v_mfma_f32_16x16x32_bf16 v[48:51], v[196:199], v[112:115], v[48:51]
    ds_read_b128 v[188:191], v1 offset:49152
    v_mfma_f32_16x16x32_bf16 v[76:79], v[196:199], v[116:119], v[76:79]
    v_cvt_pk_bf16_f32 v13, v13, v13
    v_mfma_f32_16x16x32_bf16 v[52:55], v[200:203], v[112:115], v[52:55]
    ds_read_b128 v[192:195], v1 offset:50176
    v_mfma_f32_16x16x32_bf16 v[80:83], v[200:203], v[116:119], v[80:83]
    v_lshlrev_b32 v13, 16, v13
    v_mfma_f32_16x16x32_bf16 v[56:59], v[204:207], v[112:115], v[56:59]
    ds_read_b128 v[196:199], v1 offset:51200
    v_mfma_f32_16x16x32_bf16 v[84:87], v[204:207], v[116:119], v[84:87]
    v_add_f32 v13, 0x3727c5ac, v13
    s_waitcnt vmcnt(10) lgkmcnt(5)
    v_mfma_f32_16x16x32_bf16 v[32:35], v[208:211], v[120:123], v[32:35]
    ds_read_b128 v[200:203], v1 offset:52224
    v_mfma_f32_16x16x32_bf16 v[60:63], v[208:211], v[124:127], v[60:63]
    v_cvt_pk_bf16_f32 v13, v13, v13
    v_mfma_f32_16x16x32_bf16 v[36:39], v[168:171], v[120:123], v[36:39]
    ds_read_b128 v[204:207], v1 offset:53248
    v_mfma_f32_16x16x32_bf16 v[64:67], v[168:171], v[124:127], v[64:67]
    v_lshlrev_b32 v13, 16, v13
    v_mfma_f32_16x16x32_bf16 v[40:43], v[172:175], v[120:123], v[40:43]
    ds_read_b128 v[208:211], v1 offset:54272
    v_mfma_f32_16x16x32_bf16 v[68:71], v[172:175], v[124:127], v[68:71]
    v_sqrt_f32 v13, v13
    v_mfma_f32_16x16x32_bf16 v[44:47], v[176:179], v[120:123], v[44:47]
    ds_read_b128 v[168:171], v1 offset:55296
    v_mfma_f32_16x16x32_bf16 v[72:75], v[176:179], v[124:127], v[72:75]
    v_mul_f32 v12, 0x3e800000, v12
    s_waitcnt lgkmcnt(6)
    v_mfma_f32_16x16x32_bf16 v[48:51], v[180:183], v[120:123], v[48:51]
    ds_read_b128 v[172:175], v1 offset:56320
    v_mfma_f32_16x16x32_bf16 v[76:79], v[180:183], v[124:127], v[76:79]
    v_cvt_pk_bf16_f32 v13, v13, v13
    v_mfma_f32_16x16x32_bf16 v[52:55], v[184:187], v[120:123], v[52:55]
    ds_read_b128 v[176:179], v10 offset:0
    v_mfma_f32_16x16x32_bf16 v[80:83], v[184:187], v[124:127], v[80:83]
    v_lshlrev_b32 v13, 16, v13
    v_mfma_f32_16x16x32_bf16 v[56:59], v[188:191], v[120:123], v[56:59]
    ds_read_b128 v[180:183], v10 offset:1024
    v_mfma_f32_16x16x32_bf16 v[84:87], v[188:191], v[124:127], v[84:87]
    v_cvt_pk_bf16_f32 v14, -v12, -v12
    s_waitcnt vmcnt(8) lgkmcnt(5)
    v_mfma_f32_16x16x32_bf16 v[32:35], v[192:195], v[128:131], v[32:35]
    ds_read_b128 v[184:187], v10 offset:2048
    v_mfma_f32_16x16x32_bf16 v[60:63], v[192:195], v[132:135], v[60:63]
    v_rcp_f32 v16, v13
    v_mfma_f32_16x16x32_bf16 v[36:39], v[196:199], v[128:131], v[36:39]
    ds_read_b128 v[188:191], v10 offset:3072
    v_mfma_f32_16x16x32_bf16 v[64:67], v[196:199], v[132:135], v[64:67]
    v_mul_f32 v13, 0x3e800000, v13
    v_mfma_f32_16x16x32_bf16 v[40:43], v[200:203], v[128:131], v[40:43]
    ds_read_b128 v[192:195], v10 offset:4096
    v_mfma_f32_16x16x32_bf16 v[68:71], v[200:203], v[132:135], v[68:71]
    v_lshrrev_b32 v15, 16, v13
    v_mfma_f32_16x16x32_bf16 v[44:47], v[204:207], v[128:131], v[44:47]
    ds_read_b128 v[196:199], v10 offset:5120
    v_mfma_f32_16x16x32_bf16 v[72:75], v[204:207], v[132:135], v[72:75]
    v_mul_f32 v20, 4.0, v13
    s_waitcnt lgkmcnt(6)
    v_mfma_f32_16x16x32_bf16 v[48:51], v[208:211], v[128:131], v[48:51]
    ds_read_b128 v[200:203], v10 offset:6144
    v_mfma_f32_16x16x32_bf16 v[76:79], v[208:211], v[132:135], v[76:79]
    v_mul_f32 v18, s44, v16
    v_mfma_f32_16x16x32_bf16 v[52:55], v[168:171], v[128:131], v[52:55]
    ds_read_b128 v[204:207], v10 offset:7168
    v_mfma_f32_16x16x32_bf16 v[80:83], v[168:171], v[132:135], v[80:83]
    v_mul_f32 v19, v16, v16
    v_mfma_f32_16x16x32_bf16 v[56:59], v[172:175], v[128:131], v[56:59]
    ds_read_b128 v[208:211], v10 offset:8192
    v_mfma_f32_16x16x32_bf16 v[84:87], v[172:175], v[132:135], v[84:87]
    v_mul_f32 v19, v19, v16
    s_waitcnt vmcnt(6) lgkmcnt(5)
    v_mfma_f32_16x16x32_bf16 v[32:35], v[176:179], v[136:139], v[32:35]
    ds_read_b128 v[168:171], v10 offset:9216
    v_mfma_f32_16x16x32_bf16 v[60:63], v[176:179], v[140:143], v[60:63]
    v_mul_f32 v19, s45, v19
    v_mfma_f32_16x16x32_bf16 v[36:39], v[180:183], v[136:139], v[36:39]
    ds_read_b128 v[172:175], v10 offset:10240
    v_mfma_f32_16x16x32_bf16 v[64:67], v[180:183], v[140:143], v[64:67]
    v_mov_b32 v24, v14
    v_mfma_f32_16x16x32_bf16 v[40:43], v[184:187], v[136:139], v[40:43]
    ds_read_b128 v[176:179], v10 offset:11264
    v_mfma_f32_16x16x32_bf16 v[68:71], v[184:187], v[140:143], v[68:71]
    v_mov_b32 v25, v15
    v_mfma_f32_16x16x32_bf16 v[44:47], v[188:191], v[136:139], v[44:47]
    ds_read_b128 v[180:183], v10 offset:12288
    v_mfma_f32_16x16x32_bf16 v[72:75], v[188:191], v[140:143], v[72:75]
    v_mov_b32 v30, v20
    s_waitcnt lgkmcnt(6)
    v_mfma_f32_16x16x32_bf16 v[48:51], v[192:195], v[136:139], v[48:51]
    ds_read_b128 v[184:187], v10 offset:13312
    v_mfma_f32_16x16x32_bf16 v[76:79], v[192:195], v[140:143], v[76:79]
    v_mov_b32 v28, v18
    v_mfma_f32_16x16x32_bf16 v[52:55], v[196:199], v[136:139], v[52:55]
    ds_read_b128 v[188:191], v10 offset:14336
    v_mfma_f32_16x16x32_bf16 v[80:83], v[196:199], v[140:143], v[80:83]
    v_mov_b32 v29, v19
    v_mfma_f32_16x16x32_bf16 v[56:59], v[200:203], v[136:139], v[56:59]
    ds_read_b128 v[192:195], v10 offset:15360
    v_mfma_f32_16x16x32_bf16 v[84:87], v[200:203], v[140:143], v[84:87]
    v_permlane32_swap_b32 v14, v24
    s_waitcnt vmcnt(4) lgkmcnt(5)
    v_mfma_f32_16x16x32_bf16 v[32:35], v[204:207], v[144:147], v[32:35]
    ds_read_b128 v[196:199], v10 offset:16384
    v_mfma_f32_16x16x32_bf16 v[60:63], v[204:207], v[148:151], v[60:63]
    v_permlane32_swap_b32 v15, v25
    v_mfma_f32_16x16x32_bf16 v[36:39], v[208:211], v[144:147], v[36:39]
    ds_read_b128 v[200:203], v10 offset:17408
    v_mfma_f32_16x16x32_bf16 v[64:67], v[208:211], v[148:151], v[64:67]
    v_permlane32_swap_b32 v20, v30
    v_mfma_f32_16x16x32_bf16 v[40:43], v[168:171], v[144:147], v[40:43]
    ds_read_b128 v[204:207], v10 offset:18432
    v_mfma_f32_16x16x32_bf16 v[68:71], v[168:171], v[148:151], v[68:71]
    v_permlane32_swap_b32 v18, v28
    v_mfma_f32_16x16x32_bf16 v[44:47], v[172:175], v[144:147], v[44:47]
    ds_read_b128 v[208:211], v10 offset:19456
    v_mfma_f32_16x16x32_bf16 v[72:75], v[172:175], v[148:151], v[72:75]
    v_permlane32_swap_b32 v19, v29
    s_waitcnt lgkmcnt(6)
    v_mfma_f32_16x16x32_bf16 v[48:51], v[176:179], v[144:147], v[48:51]
    ds_read_b128 v[168:171], v10 offset:20480
    v_mfma_f32_16x16x32_bf16 v[76:79], v[176:179], v[148:151], v[76:79]
    v_mfma_f32_16x16x32_bf16 v[52:55], v[180:183], v[144:147], v[52:55]
    ds_read_b128 v[172:175], v10 offset:21504
    v_mfma_f32_16x16x32_bf16 v[80:83], v[180:183], v[148:151], v[80:83]
    v_mfma_f32_16x16x32_bf16 v[56:59], v[184:187], v[144:147], v[56:59]
    ds_read_b128 v[176:179], v10 offset:22528
    v_mfma_f32_16x16x32_bf16 v[84:87], v[184:187], v[148:151], v[84:87]
    s_waitcnt vmcnt(2) lgkmcnt(5)
    v_mfma_f32_16x16x32_bf16 v[32:35], v[188:191], v[152:155], v[32:35]
    ds_read_b128 v[180:183], v10 offset:23552
    v_mfma_f32_16x16x32_bf16 v[60:63], v[188:191], v[156:159], v[60:63]
    v_mfma_f32_16x16x32_bf16 v[36:39], v[192:195], v[152:155], v[36:39]
    ds_read_b128 v[184:187], v10 offset:24576
    v_mfma_f32_16x16x32_bf16 v[64:67], v[192:195], v[156:159], v[64:67]
    v_mfma_f32_16x16x32_bf16 v[40:43], v[196:199], v[152:155], v[40:43]
    ds_read_b128 v[188:191], v10 offset:25600
    v_mfma_f32_16x16x32_bf16 v[68:71], v[196:199], v[156:159], v[68:71]
    v_mfma_f32_16x16x32_bf16 v[44:47], v[200:203], v[152:155], v[44:47]
    ds_read_b128 v[192:195], v10 offset:26624
    v_mfma_f32_16x16x32_bf16 v[72:75], v[200:203], v[156:159], v[72:75]
    s_waitcnt lgkmcnt(6)
    v_mfma_f32_16x16x32_bf16 v[48:51], v[204:207], v[152:155], v[48:51]
    ds_read_b128 v[196:199], v10 offset:27648
    v_mfma_f32_16x16x32_bf16 v[76:79], v[204:207], v[156:159], v[76:79]
    v_mfma_f32_16x16x32_bf16 v[52:55], v[208:211], v[152:155], v[52:55]
    v_mfma_f32_16x16x32_bf16 v[80:83], v[208:211], v[156:159], v[80:83]
    v_mfma_f32_16x16x32_bf16 v[56:59], v[168:171], v[152:155], v[56:59]
    v_mfma_f32_16x16x32_bf16 v[84:87], v[168:171], v[156:159], v[84:87]
    s_waitcnt vmcnt(0) lgkmcnt(3)
    v_mfma_f32_16x16x32_bf16 v[32:35], v[172:175], v[160:163], v[32:35]
    v_mfma_f32_16x16x32_bf16 v[60:63], v[172:175], v[164:167], v[60:63]
    v_mfma_f32_16x16x32_bf16 v[36:39], v[176:179], v[160:163], v[36:39]
    v_mfma_f32_16x16x32_bf16 v[64:67], v[176:179], v[164:167], v[64:67]
    v_mfma_f32_16x16x32_bf16 v[40:43], v[180:183], v[160:163], v[40:43]
    v_mfma_f32_16x16x32_bf16 v[68:71], v[180:183], v[164:167], v[68:71]
    v_mfma_f32_16x16x32_bf16 v[44:47], v[184:187], v[160:163], v[44:47]
    v_mfma_f32_16x16x32_bf16 v[72:75], v[184:187], v[164:167], v[72:75]
    s_waitcnt lgkmcnt(0)
    v_mfma_f32_16x16x32_bf16 v[48:51], v[188:191], v[160:163], v[48:51]
    v_mfma_f32_16x16x32_bf16 v[76:79], v[188:191], v[164:167], v[76:79]
    v_mfma_f32_16x16x32_bf16 v[52:55], v[192:195], v[160:163], v[52:55]
    v_mfma_f32_16x16x32_bf16 v[80:83], v[192:195], v[164:167], v[80:83]
    s_barrier
    v_mfma_f32_16x16x32_bf16 v[56:59], v[196:199], v[160:163], v[56:59]
    v_mfma_f32_16x16x32_bf16 v[84:87], v[196:199], v[164:167], v[84:87]
    s_nop 0
    v_mfma_f32_16x16x16_bf16 v[32:35], v[212:213], v[14:15], v[32:35]
    v_mfma_f32_16x16x16_bf16 v[36:39], v[214:215], v[14:15], v[36:39]
    v_mfma_f32_16x16x16_bf16 v[60:63], v[212:213], v[24:25], v[60:63]
    v_mfma_f32_16x16x16_bf16 v[64:67], v[214:215], v[24:25], v[64:67]
    s_nop 4
    s_add_u32 s37, s36, 55296
    v_pk_mul_f32 v[96:97], v[32:33], v[32:33]
    v_pk_mul_f32 v[98:99], v[34:35], v[34:35]
    v_pk_mul_f32 v[100:101], v[36:37], v[36:37]
    v_pk_mul_f32 v[102:103], v[38:39], v[38:39]
    v_pk_fma_f32 v[96:97], v[96:97], v[18:19], v[18:19] op_sel:[0,1,0] op_sel_hi:[1,1,0]
    v_pk_fma_f32 v[98:99], v[98:99], v[18:19], v[18:19] op_sel:[0,1,0] op_sel_hi:[1,1,0]
    v_pk_fma_f32 v[100:101], v[100:101], v[18:19], v[18:19] op_sel:[0,1,0] op_sel_hi:[1,1,0]
    v_pk_fma_f32 v[102:103], v[102:103], v[18:19], v[18:19] op_sel:[0,1,0] op_sel_hi:[1,1,0]
    v_pk_mul_f32 v[96:97], v[96:97], v[32:33]
    v_pk_mul_f32 v[98:99], v[98:99], v[34:35]
    v_pk_mul_f32 v[100:101], v[100:101], v[36:37]
    v_pk_mul_f32 v[102:103], v[102:103], v[38:39]
    v_exp_f32 v96, v96
    v_exp_f32 v97, v97
    v_mfma_f32_16x16x16_bf16 v[40:43], v[216:217], v[14:15], v[40:43]
    v_exp_f32 v98, v98
    v_exp_f32 v99, v99
    v_exp_f32 v100, v100
    v_exp_f32 v101, v101
    v_mfma_f32_16x16x16_bf16 v[44:47], v[218:219], v[14:15], v[44:47]
    v_exp_f32 v102, v102
    v_exp_f32 v103, v103
    v_pk_fma_f32 v[96:97], v[96:97], v[20:21], v[20:21] op_sel_hi:[1,0,0]
    v_pk_fma_f32 v[98:99], v[98:99], v[20:21], v[20:21] op_sel_hi:[1,0,0]
    v_pk_fma_f32 v[100:101], v[100:101], v[20:21], v[20:21] op_sel_hi:[1,0,0]
    v_pk_fma_f32 v[102:103], v[102:103], v[20:21], v[20:21] op_sel_hi:[1,0,0]
    v_rcp_f32 v96, v96
    v_rcp_f32 v97, v97
    v_rcp_f32 v98, v98
    v_rcp_f32 v99, v99
    v_rcp_f32 v100, v100
    v_rcp_f32 v101, v101
    v_rcp_f32 v102, v102
    v_rcp_f32 v103, v103
    v_pk_mul_f32 v[32:33], v[32:33], v[96:97]
    v_pk_mul_f32 v[34:35], v[34:35], v[98:99]
    v_pk_mul_f32 v[36:37], v[36:37], v[100:101]
    v_pk_mul_f32 v[38:39], v[38:39], v[102:103]
    v_cvt_pk_bf16_f32 v112, v32, v33
    v_cvt_pk_bf16_f32 v113, v34, v35
    v_cvt_pk_bf16_f32 v114, v36, v37
    v_cvt_pk_bf16_f32 v115, v38, v39
    buffer_store_dwordx4 v[112:115], v1, s[20:23], s36 offen sc1
    s_add_u32 s36, s36, 16384
    v_pk_mul_f32 v[104:105], v[60:61], v[60:61]
    v_pk_mul_f32 v[106:107], v[62:63], v[62:63]
    v_pk_mul_f32 v[108:109], v[64:65], v[64:65]
    v_pk_mul_f32 v[110:111], v[66:67], v[66:67]
    v_pk_fma_f32 v[104:105], v[104:105], v[28:29], v[28:29] op_sel:[0,1,0] op_sel_hi:[1,1,0]
    v_pk_fma_f32 v[106:107], v[106:107], v[28:29], v[28:29] op_sel:[0,1,0] op_sel_hi:[1,1,0]
    v_pk_fma_f32 v[108:109], v[108:109], v[28:29], v[28:29] op_sel:[0,1,0] op_sel_hi:[1,1,0]
    v_pk_fma_f32 v[110:111], v[110:111], v[28:29], v[28:29] op_sel:[0,1,0] op_sel_hi:[1,1,0]
    v_pk_mul_f32 v[104:105], v[104:105], v[60:61]
    v_pk_mul_f32 v[106:107], v[106:107], v[62:63]
    v_pk_mul_f32 v[108:109], v[108:109], v[64:65]
    v_pk_mul_f32 v[110:111], v[110:111], v[66:67]
    v_exp_f32 v104, v104
    v_exp_f32 v105, v105
    v_mfma_f32_16x16x16_bf16 v[68:71], v[216:217], v[24:25], v[68:71]
    v_exp_f32 v106, v106
    v_exp_f32 v107, v107
    v_exp_f32 v108, v108
    v_exp_f32 v109, v109
    v_mfma_f32_16x16x16_bf16 v[72:75], v[218:219], v[24:25], v[72:75]
    v_exp_f32 v110, v110
    v_exp_f32 v111, v111
    v_pk_fma_f32 v[104:105], v[104:105], v[30:31], v[30:31] op_sel_hi:[1,0,0]
    v_pk_fma_f32 v[106:107], v[106:107], v[30:31], v[30:31] op_sel_hi:[1,0,0]
    v_pk_fma_f32 v[108:109], v[108:109], v[30:31], v[30:31] op_sel_hi:[1,0,0]
    v_pk_fma_f32 v[110:111], v[110:111], v[30:31], v[30:31] op_sel_hi:[1,0,0]
    v_rcp_f32 v104, v104
    v_rcp_f32 v105, v105
    v_rcp_f32 v106, v106
    v_rcp_f32 v107, v107
    v_rcp_f32 v108, v108
    v_rcp_f32 v109, v109
    v_rcp_f32 v110, v110
    v_rcp_f32 v111, v111
    v_pk_mul_f32 v[60:61], v[60:61], v[104:105]
    v_pk_mul_f32 v[62:63], v[62:63], v[106:107]
    v_pk_mul_f32 v[64:65], v[64:65], v[108:109]
    v_pk_mul_f32 v[66:67], v[66:67], v[110:111]
    v_cvt_pk_bf16_f32 v116, v60, v61
    v_cvt_pk_bf16_f32 v117, v62, v63
    v_cvt_pk_bf16_f32 v118, v64, v65
    v_cvt_pk_bf16_f32 v119, v66, v67
    buffer_store_dwordx4 v[116:119], v1, s[20:23], s37 offen sc1
    s_add_u32 s37, s37, 16384
    v_pk_mul_f32 v[96:97], v[40:41], v[40:41]
    v_pk_mul_f32 v[98:99], v[42:43], v[42:43]
    v_pk_mul_f32 v[100:101], v[44:45], v[44:45]
    v_pk_mul_f32 v[102:103], v[46:47], v[46:47]
    v_pk_fma_f32 v[96:97], v[96:97], v[18:19], v[18:19] op_sel:[0,1,0] op_sel_hi:[1,1,0]
    v_pk_fma_f32 v[98:99], v[98:99], v[18:19], v[18:19] op_sel:[0,1,0] op_sel_hi:[1,1,0]
    v_pk_fma_f32 v[100:101], v[100:101], v[18:19], v[18:19] op_sel:[0,1,0] op_sel_hi:[1,1,0]
    v_pk_fma_f32 v[102:103], v[102:103], v[18:19], v[18:19] op_sel:[0,1,0] op_sel_hi:[1,1,0]
    v_pk_mul_f32 v[96:97], v[96:97], v[40:41]
    v_pk_mul_f32 v[98:99], v[98:99], v[42:43]
    v_pk_mul_f32 v[100:101], v[100:101], v[44:45]
    v_pk_mul_f32 v[102:103], v[102:103], v[46:47]
    v_exp_f32 v96, v96
    v_exp_f32 v97, v97
    v_mfma_f32_16x16x16_bf16 v[48:51], v[220:221], v[14:15], v[48:51]
    v_exp_f32 v98, v98
    v_exp_f32 v99, v99
    v_exp_f32 v100, v100
    v_exp_f32 v101, v101
    v_mfma_f32_16x16x16_bf16 v[52:55], v[222:223], v[14:15], v[52:55]
    v_exp_f32 v102, v102
    v_exp_f32 v103, v103
    v_pk_fma_f32 v[96:97], v[96:97], v[20:21], v[20:21] op_sel_hi:[1,0,0]
    v_pk_fma_f32 v[98:99], v[98:99], v[20:21], v[20:21] op_sel_hi:[1,0,0]
    v_pk_fma_f32 v[100:101], v[100:101], v[20:21], v[20:21] op_sel_hi:[1,0,0]
    v_pk_fma_f32 v[102:103], v[102:103], v[20:21], v[20:21] op_sel_hi:[1,0,0]
    v_rcp_f32 v96, v96
    v_rcp_f32 v97, v97
    v_rcp_f32 v98, v98
    v_rcp_f32 v99, v99
    v_rcp_f32 v100, v100
    v_rcp_f32 v101, v101
    v_rcp_f32 v102, v102
    v_rcp_f32 v103, v103
    v_pk_mul_f32 v[40:41], v[40:41], v[96:97]
    v_pk_mul_f32 v[42:43], v[42:43], v[98:99]
    v_pk_mul_f32 v[44:45], v[44:45], v[100:101]
    v_pk_mul_f32 v[46:47], v[46:47], v[102:103]
    v_cvt_pk_bf16_f32 v120, v40, v41
    v_cvt_pk_bf16_f32 v121, v42, v43
    v_cvt_pk_bf16_f32 v122, v44, v45
    v_cvt_pk_bf16_f32 v123, v46, v47
    buffer_store_dwordx4 v[120:123], v1, s[20:23], s36 offen sc1
    s_add_u32 s36, s36, 16384
    v_pk_mul_f32 v[104:105], v[68:69], v[68:69]
    v_pk_mul_f32 v[106:107], v[70:71], v[70:71]
    v_pk_mul_f32 v[108:109], v[72:73], v[72:73]
    v_pk_mul_f32 v[110:111], v[74:75], v[74:75]
    v_pk_fma_f32 v[104:105], v[104:105], v[28:29], v[28:29] op_sel:[0,1,0] op_sel_hi:[1,1,0]
    v_pk_fma_f32 v[106:107], v[106:107], v[28:29], v[28:29] op_sel:[0,1,0] op_sel_hi:[1,1,0]
    v_pk_fma_f32 v[108:109], v[108:109], v[28:29], v[28:29] op_sel:[0,1,0] op_sel_hi:[1,1,0]
    v_pk_fma_f32 v[110:111], v[110:111], v[28:29], v[28:29] op_sel:[0,1,0] op_sel_hi:[1,1,0]
    v_pk_mul_f32 v[104:105], v[104:105], v[68:69]
    v_pk_mul_f32 v[106:107], v[106:107], v[70:71]
    v_pk_mul_f32 v[108:109], v[108:109], v[72:73]
    v_pk_mul_f32 v[110:111], v[110:111], v[74:75]
    v_exp_f32 v104, v104
    v_exp_f32 v105, v105
    v_mfma_f32_16x16x16_bf16 v[76:79], v[220:221], v[24:25], v[76:79]
    v_exp_f32 v106, v106
    v_exp_f32 v107, v107
    v_exp_f32 v108, v108
    v_exp_f32 v109, v109
    v_mfma_f32_16x16x16_bf16 v[80:83], v[222:223], v[24:25], v[80:83]
    v_exp_f32 v110, v110
    v_exp_f32 v111, v111
    v_pk_fma_f32 v[104:105], v[104:105], v[30:31], v[30:31] op_sel_hi:[1,0,0]
    v_pk_fma_f32 v[106:107], v[106:107], v[30:31], v[30:31] op_sel_hi:[1,0,0]
    v_pk_fma_f32 v[108:109], v[108:109], v[30:31], v[30:31] op_sel_hi:[1,0,0]
    v_pk_fma_f32 v[110:111], v[110:111], v[30:31], v[30:31] op_sel_hi:[1,0,0]
    v_rcp_f32 v104, v104
    v_rcp_f32 v105, v105
    v_rcp_f32 v106, v106
    v_rcp_f32 v107, v107
    v_rcp_f32 v108, v108
    v_rcp_f32 v109, v109
    v_rcp_f32 v110, v110
    v_rcp_f32 v111, v111
    v_pk_mul_f32 v[68:69], v[68:69], v[104:105]
    v_pk_mul_f32 v[70:71], v[70:71], v[106:107]
    v_pk_mul_f32 v[72:73], v[72:73], v[108:109]
    v_pk_mul_f32 v[74:75], v[74:75], v[110:111]
    v_cvt_pk_bf16_f32 v124, v68, v69
    v_cvt_pk_bf16_f32 v125, v70, v71
    v_cvt_pk_bf16_f32 v126, v72, v73
    v_cvt_pk_bf16_f32 v127, v74, v75
    buffer_store_dwordx4 v[124:127], v1, s[20:23], s37 offen sc1
    s_add_u32 s37, s37, 16384
    v_pk_mul_f32 v[96:97], v[48:49], v[48:49]
    v_pk_mul_f32 v[98:99], v[50:51], v[50:51]
    v_pk_mul_f32 v[100:101], v[52:53], v[52:53]
    v_pk_mul_f32 v[102:103], v[54:55], v[54:55]
    v_pk_fma_f32 v[96:97], v[96:97], v[18:19], v[18:19] op_sel:[0,1,0] op_sel_hi:[1,1,0]
    v_pk_fma_f32 v[98:99], v[98:99], v[18:19], v[18:19] op_sel:[0,1,0] op_sel_hi:[1,1,0]
    v_pk_fma_f32 v[100:101], v[100:101], v[18:19], v[18:19] op_sel:[0,1,0] op_sel_hi:[1,1,0]
    v_pk_fma_f32 v[102:103], v[102:103], v[18:19], v[18:19] op_sel:[0,1,0] op_sel_hi:[1,1,0]
    v_pk_mul_f32 v[96:97], v[96:97], v[48:49]
    v_pk_mul_f32 v[98:99], v[98:99], v[50:51]
    v_pk_mul_f32 v[100:101], v[100:101], v[52:53]
    v_pk_mul_f32 v[102:103], v[102:103], v[54:55]
    v_exp_f32 v96, v96
    v_exp_f32 v97, v97
    v_mfma_f32_16x16x16_bf16 v[56:59], v[224:225], v[14:15], v[56:59]
    v_exp_f32 v98, v98
    v_exp_f32 v99, v99
    v_exp_f32 v100, v100
    v_exp_f32 v101, v101
    v_mfma_f32_16x16x16_bf16 v[84:87], v[224:225], v[24:25], v[84:87]
    v_exp_f32 v102, v102
    v_exp_f32 v103, v103
    v_pk_fma_f32 v[96:97], v[96:97], v[20:21], v[20:21] op_sel_hi:[1,0,0]
    v_pk_fma_f32 v[98:99], v[98:99], v[20:21], v[20:21] op_sel_hi:[1,0,0]
    v_pk_fma_f32 v[100:101], v[100:101], v[20:21], v[20:21] op_sel_hi:[1,0,0]
    v_pk_fma_f32 v[102:103], v[102:103], v[20:21], v[20:21] op_sel_hi:[1,0,0]
    v_rcp_f32 v96, v96
    v_rcp_f32 v97, v97
    v_rcp_f32 v98, v98
    v_rcp_f32 v99, v99
    v_rcp_f32 v100, v100
    v_rcp_f32 v101, v101
    v_rcp_f32 v102, v102
    v_rcp_f32 v103, v103
    v_pk_mul_f32 v[48:49], v[48:49], v[96:97]
    v_pk_mul_f32 v[50:51], v[50:51], v[98:99]
    v_pk_mul_f32 v[52:53], v[52:53], v[100:101]
    v_pk_mul_f32 v[54:55], v[54:55], v[102:103]
    v_cvt_pk_bf16_f32 v112, v48, v49
    v_cvt_pk_bf16_f32 v113, v50, v51
    v_cvt_pk_bf16_f32 v114, v52, v53
    v_cvt_pk_bf16_f32 v115, v54, v55
    buffer_store_dwordx4 v[112:115], v1, s[20:23], s36 offen sc1
    s_add_u32 s36, s36, 16384
    s_cmp_eq_u32 s26, 0
    s_waitcnt vmcnt(3)
    s_mov_b64 exec, 1
    s_cbranch_scc1 Ug34
    buffer_store_dword v230, v231, s[20:23], s58 offen
    s_branch Ug35
Ug34:
    buffer_store_dword v230, v231, s[20:23], s58 offen sc1
Ug35:
    s_mov_b64 exec, -1
    v_pk_mul_f32 v[104:105], v[76:77], v[76:77]
    v_pk_mul_f32 v[106:107], v[78:79], v[78:79]
    v_pk_mul_f32 v[108:109], v[80:81], v[80:81]
    v_pk_mul_f32 v[110:111], v[82:83], v[82:83]
    v_pk_fma_f32 v[104:105], v[104:105], v[28:29], v[28:29] op_sel:[0,1,0] op_sel_hi:[1,1,0]
    v_pk_fma_f32 v[106:107], v[106:107], v[28:29], v[28:29] op_sel:[0,1,0] op_sel_hi:[1,1,0]
    v_pk_fma_f32 v[108:109], v[108:109], v[28:29], v[28:29] op_sel:[0,1,0] op_sel_hi:[1,1,0]
    v_pk_fma_f32 v[110:111], v[110:111], v[28:29], v[28:29] op_sel:[0,1,0] op_sel_hi:[1,1,0]
    v_pk_mul_f32 v[104:105], v[104:105], v[76:77]
    v_pk_mul_f32 v[106:107], v[106:107], v[78:79]
    v_pk_mul_f32 v[108:109], v[108:109], v[80:81]
    v_pk_mul_f32 v[110:111], v[110:111], v[82:83]
    v_exp_f32 v104, v104
    v_exp_f32 v105, v105
    v_exp_f32 v106, v106
    v_exp_f32 v107, v107
    v_exp_f32 v108, v108
    v_exp_f32 v109, v109
    v_exp_f32 v110, v110
    v_exp_f32 v111, v111
    v_pk_fma_f32 v[104:105], v[104:105], v[30:31], v[30:31] op_sel_hi:[1,0,0]
    v_pk_fma_f32 v[106:107], v[106:107], v[30:31], v[30:31] op_sel_hi:[1,0,0]
    v_pk_fma_f32 v[108:109], v[108:109], v[30:31], v[30:31] op_sel_hi:[1,0,0]
    v_pk_fma_f32 v[110:111], v[110:111], v[30:31], v[30:31] op_sel_hi:[1,0,0]
    v_rcp_f32 v104, v104
    v_rcp_f32 v105, v105
    v_rcp_f32 v106, v106
    v_rcp_f32 v107, v107
    v_rcp_f32 v108, v108
    v_rcp_f32 v109, v109
    v_rcp_f32 v110, v110
    v_rcp_f32 v111, v111
    v_pk_mul_f32 v[76:77], v[76:77], v[104:105]
    v_pk_mul_f32 v[78:79], v[78:79], v[106:107]
    v_pk_mul_f32 v[80:81], v[80:81], v[108:109]
    v_pk_mul_f32 v[82:83], v[82:83], v[110:111]
    v_cvt_pk_bf16_f32 v116, v76, v77
    v_cvt_pk_bf16_f32 v117, v78, v79
    v_cvt_pk_bf16_f32 v118, v80, v81
    v_cvt_pk_bf16_f32 v119, v82, v83
    buffer_store_dwordx4 v[116:119], v1, s[20:23], s37 offen sc1
    s_add_u32 s37, s37, 16384
    s_cmp_ge_u32 s63, 12
    s_cbranch_scc1 Lc4e
    v_pk_mul_f32 v[96:97], v[56:57], v[56:57]
    v_pk_mul_f32 v[98:99], v[58:59], v[58:59]
    v_pk_mul_f32 v[100:101], v[84:85], v[84:85]
    v_pk_mul_f32 v[102:103], v[86:87], v[86:87]
    v_pk_fma_f32 v[96:97], v[96:97], v[18:19], v[18:19] op_sel:[0,1,0] op_sel_hi:[1,1,0]
    v_pk_fma_f32 v[98:99], v[98:99], v[18:19], v[18:19] op_sel:[0,1,0] op_sel_hi:[1,1,0]
    v_pk_fma_f32 v[100:101], v[100:101], v[28:29], v[28:29] op_sel:[0,1,0] op_sel_hi:[1,1,0]
    v_pk_fma_f32 v[102:103], v[102:103], v[28:29], v[28:29] op_sel:[0,1,0] op_sel_hi:[1,1,0]
    v_pk_mul_f32 v[96:97], v[96:97], v[56:57]
    v_pk_mul_f32 v[98:99], v[98:99], v[58:59]
    v_pk_mul_f32 v[100:101], v[100:101], v[84:85]
    v_pk_mul_f32 v[102:103], v[102:103], v[86:87]
    v_exp_f32 v96, v96
    v_exp_f32 v97, v97
    v_exp_f32 v98, v98
    v_exp_f32 v99, v99
    v_exp_f32 v100, v100
    v_exp_f32 v101, v101
    v_exp_f32 v102, v102
    v_exp_f32 v103, v103
    v_pk_fma_f32 v[96:97], v[96:97], v[20:21], v[20:21] op_sel_hi:[1,0,0]
    v_pk_fma_f32 v[98:99], v[98:99], v[20:21], v[20:21] op_sel_hi:[1,0,0]
    v_pk_fma_f32 v[100:101], v[100:101], v[30:31], v[30:31] op_sel_hi:[1,0,0]
    v_pk_fma_f32 v[102:103], v[102:103], v[30:31], v[30:31] op_sel_hi:[1,0,0]
    v_rcp_f32 v96, v96
    v_rcp_f32 v97, v97
    v_rcp_f32 v98, v98
    v_rcp_f32 v99, v99
    v_rcp_f32 v100, v100
    v_rcp_f32 v101, v101
    v_rcp_f32 v102, v102
    v_rcp_f32 v103, v103
    v_pk_mul_f32 v[56:57], v[56:57], v[96:97]
    v_pk_mul_f32 v[58:59], v[58:59], v[98:99]
    v_pk_mul_f32 v[84:85], v[84:85], v[100:101]
    v_pk_mul_f32 v[86:87], v[86:87], v[102:103]
    v_cvt_pk_bf16_f32 v120, v56, v57
    v_cvt_pk_bf16_f32 v121, v58, v59
    v_cvt_pk_bf16_f32 v122, v84, v85
    v_cvt_pk_bf16_f32 v123, v86, v87
    buffer_store_dwordx2 v[120:121], v7, s[20:23], s39 offen sc1
    s_add_u32 s39, s39, 55296
    buffer_store_dwordx2 v[122:123], v7, s[20:23], s39 offen sc1
    s_waitcnt vmcnt(5)
    s_branch Lc4f
Lc4e:
    s_waitcnt vmcnt(3)
Lc4f:
    s_add_u32 s58, s58, 131072
    s_cmp_eq_u32 s26, 0
    s_waitcnt vmcnt(5)
    s_mov_b64 exec, 1
    s_cbranch_scc1 Ug36
    buffer_store_dword v230, v231, s[20:23], s58 offen
    s_branch Ug37
Ug36:
    buffer_store_dword v230, v231, s[20:23], s58 offen sc1
Ug37:
    s_mov_b64 exec, -1
Lc5:
    s_and_b32 s36, s28, 1
    s_mul_i32 s37, s36, 5120
    v_mov_b32 v20, v7
    v_add_u32 v5, s37, v1
    v_add_u32 v6, 61440, v5
    v_add_u32 v7, 122880, v5
    s_lshl_b32 s33, s29, 2
    s_add_u32 s33, s33, s28
    s_mul_i32 s34, s33, 55296
    s_xor_b32 s33, s33, 1
    s_mul_i32 s35, s33, 55296
    s_lshl_b32 s36, s36, 10
    s_add_u32 s36, s36, 15728640
    s_add_u32 s34, s34, s36
    s_add_u32 s35, s35, s36
    s_mul_i32 s36, s28, 5120
    s_add_u32 s36, s36, 122880
    v_add_u32 v8, s36, v1
    s_xor_b32 s36, s28, 1
    s_mul_i32 s36, s36, 5120
    s_add_u32 s36, s36, 122880
    v_add_u32 v9, s36, v1
    s_mov_b32 s16, s80
    s_mov_b32 s17, s81
    s_mov_b32 s18, 2621440
    s_mov_b32 s19, 0x20000
    s_mul_i32 s36, s28, 2816
    s_add_u32 s36, s36, 143360
    v_and_b32 v2, 15, v0
    v_lshrrev_b32 v3, 4, v0
    v_mul_u32_u24 v2, 176, v2
    v_add_u32 v2, s36, v2
    v_lshl_add_u32 v10, v3, 5, v2
    v_lshl_add_u32 v11, v3, 3, v2
    v_add_u32 v2, 0, v0
    v_mul_u32_u24 v3, 52429, v2
    v_lshrrev_b32 v3, 19, v3
    v_mul_u32_u24 v4, 10, v3
    v_sub_u32 v2, v2, v4
    v_lshlrev_b32 v2, 4, v2
    v_mul_u32_u24 v4, 176, v3
    v_add3_u32 v12, v4, v2, s36
    v_mul_u32_u24 v4, 1280, v3
    v_add_u32 v16, v4, v2
    v_add_u32 v2, 64, v0
    v_mul_u32_u24 v3, 52429, v2
    v_lshrrev_b32 v3, 19, v3
    v_mul_u32_u24 v4, 10, v3
    v_sub_u32 v2, v2, v4
    v_lshlrev_b32 v2, 4, v2
    v_mul_u32_u24 v4, 176, v3
    v_add3_u32 v13, v4, v2, s36
    v_mul_u32_u24 v4, 1280, v3
    v_add_u32 v17, v4, v2
    v_add_u32 v2, 128, v0
    v_mul_u32_u24 v3, 52429, v2
    v_lshrrev_b32 v3, 19, v3
    v_mul_u32_u24 v4, 10, v3
    v_sub_u32 v2, v2, v4
    v_lshlrev_b32 v2, 4, v2
    v_mul_u32_u24 v4, 176, v3
    v_add3_u32 v14, v4, v2, s36
    v_mul_u32_u24 v4, 1280, v3
    v_add_u32 v18, v4, v2
    s_add_u32 s58, s58, 131072
    s_barrier
    buffer_load_dwordx4 v[32:35], v1, s[20:23], s34 offen offset:0 sc1
    buffer_load_dwordx4 v[36:39], v1, s[20:23], s35 offen offset:0 sc1
    buffer_load_dwordx4 v[40:43], v1, s[20:23], s34 offen offset:2048 sc1
    buffer_load_dwordx4 v[44:47], v1, s[20:23], s35 offen offset:2048 sc1
    s_add_u32 s34, s34, 4096
    s_add_u32 s35, s35, 4096
    buffer_load_dwordx4 v[48:51], v1, s[20:23], s34 offen offset:0 sc1
    buffer_load_dwordx4 v[52:55], v1, s[20:23], s35 offen offset:0 sc1
    buffer_load_dwordx4 v[56:59], v1, s[20:23], s34 offen offset:2048 sc1
    buffer_load_dwordx4 v[60:63], v1, s[20:23], s35 offen offset:2048 sc1
    s_add_u32 s34, s34, 4096
    s_add_u32 s35, s35, 4096
    buffer_load_dwordx4 v[64:67], v1, s[20:23], s34 offen offset:0 sc1
    buffer_load_dwordx4 v[68:71], v1, s[20:23], s35 offen offset:0 sc1
    buffer_load_dwordx4 v[72:75], v1, s[20:23], s34 offen offset:2048 sc1
    buffer_load_dwordx4 v[76:79], v1, s[20:23], s35 offen offset:2048 sc1
    s_add_u32 s34, s34, 4096
    s_add_u32 s35, s35, 4096
    ds_read_b128 v[112:115], v5 offset:0
    ds_read_b128 v[116:119], v5 offset:1024
    ds_read_b128 v[120:123], v5 offset:2048
    ds_read_b128 v[124:127], v5 offset:3072
    ds_read_b128 v[128:131], v5 offset:4096
    ds_read_b128 v[132:135], v5 offset:10240
    ds_read_b128 v[136:139], v5 offset:11264
    ds_read_b128 v[140:143], v5 offset:12288
    ds_read_b128 v[144:147], v5 offset:13312
    ds_read_b128 v[148:151], v5 offset:14336
    s_cmp_eq_u32 s26, 0
    s_waitcnt vmcnt(12)
    s_mov_b64 exec, 1
    s_cbranch_scc1 Ug38
    buffer_store_dword v230, v231, s[20:23], s58 offen
    s_branch Ug39
Ug38:
    buffer_store_dword v230, v231, s[20:23], s58 offen sc1
Ug39:
    s_mov_b64 exec, -1
    s_barrier
    s_waitcnt vmcnt(11) lgkmcnt(5)
    v_mfma_f32_16x16x32_bf16 v[172:175], v[112:115], v[36:39], 0
    ds_read_b128 v[152:155], v5 offset:20480
    v_mfma_f32_16x16x32_bf16 v[176:179], v[116:119], v[36:39], 0
    ds_read_b128 v[156:159], v5 offset:21504
    v_mfma_f32_16x16x32_bf16 v[180:183], v[120:123], v[36:39], 0
    ds_read_b128 v[160:163], v5 offset:22528
    v_mfma_f32_16x16x32_bf16 v[184:187], v[124:127], v[36:39], 0
    ds_read_b128 v[164:167], v5 offset:23552
    v_mfma_f32_16x16x32_bf16 v[188:191], v[128:131], v[36:39], 0
    ds_read_b128 v[168:171], v5 offset:24576
    v_mfma_f32_16x16x32_bf16 v[232:235], v[112:115], v[32:35], v[232:235]
    buffer_load_dwordx4 v[80:83], v1, s[20:23], s34 offen offset:0 sc1
    v_mfma_f32_16x16x32_bf16 v[236:239], v[116:119], v[32:35], v[236:239]
    v_mfma_f32_16x16x32_bf16 v[240:243], v[120:123], v[32:35], v[240:243]
    buffer_load_dwordx4 v[84:87], v1, s[20:23], s35 offen offset:0 sc1
    v_mfma_f32_16x16x32_bf16 v[244:247], v[124:127], v[32:35], v[244:247]
    v_mfma_f32_16x16x32_bf16 v[248:251], v[128:131], v[32:35], v[248:251]
    s_waitcnt vmcnt(11) lgkmcnt(5)
    v_mfma_f32_16x16x32_bf16 v[172:175], v[132:135], v[44:47], v[172:175]
    ds_read_b128 v[112:115], v5 offset:30720
    v_mfma_f32_16x16x32_bf16 v[176:179], v[136:139], v[44:47], v[176:179]
    ds_read_b128 v[116:119], v5 offset:31744
    v_mfma_f32_16x16x32_bf16 v[180:183], v[140:143], v[44:47], v[180:183]
    ds_read_b128 v[120:123], v5 offset:32768
    v_mfma_f32_16x16x32_bf16 v[184:187], v[144:147], v[44:47], v[184:187]
    ds_read_b128 v[124:127], v5 offset:33792
    v_mfma_f32_16x16x32_bf16 v[188:191], v[148:151], v[44:47], v[188:191]
    ds_read_b128 v[128:131], v5 offset:34816
    v_mfma_f32_16x16x32_bf16 v[232:235], v[132:135], v[40:43], v[232:235]
    buffer_load_dwordx4 v[88:91], v1, s[20:23], s34 offen offset:2048 sc1
    v_mfma_f32_16x16x32_bf16 v[236:239], v[136:139], v[40:43], v[236:239]
    v_mfma_f32_16x16x32_bf16 v[240:243], v[140:143], v[40:43], v[240:243]
    buffer_load_dwordx4 v[92:95], v1, s[20:23], s35 offen offset:2048 sc1
    s_add_u32 s34, s34, 4096
    s_add_u32 s35, s35, 4096
    v_mfma_f32_16x16x32_bf16 v[244:247], v[144:147], v[40:43], v[244:247]
    v_mfma_f32_16x16x32_bf16 v[248:251], v[148:151], v[40:43], v[248:251]
    s_barrier
    s_waitcnt vmcnt(11) lgkmcnt(5)
    v_mfma_f32_16x16x32_bf16 v[172:175], v[152:155], v[52:55], v[172:175]
    ds_read_b128 v[132:135], v5 offset:40960
    v_mfma_f32_16x16x32_bf16 v[176:179], v[156:159], v[52:55], v[176:179]
    ds_read_b128 v[136:139], v5 offset:41984
    v_mfma_f32_16x16x32_bf16 v[180:183], v[160:163], v[52:55], v[180:183]
    ds_read_b128 v[140:143], v5 offset:43008
    v_mfma_f32_16x16x32_bf16 v[184:187], v[164:167], v[52:55], v[184:187]
    ds_read_b128 v[144:147], v5 offset:44032
    v_mfma_f32_16x16x32_bf16 v[188:191], v[168:171], v[52:55], v[188:191]
    ds_read_b128 v[148:151], v5 offset:45056
    v_mfma_f32_16x16x32_bf16 v[232:235], v[152:155], v[48:51], v[232:235]
    buffer_load_dwordx4 v[32:35], v1, s[20:23], s34 offen offset:0 sc1
    v_mfma_f32_16x16x32_bf16 v[236:239], v[156:159], v[48:51], v[236:239]
    v_mfma_f32_16x16x32_bf16 v[240:243], v[160:163], v[48:51], v[240:243]
    buffer_load_dwordx4 v[36:39], v1, s[20:23], s35 offen offset:0 sc1
    v_mfma_f32_16x16x32_bf16 v[244:247], v[164:167], v[48:51], v[244:247]
    v_mfma_f32_16x16x32_bf16 v[248:251], v[168:171], v[48:51], v[248:251]
    s_waitcnt vmcnt(11) lgkmcnt(5)
    v_mfma_f32_16x16x32_bf16 v[172:175], v[112:115], v[60:63], v[172:175]
    ds_read_b128 v[152:155], v5 offset:51200
    v_mfma_f32_16x16x32_bf16 v[176:179], v[116:119], v[60:63], v[176:179]
    ds_read_b128 v[156:159], v5 offset:52224
    v_mfma_f32_16x16x32_bf16 v[180:183], v[120:123], v[60:63], v[180:183]
    ds_read_b128 v[160:163], v5 offset:53248
    v_mfma_f32_16x16x32_bf16 v[184:187], v[124:127], v[60:63], v[184:187]
    ds_read_b128 v[164:167], v5 offset:54272
    v_mfma_f32_16x16x32_bf16 v[188:191], v[128:131], v[60:63], v[188:191]
    ds_read_b128 v[168:171], v5 offset:55296
    v_mfma_f32_16x16x32_bf16 v[232:235], v[112:115], v[56:59], v[232:235]
    buffer_load_dwordx4 v[40:43], v1, s[20:23], s34 offen offset:2048 sc1
    v_mfma_f32_16x16x32_bf16 v[236:239], v[116:119], v[56:59], v[236:239]
    v_mfma_f32_16x16x32_bf16 v[240:243], v[120:123], v[56:59], v[240:243]
    buffer_load_dwordx4 v[44:47], v1, s[20:23], s35 offen offset:2048 sc1
    s_add_u32 s34, s34, 4096
    s_add_u32 s35, s35, 4096
    v_mfma_f32_16x16x32_bf16 v[244:247], v[124:127], v[56:59], v[244:247]
    v_mfma_f32_16x16x32_bf16 v[248:251], v[128:131], v[56:59], v[248:251]
    s_barrier
    s_waitcnt vmcnt(11) lgkmcnt(5)
    v_mfma_f32_16x16x32_bf16 v[172:175], v[132:135], v[68:71], v[172:175]
    ds_read_b128 v[112:115], v6 offset:0
    v_mfma_f32_16x16x32_bf16 v[176:179], v[136:139], v[68:71], v[176:179]
    ds_read_b128 v[116:119], v6 offset:1024
    v_mfma_f32_16x16x32_bf16 v[180:183], v[140:143], v[68:71], v[180:183]
    ds_read_b128 v[120:123], v6 offset:2048
    v_mfma_f32_16x16x32_bf16 v[184:187], v[144:147], v[68:71], v[184:187]
    ds_read_b128 v[124:127], v6 offset:3072
    v_mfma_f32_16x16x32_bf16 v[188:191], v[148:151], v[68:71], v[188:191]
    ds_read_b128 v[128:131], v6 offset:4096
    v_mfma_f32_16x16x32_bf16 v[232:235], v[132:135], v[64:67], v[232:235]
    buffer_load_dwordx4 v[48:51], v1, s[20:23], s34 offen offset:0 sc1
    v_mfma_f32_16x16x32_bf16 v[236:239], v[136:139], v[64:67], v[236:239]
    v_mfma_f32_16x16x32_bf16 v[240:243], v[140:143], v[64:67], v[240:243]
    buffer_load_dwordx4 v[52:55], v1, s[20:23], s35 offen offset:0 sc1
    v_mfma_f32_16x16x32_bf16 v[244:247], v[144:147], v[64:67], v[244:247]
    v_mfma_f32_16x16x32_bf16 v[248:251], v[148:151], v[64:67], v[248:251]
    s_waitcnt vmcnt(11) lgkmcnt(5)
    v_mfma_f32_16x16x32_bf16 v[172:175], v[152:155], v[76:79], v[172:175]
    ds_read_b128 v[132:135], v6 offset:10240
    v_mfma_f32_16x16x32_bf16 v[176:179], v[156:159], v[76:79], v[176:179]
    ds_read_b128 v[136:139], v6 offset:11264
    v_mfma_f32_16x16x32_bf16 v[180:183], v[160:163], v[76:79], v[180:183]
    ds_read_b128 v[140:143], v6 offset:12288
    v_mfma_f32_16x16x32_bf16 v[184:187], v[164:167], v[76:79], v[184:187]
    ds_read_b128 v[144:147], v6 offset:13312
    v_mfma_f32_16x16x32_bf16 v[188:191], v[168:171], v[76:79], v[188:191]
    ds_read_b128 v[148:151], v6 offset:14336
    v_mfma_f32_16x16x32_bf16 v[232:235], v[152:155], v[72:75], v[232:235]
    buffer_load_dwordx4 v[56:59], v1, s[20:23], s34 offen offset:2048 sc1
    v_mfma_f32_16x16x32_bf16 v[236:239], v[156:159], v[72:75], v[236:239]
    v_mfma_f32_16x16x32_bf16 v[240:243], v[160:163], v[72:75], v[240:243]
    buffer_load_dwordx4 v[60:63], v1, s[20:23], s35 offen offset:2048 sc1
    s_add_u32 s34, s34, 4096
    s_add_u32 s35, s35, 4096
    v_mfma_f32_16x16x32_bf16 v[244:247], v[164:167], v[72:75], v[244:247]
    v_mfma_f32_16x16x32_bf16 v[248:251], v[168:171], v[72:75], v[248:251]
    s_barrier
    s_waitcnt vmcnt(10) lgkmcnt(5)
    v_mfma_f32_16x16x32_bf16 v[172:175], v[112:115], v[84:87], v[172:175]
    ds_read_b128 v[152:155], v6 offset:20480
    v_mfma_f32_16x16x32_bf16 v[176:179], v[116:119], v[84:87], v[176:179]
    ds_read_b128 v[156:159], v6 offset:21504
    v_mfma_f32_16x16x32_bf16 v[180:183], v[120:123], v[84:87], v[180:183]
    ds_read_b128 v[160:163], v6 offset:22528
    v_mfma_f32_16x16x32_bf16 v[184:187], v[124:127], v[84:87], v[184:187]
    ds_read_b128 v[164:167], v6 offset:23552
    v_mfma_f32_16x16x32_bf16 v[188:191], v[128:131], v[84:87], v[188:191]
    ds_read_b128 v[168:171], v6 offset:24576
    v_mfma_f32_16x16x32_bf16 v[232:235], v[112:115], v[80:83], v[232:235]
    buffer_load_dwordx4 v[64:67], v1, s[20:23], s34 offen offset:0 sc1
    v_mfma_f32_16x16x32_bf16 v[236:239], v[116:119], v[80:83], v[236:239]
    v_mfma_f32_16x16x32_bf16 v[240:243], v[120:123], v[80:83], v[240:243]
    buffer_load_dwordx4 v[68:71], v1, s[20:23], s35 offen offset:0 sc1
    v_mfma_f32_16x16x32_bf16 v[244:247], v[124:127], v[80:83], v[244:247]
    v_mfma_f32_16x16x32_bf16 v[248:251], v[128:131], v[80:83], v[248:251]
    s_waitcnt vmcnt(10) lgkmcnt(5)
    v_mfma_f32_16x16x32_bf16 v[172:175], v[132:135], v[92:95], v[172:175]
    ds_read_b128 v[112:115], v6 offset:30720
    v_mfma_f32_16x16x32_bf16 v[176:179], v[136:139], v[92:95], v[176:179]
    ds_read_b128 v[116:119], v6 offset:31744
    v_mfma_f32_16x16x32_bf16 v[180:183], v[140:143], v[92:95], v[180:183]
    ds_read_b128 v[120:123], v6 offset:32768
    v_mfma_f32_16x16x32_bf16 v[184:187], v[144:147], v[92:95], v[184:187]
    ds_read_b128 v[124:127], v6 offset:33792
    v_mfma_f32_16x16x32_bf16 v[188:191], v[148:151], v[92:95], v[188:191]
    ds_read_b128 v[128:131], v6 offset:34816
    v_mfma_f32_16x16x32_bf16 v[232:235], v[132:135], v[88:91], v[232:235]
    buffer_load_dwordx4 v[72:75], v1, s[20:23], s34 offen offset:2048 sc1
    v_mfma_f32_16x16x32_bf16 v[236:239], v[136:139], v[88:91], v[236:239]
    v_mfma_f32_16x16x32_bf16 v[240:243], v[140:143], v[88:91], v[240:243]
    buffer_load_dwordx4 v[76:79], v1, s[20:23], s35 offen offset:2048 sc1
    s_add_u32 s34, s34, 4096
    s_add_u32 s35, s35, 4096
    v_mfma_f32_16x16x32_bf16 v[244:247], v[144:147], v[88:91], v[244:247]
    v_mfma_f32_16x16x32_bf16 v[248:251], v[148:151], v[88:91], v[248:251]
    s_barrier
    s_waitcnt vmcnt(10) lgkmcnt(5)
    v_mfma_f32_16x16x32_bf16 v[172:175], v[152:155], v[36:39], v[172:175]
    ds_read_b128 v[132:135], v6 offset:40960
    v_mfma_f32_16x16x32_bf16 v[176:179], v[156:159], v[36:39], v[176:179]
    ds_read_b128 v[136:139], v6 offset:41984
    v_mfma_f32_16x16x32_bf16 v[180:183], v[160:163], v[36:39], v[180:183]
    ds_read_b128 v[140:143], v6 offset:43008
    v_mfma_f32_16x16x32_bf16 v[184:187], v[164:167], v[36:39], v[184:187]
    ds_read_b128 v[144:147], v6 offset:44032
    v_mfma_f32_16x16x32_bf16 v[188:191], v[168:171], v[36:39], v[188:191]
    ds_read_b128 v[148:151], v6 offset:45056
    v_mfma_f32_16x16x32_bf16 v[232:235], v[152:155], v[32:35], v[232:235]
    buffer_load_dwordx4 v[80:83], v1, s[20:23], s34 offen offset:0 sc1
    v_mfma_f32_16x16x32_bf16 v[236:239], v[156:159], v[32:35], v[236:239]
    v_mfma_f32_16x16x32_bf16 v[240:243], v[160:163], v[32:35], v[240:243]
    buffer_load_dwordx4 v[84:87], v1, s[20:23], s35 offen offset:0 sc1
    v_mfma_f32_16x16x32_bf16 v[244:247], v[164:167], v[32:35], v[244:247]
    v_mfma_f32_16x16x32_bf16 v[248:251], v[168:171], v[32:35], v[248:251]
    s_waitcnt vmcnt(10) lgkmcnt(5)
    v_mfma_f32_16x16x32_bf16 v[172:175], v[112:115], v[44:47], v[172:175]
    ds_read_b128 v[152:155], v6 offset:51200
    v_mfma_f32_16x16x32_bf16 v[176:179], v[116:119], v[44:47], v[176:179]
    ds_read_b128 v[156:159], v6 offset:52224
    v_mfma_f32_16x16x32_bf16 v[180:183], v[120:123], v[44:47], v[180:183]
    ds_read_b128 v[160:163], v6 offset:53248
    v_mfma_f32_16x16x32_bf16 v[184:187], v[124:127], v[44:47], v[184:187]
    ds_read_b128 v[164:167], v6 offset:54272
    v_mfma_f32_16x16x32_bf16 v[188:191], v[128:131], v[44:47], v[188:191]
    ds_read_b128 v[168:171], v6 offset:55296
    v_mfma_f32_16x16x32_bf16 v[232:235], v[112:115], v[40:43], v[232:235]
    buffer_load_dwordx4 v[88:91], v1, s[20:23], s34 offen offset:2048 sc1
    v_mfma_f32_16x16x32_bf16 v[236:239], v[116:119], v[40:43], v[236:239]
    v_mfma_f32_16x16x32_bf16 v[240:243], v[120:123], v[40:43], v[240:243]
    buffer_load_dwordx4 v[92:95], v1, s[20:23], s35 offen offset:2048 sc1
    s_add_u32 s34, s34, 4096
    s_add_u32 s35, s35, 4096
    v_mfma_f32_16x16x32_bf16 v[244:247], v[124:127], v[40:43], v[244:247]
    v_mfma_f32_16x16x32_bf16 v[248:251], v[128:131], v[40:43], v[248:251]
    s_barrier
    s_waitcnt vmcnt(10) lgkmcnt(5)
    v_mfma_f32_16x16x32_bf16 v[172:175], v[132:135], v[52:55], v[172:175]
    ds_read_b128 v[112:115], v7 offset:0
    v_mfma_f32_16x16x32_bf16 v[176:179], v[136:139], v[52:55], v[176:179]
    ds_read_b128 v[116:119], v7 offset:1024
    v_mfma_f32_16x16x32_bf16 v[180:183], v[140:143], v[52:55], v[180:183]
    ds_read_b128 v[120:123], v7 offset:2048
    v_mfma_f32_16x16x32_bf16 v[184:187], v[144:147], v[52:55], v[184:187]
    ds_read_b128 v[124:127], v7 offset:3072
    v_mfma_f32_16x16x32_bf16 v[188:191], v[148:151], v[52:55], v[188:191]
    ds_read_b128 v[128:131], v7 offset:4096
    v_mfma_f32_16x16x32_bf16 v[232:235], v[132:135], v[48:51], v[232:235]
    buffer_load_dwordx4 v[32:35], v1, s[20:23], s34 offen offset:0 sc1
    v_mfma_f32_16x16x32_bf16 v[236:239], v[136:139], v[48:51], v[236:239]
    v_mfma_f32_16x16x32_bf16 v[240:243], v[140:143], v[48:51], v[240:243]
    buffer_load_dwordx4 v[36:39], v1, s[20:23], s35 offen offset:0 sc1
    v_mfma_f32_16x16x32_bf16 v[244:247], v[144:147], v[48:51], v[244:247]
    v_mfma_f32_16x16x32_bf16 v[248:251], v[148:151], v[48:51], v[248:251]
    s_waitcnt vmcnt(10) lgkmcnt(5)
    v_mfma_f32_16x16x32_bf16 v[172:175], v[152:155], v[60:63], v[172:175]
    ds_read_b128 v[132:135], v7 offset:10240
    v_mfma_f32_16x16x32_bf16 v[176:179], v[156:159], v[60:63], v[176:179]
    ds_read_b128 v[136:139], v7 offset:11264
    v_mfma_f32_16x16x32_bf16 v[180:183], v[160:163], v[60:63], v[180:183]
    ds_read_b128 v[140:143], v7 offset:12288
    v_mfma_f32_16x16x32_bf16 v[184:187], v[164:167], v[60:63], v[184:187]
    ds_read_b128 v[144:147], v7 offset:13312
    v_mfma_f32_16x16x32_bf16 v[188:191], v[168:171], v[60:63], v[188:191]
    ds_read_b128 v[148:151], v7 offset:14336
    v_mfma_f32_16x16x32_bf16 v[232:235], v[152:155], v[56:59], v[232:235]
    buffer_load_dwordx4 v[40:43], v1, s[20:23], s34 offen offset:2048 sc1
    v_mfma_f32_16x16x32_bf16 v[236:239], v[156:159], v[56:59], v[236:239]
    v_mfma_f32_16x16x32_bf16 v[240:243], v[160:163], v[56:59], v[240:243]
    buffer_load_dwordx4 v[44:47], v1, s[20:23], s35 offen offset:2048 sc1
    s_add_u32 s34, s34, 4096
    s_add_u32 s35, s35, 4096
    v_mfma_f32_16x16x32_bf16 v[244:247], v[164:167], v[56:59], v[244:247]
    v_mfma_f32_16x16x32_bf16 v[248:251], v[168:171], v[56:59], v[248:251]
    s_barrier
    s_waitcnt vmcnt(10) lgkmcnt(5)
    v_mfma_f32_16x16x32_bf16 v[172:175], v[112:115], v[68:71], v[172:175]
    ds_read_b128 v[152:155], v7 offset:20480
    v_mfma_f32_16x16x32_bf16 v[176:179], v[116:119], v[68:71], v[176:179]
    ds_read_b128 v[156:159], v7 offset:21504
    v_mfma_f32_16x16x32_bf16 v[180:183], v[120:123], v[68:71], v[180:183]
    ds_read_b128 v[160:163], v7 offset:22528
    v_mfma_f32_16x16x32_bf16 v[184:187], v[124:127], v[68:71], v[184:187]
    ds_read_b128 v[164:167], v7 offset:23552
    v_mfma_f32_16x16x32_bf16 v[188:191], v[128:131], v[68:71], v[188:191]
    ds_read_b128 v[168:171], v7 offset:24576
    v_mfma_f32_16x16x32_bf16 v[232:235], v[112:115], v[64:67], v[232:235]
    buffer_load_dwordx4 v[48:51], v1, s[20:23], s34 offen offset:0 sc1
    v_mfma_f32_16x16x32_bf16 v[236:239], v[116:119], v[64:67], v[236:239]
    v_mfma_f32_16x16x32_bf16 v[240:243], v[120:123], v[64:67], v[240:243]
    buffer_load_dwordx4 v[52:55], v1, s[20:23], s35 offen offset:0 sc1
    v_mfma_f32_16x16x32_bf16 v[244:247], v[124:127], v[64:67], v[244:247]
    v_mfma_f32_16x16x32_bf16 v[248:251], v[128:131], v[64:67], v[248:251]
    s_waitcnt vmcnt(10) lgkmcnt(5)
    v_mfma_f32_16x16x32_bf16 v[172:175], v[132:135], v[76:79], v[172:175]
    ds_read_b128 v[112:115], v7 offset:30720
    v_mfma_f32_16x16x32_bf16 v[176:179], v[136:139], v[76:79], v[176:179]
    ds_read_b128 v[116:119], v7 offset:31744
    v_mfma_f32_16x16x32_bf16 v[180:183], v[140:143], v[76:79], v[180:183]
    ds_read_b128 v[120:123], v7 offset:32768
    v_mfma_f32_16x16x32_bf16 v[184:187], v[144:147], v[76:79], v[184:187]
    ds_read_b128 v[124:127], v7 offset:33792
    v_mfma_f32_16x16x32_bf16 v[188:191], v[148:151], v[76:79], v[188:191]
    ds_read_b128 v[128:131], v7 offset:34816
    v_mfma_f32_16x16x32_bf16 v[232:235], v[132:135], v[72:75], v[232:235]
    buffer_load_dwordx4 v[56:59], v1, s[20:23], s34 offen offset:2048 sc1
    v_mfma_f32_16x16x32_bf16 v[236:239], v[136:139], v[72:75], v[236:239]
    v_mfma_f32_16x16x32_bf16 v[240:243], v[140:143], v[72:75], v[240:243]
    buffer_load_dwordx4 v[60:63], v1, s[20:23], s35 offen offset:2048 sc1
    s_add_u32 s34, s34, 4096
    s_add_u32 s35, s35, 4096
    v_mfma_f32_16x16x32_bf16 v[244:247], v[144:147], v[72:75], v[244:247]
    v_mfma_f32_16x16x32_bf16 v[248:251], v[148:151], v[72:75], v[248:251]
    s_barrier
    s_waitcnt vmcnt(10) lgkmcnt(5)
    v_mfma_f32_16x16x32_bf16 v[172:175], v[152:155], v[84:87], v[172:175]
    ds_read_b128 v[132:135], v5 offset:0
    v_mfma_f32_16x16x32_bf16 v[176:179], v[156:159], v[84:87], v[176:179]
    ds_read_b128 v[136:139], v5 offset:1024
    v_mfma_f32_16x16x32_bf16 v[180:183], v[160:163], v[84:87], v[180:183]
    ds_read_b128 v[140:143], v5 offset:2048
    v_mfma_f32_16x16x32_bf16 v[184:187], v[164:167], v[84:87], v[184:187]
    ds_read_b128 v[144:147], v5 offset:3072
    v_mfma_f32_16x16x32_bf16 v[188:191], v[168:171], v[84:87], v[188:191]
    ds_read_b128 v[148:151], v5 offset:4096
    v_mfma_f32_16x16x32_bf16 v[232:235], v[152:155], v[80:83], v[232:235]
    buffer_load_dwordx4 v[64:67], v1, s[20:23], s34 offen offset:0 sc1
    v_mfma_f32_16x16x32_bf16 v[236:239], v[156:159], v[80:83], v[236:239]
    v_mfma_f32_16x16x32_bf16 v[240:243], v[160:163], v[80:83], v[240:243]
    buffer_load_dwordx4 v[68:71], v1, s[20:23], s35 offen offset:0 sc1
    v_mfma_f32_16x16x32_bf16 v[244:247], v[164:167], v[80:83], v[244:247]
    v_mfma_f32_16x16x32_bf16 v[248:251], v[168:171], v[80:83], v[248:251]
    s_waitcnt vmcnt(10) lgkmcnt(5)
    v_mfma_f32_16x16x32_bf16 v[172:175], v[112:115], v[92:95], v[172:175]
    ds_read_b128 v[152:155], v5 offset:10240
    v_mfma_f32_16x16x32_bf16 v[176:179], v[116:119], v[92:95], v[176:179]
    ds_read_b128 v[156:159], v5 offset:11264
    v_mfma_f32_16x16x32_bf16 v[180:183], v[120:123], v[92:95], v[180:183]
    ds_read_b128 v[160:163], v5 offset:12288
    v_mfma_f32_16x16x32_bf16 v[184:187], v[124:127], v[92:95], v[184:187]
    ds_read_b128 v[164:167], v5 offset:13312
    v_mfma_f32_16x16x32_bf16 v[188:191], v[128:131], v[92:95], v[188:191]
    ds_read_b128 v[168:171], v5 offset:14336
    v_mfma_f32_16x16x32_bf16 v[232:235], v[112:115], v[88:91], v[232:235]
    buffer_load_dwordx4 v[72:75], v1, s[20:23], s34 offen offset:2048 sc1
    v_mfma_f32_16x16x32_bf16 v[236:239], v[116:119], v[88:91], v[236:239]
    v_mfma_f32_16x16x32_bf16 v[240:243], v[120:123], v[88:91], v[240:243]
    buffer_load_dwordx4 v[76:79], v1, s[20:23], s35 offen offset:2048 sc1
    s_add_u32 s34, s34, 4096
    s_add_u32 s35, s35, 4096
    v_mfma_f32_16x16x32_bf16 v[244:247], v[124:127], v[88:91], v[244:247]
    v_mfma_f32_16x16x32_bf16 v[248:251], v[128:131], v[88:91], v[248:251]
    s_barrier
    s_waitcnt vmcnt(10) lgkmcnt(5)
    v_mfma_f32_16x16x32_bf16 v[172:175], v[132:135], v[36:39], v[172:175]
    ds_read_b128 v[112:115], v5 offset:20480
    v_mfma_f32_16x16x32_bf16 v[176:179], v[136:139], v[36:39], v[176:179]
    ds_read_b128 v[116:119], v5 offset:21504
    v_mfma_f32_16x16x32_bf16 v[180:183], v[140:143], v[36:39], v[180:183]
    ds_read_b128 v[120:123], v5 offset:22528
    v_mfma_f32_16x16x32_bf16 v[184:187], v[144:147], v[36:39], v[184:187]
    ds_read_b128 v[124:127], v5 offset:23552
    v_mfma_f32_16x16x32_bf16 v[188:191], v[148:151], v[36:39], v[188:191]
    ds_read_b128 v[128:131], v5 offset:24576
    v_mfma_f32_16x16x32_bf16 v[232:235], v[132:135], v[32:35], v[232:235]
    buffer_load_dwordx4 v[80:83], v1, s[20:23], s34 offen offset:0 sc1
    v_mfma_f32_16x16x32_bf16 v[236:239], v[136:139], v[32:35], v[236:239]
    v_mfma_f32_16x16x32_bf16 v[240:243], v[140:143], v[32:35], v[240:243]
    buffer_load_dwordx4 v[84:87], v1, s[20:23], s35 offen offset:0 sc1
    v_mfma_f32_16x16x32_bf16 v[244:247], v[144:147], v[32:35], v[244:247]
    v_mfma_f32_16x16x32_bf16 v[248:251], v[148:151], v[32:35], v[248:251]
    s_waitcnt vmcnt(10) lgkmcnt(5)
    v_mfma_f32_16x16x32_bf16 v[172:175], v[152:155], v[44:47], v[172:175]
    ds_read_b128 v[132:135], v5 offset:30720
    v_mfma_f32_16x16x32_bf16 v[176:179], v[156:159], v[44:47], v[176:179]
    ds_read_b128 v[136:139], v5 offset:31744
    v_mfma_f32_16x16x32_bf16 v[180:183], v[160:163], v[44:47], v[180:183]
    ds_read_b128 v[140:143], v5 offset:32768
    v_mfma_f32_16x16x32_bf16 v[184:187], v[164:167], v[44:47], v[184:187]
    ds_read_b128 v[144:147], v5 offset:33792
    v_mfma_f32_16x16x32_bf16 v[188:191], v[168:171], v[44:47], v[188:191]
    ds_read_b128 v[148:151], v5 offset:34816
    v_mfma_f32_16x16x32_bf16 v[232:235], v[152:155], v[40:43], v[232:235]
    buffer_load_dwordx4 v[88:91], v1, s[20:23], s34 offen offset:2048 sc1
    v_mfma_f32_16x16x32_bf16 v[236:239], v[156:159], v[40:43], v[236:239]
    v_mfma_f32_16x16x32_bf16 v[240:243], v[160:163], v[40:43], v[240:243]
    buffer_load_dwordx4 v[92:95], v1, s[20:23], s35 offen offset:2048 sc1
    s_add_u32 s34, s34, 4096
    s_add_u32 s35, s35, 4096
    v_mfma_f32_16x16x32_bf16 v[244:247], v[164:167], v[40:43], v[244:247]
    v_mfma_f32_16x16x32_bf16 v[248:251], v[168:171], v[40:43], v[248:251]
    s_barrier
    s_waitcnt vmcnt(10) lgkmcnt(5)
    v_mfma_f32_16x16x32_bf16 v[172:175], v[112:115], v[52:55], v[172:175]
    ds_read_b128 v[152:155], v5 offset:40960
    v_mfma_f32_16x16x32_bf16 v[176:179], v[116:119], v[52:55], v[176:179]
    ds_read_b128 v[156:159], v5 offset:41984
    v_mfma_f32_16x16x32_bf16 v[180:183], v[120:123], v[52:55], v[180:183]
    ds_read_b128 v[160:163], v5 offset:43008
    v_mfma_f32_16x16x32_bf16 v[184:187], v[124:127], v[52:55], v[184:187]
    ds_read_b128 v[164:167], v5 offset:44032
    v_mfma_f32_16x16x32_bf16 v[188:191], v[128:131], v[52:55], v[188:191]
    ds_read_b128 v[168:171], v5 offset:45056
    v_mfma_f32_16x16x32_bf16 v[232:235], v[112:115], v[48:51], v[232:235]
    buffer_load_dwordx2 v[32:33], v20, s[20:23], s34 offen offset:0 sc1
    buffer_load_dwordx2 v[34:35], v20, s[20:23], s34 offen offset:512 sc1
    v_mfma_f32_16x16x32_bf16 v[236:239], v[116:119], v[48:51], v[236:239]
    v_mfma_f32_16x16x32_bf16 v[240:243], v[120:123], v[48:51], v[240:243]
    buffer_load_dwordx2 v[36:37], v20, s[20:23], s35 offen offset:0 sc1
    buffer_load_dwordx2 v[38:39], v20, s[20:23], s35 offen offset:512 sc1
    v_mfma_f32_16x16x32_bf16 v[244:247], v[124:127], v[48:51], v[244:247]
    v_mfma_f32_16x16x32_bf16 v[248:251], v[128:131], v[48:51], v[248:251]
    s_waitcnt vmcnt(12) lgkmcnt(5)
    v_mfma_f32_16x16x32_bf16 v[172:175], v[132:135], v[60:63], v[172:175]
    ds_read_b128 v[112:115], v5 offset:51200
    v_mfma_f32_16x16x32_bf16 v[176:179], v[136:139], v[60:63], v[176:179]
    ds_read_b128 v[116:119], v5 offset:52224
    v_mfma_f32_16x16x32_bf16 v[180:183], v[140:143], v[60:63], v[180:183]
    ds_read_b128 v[120:123], v5 offset:53248
    v_mfma_f32_16x16x32_bf16 v[184:187], v[144:147], v[60:63], v[184:187]
    ds_read_b128 v[124:127], v5 offset:54272
    v_mfma_f32_16x16x32_bf16 v[188:191], v[148:151], v[60:63], v[188:191]
    ds_read_b128 v[128:131], v5 offset:55296
    v_mfma_f32_16x16x32_bf16 v[232:235], v[132:135], v[56:59], v[232:235]
    buffer_load_dwordx2 v[40:41], v20, s[20:23], s34 offen offset:2048 sc1
    buffer_load_dwordx2 v[42:43], v20, s[20:23], s34 offen offset:2560 sc1
    v_mfma_f32_16x16x32_bf16 v[236:239], v[136:139], v[56:59], v[236:239]
    v_mfma_f32_16x16x32_bf16 v[240:243], v[140:143], v[56:59], v[240:243]
    buffer_load_dwordx2 v[44:45], v20, s[20:23], s35 offen offset:2048 sc1
    buffer_load_dwordx2 v[46:47], v20, s[20:23], s35 offen offset:2560 sc1
    s_add_u32 s34, s34, 4096
    s_add_u32 s35, s35, 4096
    v_mfma_f32_16x16x32_bf16 v[244:247], v[144:147], v[56:59], v[244:247]
    v_mfma_f32_16x16x32_bf16 v[248:251], v[148:151], v[56:59], v[248:251]
    s_barrier
    s_waitcnt vmcnt(14) lgkmcnt(5)
    v_mfma_f32_16x16x32_bf16 v[172:175], v[152:155], v[68:71], v[172:175]
    ds_read_b128 v[132:135], v6 offset:0
    v_mfma_f32_16x16x32_bf16 v[176:179], v[156:159], v[68:71], v[176:179]
    ds_read_b128 v[136:139], v6 offset:1024
    v_mfma_f32_16x16x32_bf16 v[180:183], v[160:163], v[68:71], v[180:183]
    ds_read_b128 v[140:143], v6 offset:2048
    v_mfma_f32_16x16x32_bf16 v[184:187], v[164:167], v[68:71], v[184:187]
    ds_read_b128 v[144:147], v6 offset:3072
    v_mfma_f32_16x16x32_bf16 v[188:191], v[168:171], v[68:71], v[188:191]
    ds_read_b128 v[148:151], v6 offset:4096
    v_mfma_f32_16x16x32_bf16 v[232:235], v[152:155], v[64:67], v[232:235]
    buffer_load_dwordx2 v[48:49], v20, s[20:23], s34 offen offset:0 sc1
    buffer_load_dwordx2 v[50:51], v20, s[20:23], s34 offen offset:512 sc1
    v_mfma_f32_16x16x32_bf16 v[236:239], v[156:159], v[64:67], v[236:239]
    v_mfma_f32_16x16x32_bf16 v[240:243], v[160:163], v[64:67], v[240:243]
    buffer_load_dwordx2 v[52:53], v20, s[20:23], s35 offen offset:0 sc1
    buffer_load_dwordx2 v[54:55], v20, s[20:23], s35 offen offset:512 sc1
    v_mfma_f32_16x16x32_bf16 v[244:247], v[164:167], v[64:67], v[244:247]
    v_mfma_f32_16x16x32_bf16 v[248:251], v[168:171], v[64:67], v[248:251]
    s_waitcnt vmcnt(16) lgkmcnt(5)
    v_mfma_f32_16x16x32_bf16 v[172:175], v[112:115], v[76:79], v[172:175]
    ds_read_b128 v[152:155], v6 offset:10240
    v_mfma_f32_16x16x32_bf16 v[176:179], v[116:119], v[76:79], v[176:179]
    ds_read_b128 v[156:159], v6 offset:11264
    v_mfma_f32_16x16x32_bf16 v[180:183], v[120:123], v[76:79], v[180:183]
    ds_read_b128 v[160:163], v6 offset:12288
    v_mfma_f32_16x16x32_bf16 v[184:187], v[124:127], v[76:79], v[184:187]
    ds_read_b128 v[164:167], v6 offset:13312
    v_mfma_f32_16x16x32_bf16 v[188:191], v[128:131], v[76:79], v[188:191]
    ds_read_b128 v[168:171], v6 offset:14336
    v_mfma_f32_16x16x32_bf16 v[232:235], v[112:115], v[72:75], v[232:235]
    v_mfma_f32_16x16x32_bf16 v[236:239], v[116:119], v[72:75], v[236:239]
    v_mfma_f32_16x16x32_bf16 v[240:243], v[120:123], v[72:75], v[240:243]
    v_mfma_f32_16x16x32_bf16 v[244:247], v[124:127], v[72:75], v[244:247]
    v_mfma_f32_16x16x32_bf16 v[248:251], v[128:131], v[72:75], v[248:251]
    s_barrier
    s_waitcnt vmcnt(14) lgkmcnt(5)
    v_mfma_f32_16x16x32_bf16 v[172:175], v[132:135], v[84:87], v[172:175]
    ds_read_b128 v[112:115], v6 offset:20480
    v_mfma_f32_16x16x32_bf16 v[176:179], v[136:139], v[84:87], v[176:179]
    ds_read_b128 v[116:119], v6 offset:21504
    v_mfma_f32_16x16x32_bf16 v[180:183], v[140:143], v[84:87], v[180:183]
    ds_read_b128 v[120:123], v6 offset:22528
    v_mfma_f32_16x16x32_bf16 v[184:187], v[144:147], v[84:87], v[184:187]
    ds_read_b128 v[124:127], v6 offset:23552
    v_mfma_f32_16x16x32_bf16 v[188:191], v[148:151], v[84:87], v[188:191]
    ds_read_b128 v[128:131], v6 offset:24576
    v_mfma_f32_16x16x32_bf16 v[232:235], v[132:135], v[80:83], v[232:235]
    v_mfma_f32_16x16x32_bf16 v[236:239], v[136:139], v[80:83], v[236:239]
    v_mfma_f32_16x16x32_bf16 v[240:243], v[140:143], v[80:83], v[240:243]
    v_mfma_f32_16x16x32_bf16 v[244:247], v[144:147], v[80:83], v[244:247]
    v_mfma_f32_16x16x32_bf16 v[248:251], v[148:151], v[80:83], v[248:251]
    s_waitcnt vmcnt(12) lgkmcnt(5)
    v_mfma_f32_16x16x32_bf16 v[172:175], v[152:155], v[92:95], v[172:175]
    ds_read_b128 v[132:135], v6 offset:30720
    v_mfma_f32_16x16x32_bf16 v[176:179], v[156:159], v[92:95], v[176:179]
    ds_read_b128 v[136:139], v6 offset:31744
    v_mfma_f32_16x16x32_bf16 v[180:183], v[160:163], v[92:95], v[180:183]
    ds_read_b128 v[140:143], v6 offset:32768
    v_mfma_f32_16x16x32_bf16 v[184:187], v[164:167], v[92:95], v[184:187]
    ds_read_b128 v[144:147], v6 offset:33792
    v_mfma_f32_16x16x32_bf16 v[188:191], v[168:171], v[92:95], v[188:191]
    ds_read_b128 v[148:151], v6 offset:34816
    v_mfma_f32_16x16x32_bf16 v[232:235], v[152:155], v[88:91], v[232:235]
    v_mfma_f32_16x16x32_bf16 v[236:239], v[156:159], v[88:91], v[236:239]
    v_mfma_f32_16x16x32_bf16 v[240:243], v[160:163], v[88:91], v[240:243]
    v_mfma_f32_16x16x32_bf16 v[244:247], v[164:167], v[88:91], v[244:247]
    v_mfma_f32_16x16x32_bf16 v[248:251], v[168:171], v[88:91], v[248:251]
    s_barrier
    s_waitcnt vmcnt(8) lgkmcnt(5)
    v_mfma_f32_16x16x32_bf16 v[172:175], v[112:115], v[36:39], v[172:175]
    ds_read_b128 v[152:155], v6 offset:40960
    v_mfma_f32_16x16x32_bf16 v[176:179], v[116:119], v[36:39], v[176:179]
    ds_read_b128 v[156:159], v6 offset:41984
    v_mfma_f32_16x16x32_bf16 v[180:183], v[120:123], v[36:39], v[180:183]
    ds_read_b128 v[160:163], v6 offset:43008
    v_mfma_f32_16x16x32_bf16 v[184:187], v[124:127], v[36:39], v[184:187]
    ds_read_b128 v[164:167], v6 offset:44032
    v_mfma_f32_16x16x32_bf16 v[188:191], v[128:131], v[36:39], v[188:191]
    ds_read_b128 v[168:171], v6 offset:45056
    v_mfma_f32_16x16x32_bf16 v[232:235], v[112:115], v[32:35], v[232:235]
    v_mfma_f32_16x16x32_bf16 v[236:239], v[116:119], v[32:35], v[236:239]
    v_mfma_f32_16x16x32_bf16 v[240:243], v[120:123], v[32:35], v[240:243]
    v_mfma_f32_16x16x32_bf16 v[244:247], v[124:127], v[32:35], v[244:247]
    v_mfma_f32_16x16x32_bf16 v[248:251], v[128:131], v[32:35], v[248:251]
    s_waitcnt vmcnt(4) lgkmcnt(5)
    v_mfma_f32_16x16x32_bf16 v[172:175], v[132:135], v[44:47], v[172:175]
    v_mfma_f32_16x16x32_bf16 v[176:179], v[136:139], v[44:47], v[176:179]
    v_mfma_f32_16x16x32_bf16 v[180:183], v[140:143], v[44:47], v[180:183]
    v_mfma_f32_16x16x32_bf16 v[184:187], v[144:147], v[44:47], v[184:187]
    v_mfma_f32_16x16x32_bf16 v[188:191], v[148:151], v[44:47], v[188:191]
    v_mfma_f32_16x16x32_bf16 v[232:235], v[132:135], v[40:43], v[232:235]
    v_mfma_f32_16x16x32_bf16 v[236:239], v[136:139], v[40:43], v[236:239]
    v_mfma_f32_16x16x32_bf16 v[240:243], v[140:143], v[40:43], v[240:243]
    v_mfma_f32_16x16x32_bf16 v[244:247], v[144:147], v[40:43], v[244:247]
    v_mfma_f32_16x16x32_bf16 v[248:251], v[148:151], v[40:43], v[248:251]
    s_waitcnt vmcnt(0) lgkmcnt(0)
    v_mfma_f32_16x16x32_bf16 v[172:175], v[152:155], v[52:55], v[172:175]
    v_mfma_f32_16x16x32_bf16 v[176:179], v[156:159], v[52:55], v[176:179]
    v_mfma_f32_16x16x32_bf16 v[180:183], v[160:163], v[52:55], v[180:183]
    v_mfma_f32_16x16x32_bf16 v[184:187], v[164:167], v[52:55], v[184:187]
    v_mfma_f32_16x16x32_bf16 v[188:191], v[168:171], v[52:55], v[188:191]
    v_mfma_f32_16x16x32_bf16 v[232:235], v[152:155], v[48:51], v[232:235]
    v_mfma_f32_16x16x32_bf16 v[236:239], v[156:159], v[48:51], v[236:239]
    v_mfma_f32_16x16x32_bf16 v[240:243], v[160:163], v[48:51], v[240:243]
    v_mfma_f32_16x16x32_bf16 v[244:247], v[164:167], v[48:51], v[244:247]
    v_mfma_f32_16x16x32_bf16 v[248:251], v[168:171], v[48:51], v[248:251]
    s_nop 2
    ds_write_b128 v8, v[172:175] offset:0
    ds_write_b128 v8, v[176:179] offset:1024
    ds_write_b128 v8, v[180:183] offset:2048
    ds_write_b128 v8, v[184:187] offset:3072
    ds_write_b128 v8, v[188:191] offset:4096
    s_waitcnt lgkmcnt(0)
    s_barrier
    ds_read_b128 v[172:175], v9 offset:0
    ds_read_b128 v[176:179], v9 offset:1024
    ds_read_b128 v[180:183], v9 offset:2048
    ds_read_b128 v[184:187], v9 offset:3072
    ds_read_b128 v[188:191], v9 offset:4096
    s_waitcnt lgkmcnt(4)
    v_pk_add_f32 v[232:233], v[232:233], v[172:173]
    v_pk_add_f32 v[234:235], v[234:235], v[174:175]
    s_waitcnt lgkmcnt(3)
    v_pk_add_f32 v[236:237], v[236:237], v[176:177]
    v_pk_add_f32 v[238:239], v[238:239], v[178:179]
    s_waitcnt lgkmcnt(2)
    v_pk_add_f32 v[240:241], v[240:241], v[180:181]
    v_pk_add_f32 v[242:243], v[242:243], v[182:183]
    s_waitcnt lgkmcnt(1)
    v_pk_add_f32 v[244:245], v[244:245], v[184:185]
    v_pk_add_f32 v[246:247], v[246:247], v[186:187]
    s_waitcnt lgkmcnt(0)
    v_pk_add_f32 v[248:249], v[248:249], v[188:189]
    v_pk_add_f32 v[250:251], v[250:251], v[190:191]
    v_cvt_pk_bf16_f32 v192, v232, v233
    v_cvt_pk_bf16_f32 v193, v234, v235
    v_cvt_pk_bf16_f32 v194, v236, v237
    v_cvt_pk_bf16_f32 v195, v238, v239
    ds_write_b128 v10, v[192:195]
    v_cvt_pk_bf16_f32 v196, v240, v241
    v_cvt_pk_bf16_f32 v197, v242, v243
    v_cvt_pk_bf16_f32 v198, v244, v245
    v_cvt_pk_bf16_f32 v199, v246, v247
    ds_write_b128 v10, v[196:199] offset:16
    v_cvt_pk_bf16_f32 v200, v248, v249
    v_cvt_pk_bf16_f32 v201, v250, v251
    ds_write_b64 v11, v[200:201] offset:128
    s_waitcnt lgkmcnt(0)
    ds_read_b128 v[204:207], v12
    ds_read_b128 v[208:211], v13
    ds_read_b128 v[212:215], v14
    s_waitcnt lgkmcnt(2)
    buffer_store_dwordx4 v[204:207], v16, s[16:19], s59 offen
    s_waitcnt lgkmcnt(1)
    buffer_store_dwordx4 v[208:211], v17, s[16:19], s59 offen
    s_waitcnt lgkmcnt(0)
    s_mov_b32 exec_hi, 0
    buffer_store_dwordx4 v[212:215], v18, s[16:19], s59 offen
    s_endpgm
Lfallback:
    s_add_u32 s61, s61, 122880
    s_mov_b64 s[46:47], 0
    v_subrev_u32 v37, s61, v37
    v_subrev_u32 v38, s61, v38
    v_subrev_u32 v39, s61, v39
    v_add_u32 v10, 5120, v39
    v_add_u32 v11, 7680, v39
    v_add_u32 v38, 4096, v38
    s_mul_i32 s42, s29, 163840
    s_add_u32 s42, s42, 5242880
    s_mov_b32 s43, 16
    v_mov_b32 v8, 0xff800000
    v_mov_b32 v9, 0xff800000
Lfb0:
    buffer_load_dwordx4 v[168:171], v37, s[20:23], s42 offen offset:0 sc1
    buffer_load_dwordx4 v[172:175], v37, s[20:23], s42 offen offset:512 sc1
    buffer_load_dwordx4 v[176:179], v37, s[20:23], s42 offen offset:1024 sc1
    buffer_load_dwordx4 v[180:183], v37, s[20:23], s42 offen offset:1536 sc1
    buffer_load_dwordx4 v[184:187], v38, s[20:23], s42 offen sc1
    s_waitcnt vmcnt(0)
    v_mfma_f32_32x32x16_bf16 v[104:119], v[168:171], v[12:15], 0
    v_mfma_f32_32x32x8_bf16 v[104:119], v[184:185], v[24:25], v[104:119]
    v_mfma_f32_32x32x16_bf16 v[120:135], v[172:175], v[12:15], 0
    v_mfma_f32_32x32x8_bf16 v[120:135], v[186:187], v[24:25], v[120:135]
    v_mfma_f32_32x32x16_bf16 v[136:151], v[176:179], v[12:15], 0
    v_mfma_f32_32x32x8_bf16 v[136:151], v[184:185], v[32:33], v[136:151]
    v_mfma_f32_32x32x16_bf16 v[152:167], v[180:183], v[12:15], 0
    v_mfma_f32_32x32x8_bf16 v[152:167], v[186:187], v[32:33], v[152:167]
    s_nop 15
    v_max3_f32 v8, v8, v104, v105
    v_max3_f32 v8, v8, v106, v107
    v_max3_f32 v8, v8, v108, v109
    v_max3_f32 v8, v8, v110, v111
    v_max3_f32 v8, v8, v112, v113
    v_max3_f32 v8, v8, v114, v115
    v_max3_f32 v8, v8, v116, v117
    v_max3_f32 v8, v8, v118, v119
    v_max3_f32 v8, v8, v120, v121
    v_max3_f32 v8, v8, v122, v123
    v_max3_f32 v8, v8, v124, v125
    v_max3_f32 v8, v8, v126, v127
    v_max3_f32 v8, v8, v128, v129
    v_max3_f32 v8, v8, v130, v131
    v_max3_f32 v8, v8, v132, v133
    v_max3_f32 v8, v8, v134, v135
    v_max3_f32 v8, v8, v136, v137
    v_max3_f32 v8, v8, v138, v139
    v_max3_f32 v8, v8, v140, v141
    v_max3_f32 v8, v8, v142, v143
    v_max3_f32 v8, v8, v144, v145
    v_max3_f32 v8, v8, v146, v147
    v_max3_f32 v8, v8, v148, v149
    v_max3_f32 v8, v8, v150, v151
    v_max3_f32 v8, v8, v152, v153
    v_max3_f32 v8, v8, v154, v155
    v_max3_f32 v8, v8, v156, v157
    v_max3_f32 v8, v8, v158, v159
    v_max3_f32 v8, v8, v160, v161
    v_max3_f32 v8, v8, v162, v163
    v_max3_f32 v8, v8, v164, v165
    v_max3_f32 v8, v8, v166, v167
    v_mfma_f32_32x32x16_bf16 v[104:119], v[168:171], v[16:19], 0
    v_mfma_f32_32x32x8_bf16 v[104:119], v[184:185], v[26:27], v[104:119]
    v_mfma_f32_32x32x16_bf16 v[120:135], v[172:175], v[16:19], 0
    v_mfma_f32_32x32x8_bf16 v[120:135], v[186:187], v[26:27], v[120:135]
    v_mfma_f32_32x32x16_bf16 v[136:151], v[176:179], v[16:19], 0
    v_mfma_f32_32x32x8_bf16 v[136:151], v[184:185], v[34:35], v[136:151]
    v_mfma_f32_32x32x16_bf16 v[152:167], v[180:183], v[16:19], 0
    v_mfma_f32_32x32x8_bf16 v[152:167], v[186:187], v[34:35], v[152:167]
    s_nop 15
    v_max3_f32 v9, v9, v104, v105
    v_max3_f32 v9, v9, v106, v107
    v_max3_f32 v9, v9, v108, v109
    v_max3_f32 v9, v9, v110, v111
    v_max3_f32 v9, v9, v112, v113
    v_max3_f32 v9, v9, v114, v115
    v_max3_f32 v9, v9, v116, v117
    v_max3_f32 v9, v9, v118, v119
    v_max3_f32 v9, v9, v120, v121
    v_max3_f32 v9, v9, v122, v123
    v_max3_f32 v9, v9, v124, v125
    v_max3_f32 v9, v9, v126, v127
    v_max3_f32 v9, v9, v128, v129
    v_max3_f32 v9, v9, v130, v131
    v_max3_f32 v9, v9, v132, v133
    v_max3_f32 v9, v9, v134, v135
    v_max3_f32 v9, v9, v136, v137
    v_max3_f32 v9, v9, v138, v139
    v_max3_f32 v9, v9, v140, v141
    v_max3_f32 v9, v9, v142, v143
    v_max3_f32 v9, v9, v144, v145
    v_max3_f32 v9, v9, v146, v147
    v_max3_f32 v9, v9, v148, v149
    v_max3_f32 v9, v9, v150, v151
    v_max3_f32 v9, v9, v152, v153
    v_max3_f32 v9, v9, v154, v155
    v_max3_f32 v9, v9, v156, v157
    v_max3_f32 v9, v9, v158, v159
    v_max3_f32 v9, v9, v160, v161
    v_max3_f32 v9, v9, v162, v163
    v_max3_f32 v9, v9, v164, v165
    v_max3_f32 v9, v9, v166, v167
    s_add_u32 s42, s42, 10240
    s_sub_u32 s43, s43, 1
    s_cmp_lg_u32 s43, 0
    s_cbranch_scc1 Lfb0
    v_mov_b32 v4, v8
    s_nop 1
    v_permlane32_swap_b32 v8, v4
    v_max_f32 v8, v8, v4
    v_sub_f32 v40, 0, v8
    v_sub_f32 v41, 0, v8
    v_sub_f32 v42, 0, v8
    v_sub_f32 v43, 0, v8
    v_sub_f32 v44, 0, v8
    v_sub_f32 v45, 0, v8
    v_sub_f32 v46, 0, v8
    v_sub_f32 v47, 0, v8
    v_sub_f32 v48, 0, v8
    v_sub_f32 v49, 0, v8
    v_sub_f32 v50, 0, v8
    v_sub_f32 v51, 0, v8
    v_sub_f32 v52, 0, v8
    v_sub_f32 v53, 0, v8
    v_sub_f32 v54, 0, v8
    v_sub_f32 v55, 0, v8
    v_mov_b32 v4, v9
    s_nop 1
    v_permlane32_swap_b32 v9, v4
    v_max_f32 v9, v9, v4
    v_sub_f32 v56, 0, v9
    v_sub_f32 v57, 0, v9
    v_sub_f32 v58, 0, v9
    v_sub_f32 v59, 0, v9
    v_sub_f32 v60, 0, v9
    v_sub_f32 v61, 0, v9
    v_sub_f32 v62, 0, v9
    v_sub_f32 v63, 0, v9
    v_sub_f32 v64, 0, v9
    v_sub_f32 v65, 0, v9
    v_sub_f32 v66, 0, v9
    v_sub_f32 v67, 0, v9
    v_sub_f32 v68, 0, v9
    v_sub_f32 v69, 0, v9
    v_sub_f32 v70, 0, v9
    v_sub_f32 v71, 0, v9
    s_mul_i32 s42, s29, 163840
    s_add_u32 s42, s42, 5242880
    s_mov_b32 s43, 16
    v_mov_b32 v72, 0
    v_mov_b32 v73, 0
    v_mov_b32 v74, 0
    v_mov_b32 v75, 0
    v_mov_b32 v76, 0
    v_mov_b32 v77, 0
    v_mov_b32 v78, 0
    v_mov_b32 v79, 0
    v_mov_b32 v80, 0
    v_mov_b32 v81, 0
    v_mov_b32 v82, 0
    v_mov_b32 v83, 0
    v_mov_b32 v84, 0
    v_mov_b32 v85, 0
    v_mov_b32 v86, 0
    v_mov_b32 v87, 0
    v_mov_b32 v88, 0
    v_mov_b32 v89, 0
    v_mov_b32 v90, 0
    v_mov_b32 v91, 0
    v_mov_b32 v92, 0
    v_mov_b32 v93, 0
    v_mov_b32 v94, 0
    v_mov_b32 v95, 0
    v_mov_b32 v96, 0
    v_mov_b32 v97, 0
    v_mov_b32 v98, 0
    v_mov_b32 v99, 0
    v_mov_b32 v100, 0
    v_mov_b32 v101, 0
    v_mov_b32 v102, 0
    v_mov_b32 v103, 0
Lfb1:
    buffer_load_dwordx4 v[168:171], v37, s[20:23], s42 offen offset:0 sc1
    buffer_load_dwordx4 v[172:175], v37, s[20:23], s42 offen offset:512 sc1
    buffer_load_dwordx4 v[176:179], v37, s[20:23], s42 offen offset:1024 sc1
    buffer_load_dwordx4 v[180:183], v37, s[20:23], s42 offen offset:1536 sc1
    buffer_load_dwordx4 v[184:187], v38, s[20:23], s42 offen sc1
    s_mov_b64 exec, s[40:41]
    buffer_load_dwordx4 v[192:195], v10, s[20:23], s42 offen offset:0 sc1
    buffer_load_dwordx4 v[196:199], v10, s[20:23], s42 offen offset:640 sc1
    buffer_load_dwordx4 v[200:203], v10, s[20:23], s42 offen offset:1280 sc1
    buffer_load_dwordx4 v[204:207], v10, s[20:23], s42 offen offset:1920 sc1
    buffer_load_dwordx4 v[208:211], v11, s[20:23], s42 offen offset:0 sc1
    buffer_load_dwordx4 v[212:215], v11, s[20:23], s42 offen offset:640 sc1
    buffer_load_dwordx4 v[216:219], v11, s[20:23], s42 offen offset:1280 sc1
    buffer_load_dwordx4 v[220:223], v11, s[20:23], s42 offen offset:1920 sc1
    s_mov_b64 exec, -1
    s_waitcnt vmcnt(0)
    v_mfma_f32_32x32x16_bf16 v[104:119], v[168:171], v[12:15], v[40:55]
    v_mfma_f32_32x32x8_bf16 v[104:119], v[184:185], v[24:25], v[104:119]
    v_mfma_f32_32x32x16_bf16 v[120:135], v[172:175], v[12:15], v[40:55]
    v_mfma_f32_32x32x8_bf16 v[120:135], v[186:187], v[24:25], v[120:135]
    v_mfma_f32_32x32x16_bf16 v[136:151], v[176:179], v[12:15], v[40:55]
    v_mfma_f32_32x32x8_bf16 v[136:151], v[184:185], v[32:33], v[136:151]
    v_mfma_f32_32x32x16_bf16 v[152:167], v[180:183], v[12:15], v[40:55]
    v_mfma_f32_32x32x8_bf16 v[152:167], v[186:187], v[32:33], v[152:167]
    s_nop 15
    v_exp_f32 v104, v104
    v_exp_f32 v105, v105
    v_exp_f32 v106, v106
    v_exp_f32 v107, v107
    v_exp_f32 v108, v108
    v_exp_f32 v109, v109
    v_exp_f32 v110, v110
    v_exp_f32 v111, v111
    v_exp_f32 v112, v112
    v_exp_f32 v113, v113
    v_exp_f32 v114, v114
    v_exp_f32 v115, v115
    v_exp_f32 v116, v116
    v_exp_f32 v117, v117
    v_exp_f32 v118, v118
    v_exp_f32 v119, v119
    v_exp_f32 v120, v120
    v_exp_f32 v121, v121
    v_exp_f32 v122, v122
    v_exp_f32 v123, v123
    v_exp_f32 v124, v124
    v_exp_f32 v125, v125
    v_exp_f32 v126, v126
    v_exp_f32 v127, v127
    v_exp_f32 v128, v128
    v_exp_f32 v129, v129
    v_exp_f32 v130, v130
    v_exp_f32 v131, v131
    v_exp_f32 v132, v132
    v_exp_f32 v133, v133
    v_exp_f32 v134, v134
    v_exp_f32 v135, v135
    v_exp_f32 v136, v136
    v_exp_f32 v137, v137
    v_exp_f32 v138, v138
    v_exp_f32 v139, v139
    v_exp_f32 v140, v140
    v_exp_f32 v141, v141
    v_exp_f32 v142, v142
    v_exp_f32 v143, v143
    v_exp_f32 v144, v144
    v_exp_f32 v145, v145
    v_exp_f32 v146, v146
    v_exp_f32 v147, v147
    v_exp_f32 v148, v148
    v_exp_f32 v149, v149
    v_exp_f32 v150, v150
    v_exp_f32 v151, v151
    v_exp_f32 v152, v152
    v_exp_f32 v153, v153
    v_exp_f32 v154, v154
    v_exp_f32 v155, v155
    v_exp_f32 v156, v156
    v_exp_f32 v157, v157
    v_exp_f32 v158, v158
    v_exp_f32 v159, v159
    v_exp_f32 v160, v160
    v_exp_f32 v161, v161
    v_exp_f32 v162, v162
    v_exp_f32 v163, v163
    v_exp_f32 v164, v164
    v_exp_f32 v165, v165
    v_exp_f32 v166, v166
    v_exp_f32 v167, v167
    s_nop 1
    v_smfmac_f32_32x32x32_bf16 v[72:87], v[192:195], v[104:111], v36
    v_smfmac_f32_32x32x32_bf16 v[72:87], v[196:199], v[112:119], v36
    v_smfmac_f32_32x32x32_bf16 v[72:87], v[200:203], v[120:127], v36
    v_smfmac_f32_32x32x32_bf16 v[72:87], v[204:207], v[128:135], v36
    v_smfmac_f32_32x32x32_bf16 v[72:87], v[208:211], v[136:143], v36
    v_smfmac_f32_32x32x32_bf16 v[72:87], v[212:215], v[144:151], v36
    v_smfmac_f32_32x32x32_bf16 v[72:87], v[216:219], v[152:159], v36
    v_smfmac_f32_32x32x32_bf16 v[72:87], v[220:223], v[160:167], v36
    v_mfma_f32_32x32x16_bf16 v[104:119], v[168:171], v[16:19], v[56:71]
    v_mfma_f32_32x32x8_bf16 v[104:119], v[184:185], v[26:27], v[104:119]
    v_mfma_f32_32x32x16_bf16 v[120:135], v[172:175], v[16:19], v[56:71]
    v_mfma_f32_32x32x8_bf16 v[120:135], v[186:187], v[26:27], v[120:135]
    v_mfma_f32_32x32x16_bf16 v[136:151], v[176:179], v[16:19], v[56:71]
    v_mfma_f32_32x32x8_bf16 v[136:151], v[184:185], v[34:35], v[136:151]
    v_mfma_f32_32x32x16_bf16 v[152:167], v[180:183], v[16:19], v[56:71]
    v_mfma_f32_32x32x8_bf16 v[152:167], v[186:187], v[34:35], v[152:167]
    s_nop 15
    v_exp_f32 v104, v104
    v_exp_f32 v105, v105
    v_exp_f32 v106, v106
    v_exp_f32 v107, v107
    v_exp_f32 v108, v108
    v_exp_f32 v109, v109
    v_exp_f32 v110, v110
    v_exp_f32 v111, v111
    v_exp_f32 v112, v112
    v_exp_f32 v113, v113
    v_exp_f32 v114, v114
    v_exp_f32 v115, v115
    v_exp_f32 v116, v116
    v_exp_f32 v117, v117
    v_exp_f32 v118, v118
    v_exp_f32 v119, v119
    v_exp_f32 v120, v120
    v_exp_f32 v121, v121
    v_exp_f32 v122, v122
    v_exp_f32 v123, v123
    v_exp_f32 v124, v124
    v_exp_f32 v125, v125
    v_exp_f32 v126, v126
    v_exp_f32 v127, v127
    v_exp_f32 v128, v128
    v_exp_f32 v129, v129
    v_exp_f32 v130, v130
    v_exp_f32 v131, v131
    v_exp_f32 v132, v132
    v_exp_f32 v133, v133
    v_exp_f32 v134, v134
    v_exp_f32 v135, v135
    v_exp_f32 v136, v136
    v_exp_f32 v137, v137
    v_exp_f32 v138, v138
    v_exp_f32 v139, v139
    v_exp_f32 v140, v140
    v_exp_f32 v141, v141
    v_exp_f32 v142, v142
    v_exp_f32 v143, v143
    v_exp_f32 v144, v144
    v_exp_f32 v145, v145
    v_exp_f32 v146, v146
    v_exp_f32 v147, v147
    v_exp_f32 v148, v148
    v_exp_f32 v149, v149
    v_exp_f32 v150, v150
    v_exp_f32 v151, v151
    v_exp_f32 v152, v152
    v_exp_f32 v153, v153
    v_exp_f32 v154, v154
    v_exp_f32 v155, v155
    v_exp_f32 v156, v156
    v_exp_f32 v157, v157
    v_exp_f32 v158, v158
    v_exp_f32 v159, v159
    v_exp_f32 v160, v160
    v_exp_f32 v161, v161
    v_exp_f32 v162, v162
    v_exp_f32 v163, v163
    v_exp_f32 v164, v164
    v_exp_f32 v165, v165
    v_exp_f32 v166, v166
    v_exp_f32 v167, v167
    s_nop 1
    v_smfmac_f32_32x32x32_bf16 v[88:103], v[192:195], v[104:111], v36
    v_smfmac_f32_32x32x32_bf16 v[88:103], v[196:199], v[112:119], v36
    v_smfmac_f32_32x32x32_bf16 v[88:103], v[200:203], v[120:127], v36
    v_smfmac_f32_32x32x32_bf16 v[88:103], v[204:207], v[128:135], v36
    v_smfmac_f32_32x32x32_bf16 v[88:103], v[208:211], v[136:143], v36
    v_smfmac_f32_32x32x32_bf16 v[88:103], v[212:215], v[144:151], v36
    v_smfmac_f32_32x32x32_bf16 v[88:103], v[216:219], v[152:159], v36
    v_smfmac_f32_32x32x32_bf16 v[88:103], v[220:223], v[160:167], v36
    s_add_u32 s42, s42, 10240
    s_sub_u32 s43, s43, 1
    s_cmp_lg_u32 s43, 0
    s_cbranch_scc1 Lfb1
    s_nop 15
    s_branch Lchk
Lh2:
    s_setprio 0
    s_and_b32 s33, s32, 3
    s_lshl_b32 s29, s31, 2
    s_add_u32 s29, s29, s33
    s_lshr_b32 s30, s32, 2
    s_and_b32 s33, s32, 1
    s_lshl_b32 s62, s31, 1
    s_add_u32 s62, s62, s33
    s_lshr_b32 s63, s32, 1
    v_lshlrev_b32 v1, 4, v0
    s_lshl_b32 s54, s28, 8
    s_add_u32 s54, s54, s2
    s_and_b32 s34, s54, 7
    s_lshr_b32 s35, s54, 3
    s_mul_i32 s49, s35, 21846
    s_lshr_b32 s49, s49, 16
    s_mul_i32 s48, s49, 3
    s_sub_u32 s48, s35, s48
    s_lshl_b32 s48, s48, 4
    s_add_u32 s48, s48, s49
    s_cmp_ge_u32 s35, 48
    s_cselect_b32 s48, s35, s48
    s_sub_u32 s36, s35, 54
    s_cselect_b32 s48, s48, s36
    s_cselect_b32 s12, s76, s68
    s_cselect_b32 s13, s77, s69
    s_mov_b32 s14, 819200
    s_cselect_b32 s14, 2211840, s14
    s_mov_b32 s15, 0x20000
    s_cselect_b32 s35, s35, s36
    s_cselect_b32 s37, 54, 20
    s_mov_b32 s56, 22806528
    s_cselect_b32 s56, 23625728, s56
    s_cselect_b32 s44, 8, 20
    s_cselect_b32 s47, 16, 8
    s_cselect_b32 s45, 32, 40
    s_mul_i32 s37, s37, s34
    s_add_u32 s37, s37, s48
    s_mul_i32 s37, s37, 5120
    s_add_u32 s56, s56, s37
    s_cmp_ge_u32 s54, 560
    s_cselect_b32 s44, 80, s44
    s_cselect_b32 s45, 160, s45
    s_cselect_b32 s46, 20, 4
    s_cselect_b32 s47, 40, s47
    s_cselect_b32 s36, -2544, 0
    s_mul_i32 s50, s35, s45
    s_add_u32 s50, s50, s36
    s_add_u32 s51, s50, s47
    s_mul_i32 s50, s50, 1280
    s_mul_i32 s51, s51, 1280
    s_mul_i32 s34, s34, 160
    s_add_u32 s50, s50, s34
    s_add_u32 s51, s51, s34
    v_lshrrev_b32 v2, 5, v0
    v_mul_u32_u24 v2, s44, v2
    v_bfe_u32 v3, v0, 4, 1
    v_mul_u32_u24 v3, s46, v3
    v_add_u32 v2, v2, v3
    v_mul_u32_u24 v2, 1280, v2
    v_and_b32 v3, 15, v0
    v_lshl_add_u32 v9, v3, 1, v2
    v_bfe_u32 v3, v0, 2, 2
    v_mul_u32_u24 v3, 24, v3
    v_add_u32 v8, v9, v3
    s_mov_b32 s16, s72
    s_mov_b32 s17, s73
    s_mov_b32 s18, 2211840
    s_mov_b32 s19, 0x20000
    s_lshl_b32 s38, s28, 10
    s_mul_i32 s33, s29, 20
    s_add_u32 s34, s33, 19
    s_lshr_b32 s33, s33, 6
    s_lshr_b32 s34, s34, 6
    s_sub_u32 s34, s34, s33
    s_add_u32 s33, s33, 10
    v_bfe_u32 v3, v0, 1, 1
    v_mul_u32_u24 v3, s34, v3
    v_bfe_u32 v4, v0, 2, 1
    v_mul_u32_u24 v4, 10, v4
    v_add3_u32 v3, v3, v4, s33
    v_bfe_u32 v4, v0, 3, 2
    v_lshl_add_u32 v4, v4, 2, s28
    v_lshl_add_u32 v3, v3, 4, v4
    v_and_b32 v4, 1, v0
    v_lshl_add_u32 v3, v3, 1, v4
    v_lshlrev_b32 v3, 7, v3
    v_add_u32 v3, 28598272, v3
    v_mov_b32 v16, s100
    v_mov_b32 v17, 0
    s_lshl_b32 s33, s30, 7
    s_add_u32 s33, s33, 28467200
    v_lshl_add_u32 v14, v0, 10, s33
    v_min_u32 v2, 59, v0
    s_add_u32 s33, s33, 14336
    v_lshl_add_u32 v15, v2, 10, s33
    s_mul_i32 s33, s63, 20
    s_add_u32 s33, s33, 592
    s_cmp_ge_u32 s63, 6
    s_cselect_b32 s34, 20, 0
    s_add_u32 s34, s34, 892
    v_add_u32 v2, s33, v0
    v_cmp_gt_u32 vcc, 20, v0
    v_add_u32 v4, s34, v0
    s_nop 0
    v_cndmask_b32 v4, v4, v2, vcc
    v_cmp_gt_u32 vcc, 40, v0
    v_lshlrev_b32 v4, 7, v4
    v_add_u32 v4, 28467200, v4
    v_cndmask_b32 v15, v15, v4, vcc
    v_and_b32 v2, 31, v0
    s_lshl_b32 s33, s29, 7
    s_add_u32 s33, s33, 28991488
    v_lshl_add_u32 v10, v2, 2, s33
    v_add_u32 v11, 131072, v10
    v_add_u32 v12, 262144, v10
    s_min_u32 s34, s28, 2
    s_mul_i32 s34, s34, 131072
    s_add_u32 s33, s33, s34
    v_mov_b32 v19, s33
    s_lshl_b32 s33, s54, 7
    s_add_u32 s33, s33, 28467200
    v_writelane_b32 v19, s33, 0
    s_lshl_b32 s33, s29, 2
    s_add_u32 s33, s33, s28
    s_lshl_b32 s33, s33, 7
    s_add_u32 s33, s33, 28729344
    v_writelane_b32 v19, s33, 1
    s_lshl_b32 s33, s62, 2
    s_add_u32 s33, s33, s28
    s_lshl_b32 s33, s33, 7
    s_add_u32 s33, s33, 28860416
    v_writelane_b32 v19, s33, 2
    s_mul_i32 s40, s29, 163840
    s_add_u32 s40, s40, 5242880
    s_mul_i32 s41, s28, 10240
    s_add_u32 s40, s40, s41
    s_mov_b32 s42, 0x01010101
    s_mov_b32 s43, 0
    s_mov_b32 s60, 200000
    s_setprio 3
    s_barrier
Lkv:
    s_cmp_lg_u32 s43, 0
    s_cbranch_scc1 Lkv_go
Lkv_poll:
    s_sleep 3
    s_mov_b32 exec_hi, 0
    buffer_load_dword v4, v3, s[20:23], 0 offen sc1
    s_waitcnt vmcnt(0)
    v_cmp_ne_u32 vcc, s100, v4
    s_mov_b64 exec, -1
    s_lshr_b32 s33, vcc_lo, 1
    s_or_b32 s33, s33, vcc_lo
    s_lshr_b32 s34, s33, 2
    s_or_b32 s33, s33, s34
    s_lshr_b32 s34, s33, 4
    s_or_b32 s33, s33, s34
    s_sub_u32 s60, s60, 1
    s_cselect_b32 s33, 0, s33
    s_andn2_b32 s43, s42, s33
    s_cbranch_scc0 Lkv_poll
Lkv_go:
    s_ff1_i32_b32 s33, s43
    s_bitset0_b32 s43, s33
    s_bitset0_b32 s42, s33
    s_mul_i32 s39, s33, 5120
    s_add_u32 s39, s39, s40
    s_cmp_ge_u32 s41, 40960
    s_cbranch_scc1 Lkv_l
    s_add_u32 m0, s41, 0
    s_add_u32 s33, s39, 0
    buffer_load_dwordx4 v1, s[20:23], s33 offen offset:0 sc1 lds
    buffer_load_dwordx4 v1, s[20:23], s33 offen offset:1024 sc1 lds
    buffer_load_dwordx4 v1, s[20:23], s33 offen offset:2048 sc1 lds
    buffer_load_dwordx4 v1, s[20:23], s33 offen offset:3072 sc1 lds
    s_add_u32 m0, s41, 4096
    s_add_u32 s33, s39, 4096
    buffer_load_dwordx4 v1, s[20:23], s33 offen offset:0 sc1 lds
    buffer_load_dwordx4 v1, s[20:23], s33 offen offset:1024 sc1 lds
    buffer_load_dwordx4 v1, s[20:23], s33 offen offset:2048 sc1 lds
    buffer_load_dwordx4 v1, s[20:23], s33 offen offset:3072 sc1 lds
    s_add_u32 m0, s41, 8192
    s_add_u32 s33, s39, 8192
    buffer_load_dwordx4 v1, s[20:23], s33 offen offset:0 sc1 lds
    buffer_load_dwordx4 v1, s[20:23], s33 offen offset:1024 sc1 lds
    s_waitcnt vmcnt(0)
    s_barrier
    s_branch Lkv_n
Lkv_l:
    s_add_u32 m0, s41, 0
    s_add_u32 s33, s39, 0
    buffer_load_dwordx4 v1, s[20:23], s33 offen offset:0 sc1 lds
    buffer_load_dwordx4 v1, s[20:23], s33 offen offset:1024 sc1 lds
    buffer_load_dwordx4 v1, s[20:23], s33 offen offset:2048 sc1 lds
    buffer_load_dwordx4 v1, s[20:23], s33 offen offset:3072 sc1 lds
    s_add_u32 m0, s41, 4096
    s_add_u32 s33, s39, 4096
    buffer_load_dwordx4 v1, s[20:23], s33 offen offset:0 sc1 lds
    buffer_load_dwordx4 v1, s[20:23], s33 offen offset:1024 sc1 lds
    buffer_load_dwordx4 v1, s[20:23], s33 offen offset:2048 sc1 lds
    buffer_load_dwordx4 v1, s[20:23], s33 offen offset:3072 sc1 lds
    s_add_u32 m0, s41, 8192
    s_add_u32 s33, s39, 8192
    buffer_load_dwordx4 v1, s[20:23], s33 offen offset:0 sc1 lds
    buffer_load_dwordx4 v1, s[20:23], s33 offen offset:1024 sc1 lds
Lkv_n:
    s_add_u32 s41, s41, 40960
    s_cmp_lg_u32 s42, 0
    s_cbranch_scc1 Lkv
    s_lshl_b32 s57, s54, 7
    s_add_u32 s57, s57, 28467200
    buffer_load_dword v18, v19, s[20:23], 0 offen sc1
    s_cmp_ge_u32 s54, 592
    s_cbranch_scc1 Lh2n
    buffer_load_ushort v32, v8, s[12:15], s50 offen offset:0
    buffer_load_short_d16_hi v36, v8, s[12:15], s50 offen offset:1280
    buffer_load_ushort v33, v8, s[12:15], s50 offen offset:2560
    buffer_load_short_d16_hi v37, v8, s[12:15], s50 offen offset:3840
    buffer_load_ushort v34, v8, s[12:15], s51 offen offset:0
    buffer_load_short_d16_hi v38, v8, s[12:15], s51 offen offset:1280
    buffer_load_ushort v35, v8, s[12:15], s51 offen offset:2560
    buffer_load_short_d16_hi v39, v8, s[12:15], s51 offen offset:3840
    buffer_load_ushort v40, v8, s[12:15], s50 offen offset:8
    buffer_load_short_d16_hi v44, v8, s[12:15], s50 offen offset:1288
    buffer_load_ushort v41, v8, s[12:15], s50 offen offset:2568
    buffer_load_short_d16_hi v45, v8, s[12:15], s50 offen offset:3848
    buffer_load_ushort v42, v8, s[12:15], s51 offen offset:8
    buffer_load_short_d16_hi v46, v8, s[12:15], s51 offen offset:1288
    buffer_load_ushort v43, v8, s[12:15], s51 offen offset:2568
    buffer_load_short_d16_hi v47, v8, s[12:15], s51 offen offset:3848
    s_waitcnt vmcnt(17)
    s_barrier
    buffer_load_ushort v48, v8, s[12:15], s50 offen offset:16
    buffer_load_short_d16_hi v52, v8, s[12:15], s50 offen offset:1296
    buffer_load_ushort v49, v8, s[12:15], s50 offen offset:2576
    buffer_load_short_d16_hi v53, v8, s[12:15], s50 offen offset:3856
    buffer_load_ushort v50, v8, s[12:15], s51 offen offset:16
    buffer_load_short_d16_hi v54, v8, s[12:15], s51 offen offset:1296
    buffer_load_ushort v51, v8, s[12:15], s51 offen offset:2576
    buffer_load_short_d16_hi v55, v8, s[12:15], s51 offen offset:3856
    buffer_load_ushort v56, v8, s[12:15], s50 offen offset:24
    buffer_load_short_d16_hi v60, v8, s[12:15], s50 offen offset:1304
    buffer_load_ushort v57, v8, s[12:15], s50 offen offset:2584
    buffer_load_short_d16_hi v61, v8, s[12:15], s50 offen offset:3864
    buffer_load_ushort v58, v8, s[12:15], s51 offen offset:24
    buffer_load_short_d16_hi v62, v8, s[12:15], s51 offen offset:1304
    buffer_load_ushort v59, v8, s[12:15], s51 offen offset:2584
    buffer_load_short_d16_hi v63, v8, s[12:15], s51 offen offset:3864
    buffer_load_ushort v64, v9, s[12:15], s50 offen offset:128
    buffer_load_short_d16_hi v68, v9, s[12:15], s50 offen offset:1408
    buffer_load_ushort v65, v9, s[12:15], s50 offen offset:2688
    buffer_load_short_d16_hi v69, v9, s[12:15], s50 offen offset:3968
    buffer_load_ushort v66, v9, s[12:15], s51 offen offset:128
    buffer_load_short_d16_hi v70, v9, s[12:15], s51 offen offset:1408
    buffer_load_ushort v67, v9, s[12:15], s51 offen offset:2688
    buffer_load_short_d16_hi v71, v9, s[12:15], s51 offen offset:3968
    v_add_u32 v2, 4096, v1
    s_mov_b32 s33, 0xffff0000
    s_waitcnt vmcnt(32)
    v_and_or_b32 v32, v36, s33, v32
    v_and_or_b32 v33, v37, s33, v33
    v_and_or_b32 v34, v38, s33, v34
    v_and_or_b32 v35, v39, s33, v35
    buffer_store_dwordx4 v[32:35], v1, s[20:23], s56 offen offset:0 sc1
    s_waitcnt vmcnt(25)
    v_and_or_b32 v40, v44, s33, v40
    v_and_or_b32 v41, v45, s33, v41
    v_and_or_b32 v42, v46, s33, v42
    v_and_or_b32 v43, v47, s33, v43
    buffer_store_dwordx4 v[40:43], v1, s[20:23], s56 offen offset:1024 sc1
    s_waitcnt vmcnt(18)
    v_and_or_b32 v48, v52, s33, v48
    v_and_or_b32 v49, v53, s33, v49
    v_and_or_b32 v50, v54, s33, v50
    v_and_or_b32 v51, v55, s33, v51
    buffer_store_dwordx4 v[48:51], v1, s[20:23], s56 offen offset:2048 sc1
    s_waitcnt vmcnt(11)
    v_and_or_b32 v56, v60, s33, v56
    v_and_or_b32 v57, v61, s33, v57
    v_and_or_b32 v58, v62, s33, v58
    v_and_or_b32 v59, v63, s33, v59
    buffer_store_dwordx4 v[56:59], v1, s[20:23], s56 offen offset:3072 sc1
    s_waitcnt vmcnt(4)
    v_and_or_b32 v64, v68, s33, v64
    v_and_or_b32 v65, v69, s33, v65
    v_and_or_b32 v66, v70, s33, v66
    v_and_or_b32 v67, v71, s33, v67
    buffer_store_dwordx4 v[64:67], v2, s[20:23], s56 offen sc1
    s_branch Lh2a
Lh2n:
    s_sub_u32 s34, s54, 592
    s_min_u32 s34, s34, 359
    s_mul_i32 s35, s34, 3277
    s_lshr_b32 s35, s35, 16
    s_mul_i32 s36, s35, 20
    s_sub_u32 s34, s34, s36
    s_mul_i32 s50, s34, 110592
    s_mul_i32 s36, s35, 192
    s_add_u32 s50, s50, s36
    s_add_u32 s51, s50, 6912
    s_add_u32 s52, s50, 13824
    s_add_u32 s53, s50, 20736
    s_mul_i32 s56, s35, 143360
    s_sub_u32 s36, s35, 16
    s_mul_i32 s36, s36, 860160
    s_add_u32 s36, s36, 6144
    s_cmp_lt_u32 s35, 16
    s_cselect_b32 s56, s56, s36
    s_mov_b32 s37, 143360
    s_cselect_b32 s37, 1024, s37
    s_mul_i32 s34, s34, 7168
    s_add_u32 s56, s56, s34
    s_add_u32 s56, s56, 25837568
    v_lshrrev_b32 v2, 4, v0
    v_mul_u32_u24 v2, 27648, v2
    v_and_b32 v3, 15, v0
    v_lshl_add_u32 v8, v3, 1, v2
    s_cmp_ge_u32 s54, 952
    s_cbranch_scc0 Lrw1
    s_waitcnt vmcnt(0)
    s_barrier
    s_branch Lh2a
Lrw1:
    buffer_load_ushort v32, v8, s[16:19], s50 offen offset:0
    buffer_load_short_d16_hi v36, v8, s[16:19], s50 offen offset:3456
    buffer_load_ushort v33, v8, s[16:19], s51 offen offset:0
    buffer_load_short_d16_hi v37, v8, s[16:19], s51 offen offset:3456
    buffer_load_ushort v34, v8, s[16:19], s52 offen offset:0
    buffer_load_short_d16_hi v38, v8, s[16:19], s52 offen offset:3456
    buffer_load_ushort v35, v8, s[16:19], s53 offen offset:0
    buffer_load_short_d16_hi v39, v8, s[16:19], s53 offen offset:3456
    buffer_load_ushort v40, v8, s[16:19], s50 offen offset:32
    buffer_load_short_d16_hi v44, v8, s[16:19], s50 offen offset:3488
    buffer_load_ushort v41, v8, s[16:19], s51 offen offset:32
    buffer_load_short_d16_hi v45, v8, s[16:19], s51 offen offset:3488
    buffer_load_ushort v42, v8, s[16:19], s52 offen offset:32
    buffer_load_short_d16_hi v46, v8, s[16:19], s52 offen offset:3488
    buffer_load_ushort v43, v8, s[16:19], s53 offen offset:32
    buffer_load_short_d16_hi v47, v8, s[16:19], s53 offen offset:3488
    s_waitcnt vmcnt(17)
    s_barrier
    buffer_load_ushort v48, v8, s[16:19], s50 offen offset:64
    buffer_load_short_d16_hi v52, v8, s[16:19], s50 offen offset:3520
    buffer_load_ushort v49, v8, s[16:19], s51 offen offset:64
    buffer_load_short_d16_hi v53, v8, s[16:19], s51 offen offset:3520
    buffer_load_ushort v50, v8, s[16:19], s52 offen offset:64
    buffer_load_short_d16_hi v54, v8, s[16:19], s52 offen offset:3520
    buffer_load_ushort v51, v8, s[16:19], s53 offen offset:64
    buffer_load_short_d16_hi v55, v8, s[16:19], s53 offen offset:3520
    buffer_load_ushort v56, v8, s[16:19], s50 offen offset:96
    buffer_load_short_d16_hi v60, v8, s[16:19], s50 offen offset:3552
    buffer_load_ushort v57, v8, s[16:19], s51 offen offset:96
    buffer_load_short_d16_hi v61, v8, s[16:19], s51 offen offset:3552
    buffer_load_ushort v58, v8, s[16:19], s52 offen offset:96
    buffer_load_short_d16_hi v62, v8, s[16:19], s52 offen offset:3552
    buffer_load_ushort v59, v8, s[16:19], s53 offen offset:96
    buffer_load_short_d16_hi v63, v8, s[16:19], s53 offen offset:3552
    buffer_load_ushort v64, v8, s[16:19], s50 offen offset:128
    buffer_load_short_d16_hi v68, v8, s[16:19], s50 offen offset:3584
    buffer_load_ushort v65, v8, s[16:19], s51 offen offset:128
    buffer_load_short_d16_hi v69, v8, s[16:19], s51 offen offset:3584
    buffer_load_ushort v66, v8, s[16:19], s52 offen offset:128
    buffer_load_short_d16_hi v70, v8, s[16:19], s52 offen offset:3584
    buffer_load_ushort v67, v8, s[16:19], s53 offen offset:128
    buffer_load_short_d16_hi v71, v8, s[16:19], s53 offen offset:3584
    buffer_load_ushort v72, v8, s[16:19], s50 offen offset:160
    buffer_load_short_d16_hi v76, v8, s[16:19], s50 offen offset:3616
    buffer_load_ushort v73, v8, s[16:19], s51 offen offset:160
    buffer_load_short_d16_hi v77, v8, s[16:19], s51 offen offset:3616
    buffer_load_ushort v74, v8, s[16:19], s52 offen offset:160
    buffer_load_short_d16_hi v78, v8, s[16:19], s52 offen offset:3616
    buffer_load_ushort v75, v8, s[16:19], s53 offen offset:160
    buffer_load_short_d16_hi v79, v8, s[16:19], s53 offen offset:3616
    s_mov_b32 s33, 0xffff0000
    s_waitcnt vmcnt(40)
    v_and_or_b32 v32, v36, s33, v32
    v_and_or_b32 v33, v37, s33, v33
    v_and_or_b32 v34, v38, s33, v34
    v_and_or_b32 v35, v39, s33, v35
    buffer_store_dwordx4 v[32:35], v1, s[20:23], s56 offen sc1
    s_add_u32 s56, s56, s37
    s_waitcnt vmcnt(33)
    v_and_or_b32 v40, v44, s33, v40
    v_and_or_b32 v41, v45, s33, v41
    v_and_or_b32 v42, v46, s33, v42
    v_and_or_b32 v43, v47, s33, v43
    buffer_store_dwordx4 v[40:43], v1, s[20:23], s56 offen sc1
    s_add_u32 s56, s56, s37
    s_waitcnt vmcnt(26)
    v_and_or_b32 v48, v52, s33, v48
    v_and_or_b32 v49, v53, s33, v49
    v_and_or_b32 v50, v54, s33, v50
    v_and_or_b32 v51, v55, s33, v51
    buffer_store_dwordx4 v[48:51], v1, s[20:23], s56 offen sc1
    s_add_u32 s56, s56, s37
    s_waitcnt vmcnt(19)
    v_and_or_b32 v56, v60, s33, v56
    v_and_or_b32 v57, v61, s33, v57
    v_and_or_b32 v58, v62, s33, v58
    v_and_or_b32 v59, v63, s33, v59
    buffer_store_dwordx4 v[56:59], v1, s[20:23], s56 offen sc1
    s_add_u32 s56, s56, s37
    s_waitcnt vmcnt(12)
    v_and_or_b32 v64, v68, s33, v64
    v_and_or_b32 v65, v69, s33, v65
    v_and_or_b32 v66, v70, s33, v66
    v_and_or_b32 v67, v71, s33, v67
    buffer_store_dwordx4 v[64:67], v1, s[20:23], s56 offen sc1
    s_add_u32 s56, s56, s37
    s_waitcnt vmcnt(5)
    v_and_or_b32 v72, v76, s33, v72
    v_and_or_b32 v73, v77, s33, v73
    v_and_or_b32 v74, v78, s33, v74
    v_and_or_b32 v75, v79, s33, v75
    buffer_store_dwordx4 v[72:75], v1, s[20:23], s56 offen sc1
    s_add_u32 s56, s56, s37
Lh2a:
    s_waitcnt vmcnt(0)
    s_mov_b64 exec, 1
    buffer_store_dword v16, v17, s[20:23], s57 offen sc1
    s_mov_b64 exec, -1
    s_mov_b32 s60, 200000
    s_mov_b32 exec_lo, 0xffffffff
    s_mov_b32 exec_hi, 0x3fffff
Up40:
    s_sleep 4
    buffer_load_dword v4, v14, s[20:23], 0 offen sc1
    s_sub_u32 s60, s60, 1
    s_cbranch_scc1 Ue41
    s_waitcnt vmcnt(0)
    v_xor_b32 v4, s100, v4
    v_cmp_ne_u32 vcc, 0, v4
    s_nop 1
    s_cmp_lg_u64 vcc, 0
    s_cbranch_scc1 Up40
Ue41:
    s_waitcnt vmcnt(0)
    s_mov_b64 exec, -1
    s_mul_i32 s55, s30, 276480
    s_add_u32 s55, s55, 23625728
    s_add_u32 s55, s55, s38
    s_mov_b32 s39, s55
    buffer_load_dwordx4 v[20:23], v1, s[20:23], s39 offen sc1
    s_add_u32 s39, s39, 4096
    buffer_load_dwordx4 v[24:27], v1, s[20:23], s39 offen sc1
    s_add_u32 s39, s39, 4096
    buffer_load_dwordx4 v[28:31], v1, s[20:23], s39 offen sc1
    s_add_u32 s39, s39, 4096
    buffer_load_dwordx4 v[32:35], v1, s[20:23], s39 offen sc1
    s_add_u32 s39, s39, 4096
    buffer_load_dwordx4 v[36:39], v1, s[20:23], s39 offen sc1
    s_add_u32 s39, s39, 4096
    buffer_load_dwordx4 v[40:43], v1, s[20:23], s39 offen sc1
    s_add_u32 s39, s39, 4096
    buffer_load_dwordx4 v[44:47], v1, s[20:23], s39 offen sc1
    s_add_u32 s39, s39, 4096
    buffer_load_dwordx4 v[48:51], v1, s[20:23], s39 offen sc1
    s_add_u32 s39, s39, 4096
    buffer_load_dwordx4 v[52:55], v1, s[20:23], s39 offen sc1
    s_add_u32 s39, s39, 4096
    buffer_load_dwordx4 v[56:59], v1, s[20:23], s39 offen sc1
    s_add_u32 s39, s39, 4096
    buffer_load_dwordx4 v[60:63], v1, s[20:23], s39 offen sc1
    s_add_u32 s39, s39, 4096
    buffer_load_dwordx4 v[64:67], v1, s[20:23], s39 offen sc1
    s_add_u32 s39, s39, 4096
    buffer_load_dwordx4 v[68:71], v1, s[20:23], s39 offen sc1
    s_add_u32 s39, s39, 4096
    buffer_load_dwordx4 v[72:75], v1, s[20:23], s39 offen sc1
    s_add_u32 s39, s39, 4096
    buffer_load_dwordx4 v[76:79], v1, s[20:23], s39 offen sc1
    s_add_u32 s39, s39, 4096
    buffer_load_dwordx4 v[80:83], v1, s[20:23], s39 offen sc1
    s_add_u32 s39, s39, 4096
    buffer_load_dwordx4 v[84:87], v1, s[20:23], s39 offen sc1
    s_add_u32 s39, s39, 4096
    buffer_load_dwordx4 v[88:91], v1, s[20:23], s39 offen sc1
    s_add_u32 s39, s39, 4096
    buffer_load_dwordx4 v[92:95], v1, s[20:23], s39 offen sc1
    s_add_u32 s39, s39, 4096
    buffer_load_dwordx4 v[96:99], v1, s[20:23], s39 offen sc1
    s_add_u32 s39, s39, 4096
    buffer_load_dword v13, v15, s[20:23], 0 offen sc1
    buffer_load_dwordx4 v[100:103], v1, s[20:23], s39 offen sc1
    s_add_u32 s39, s39, 4096
    buffer_load_dwordx4 v[104:107], v1, s[20:23], s39 offen sc1
    s_add_u32 s39, s39, 4096
    buffer_load_dwordx4 v[108:111], v1, s[20:23], s39 offen sc1
    s_add_u32 s39, s39, 4096
    buffer_load_dwordx4 v[112:115], v1, s[20:23], s39 offen sc1
    s_add_u32 s39, s39, 4096
    buffer_load_dwordx4 v[116:119], v1, s[20:23], s39 offen sc1
    s_add_u32 s39, s39, 4096
    buffer_load_dwordx4 v[120:123], v1, s[20:23], s39 offen sc1
    s_add_u32 s39, s39, 4096
    buffer_load_dwordx4 v[124:127], v1, s[20:23], s39 offen sc1
    s_add_u32 s39, s39, 4096
    buffer_load_dwordx4 v[128:131], v1, s[20:23], s39 offen sc1
    s_add_u32 s39, s39, 4096
    buffer_load_dwordx4 v[132:135], v1, s[20:23], s39 offen sc1
    s_add_u32 s39, s39, 4096
    buffer_load_dwordx4 v[136:139], v1, s[20:23], s39 offen sc1
    s_add_u32 s39, s39, 45056
    buffer_load_dwordx4 v[140:143], v1, s[20:23], s39 offen sc1
    s_add_u32 s39, s39, 4096
    buffer_load_dwordx4 v[144:147], v1, s[20:23], s39 offen sc1
    s_add_u32 s39, s39, 4096
    buffer_load_dwordx4 v[148:151], v1, s[20:23], s39 offen sc1
    s_add_u32 s39, s39, 4096
    buffer_load_dwordx4 v[152:155], v1, s[20:23], s39 offen sc1
    s_add_u32 s39, s39, 4096
    buffer_load_dwordx4 v[156:159], v1, s[20:23], s39 offen sc1
    s_add_u32 s39, s39, 4096
    buffer_load_dwordx4 v[160:163], v1, s[20:23], s39 offen sc1
    s_add_u32 s39, s39, 4096
    buffer_load_dwordx4 v[164:167], v1, s[20:23], s39 offen sc1
    s_add_u32 s39, s39, 4096
    s_waitcnt vmcnt(17)
    v_xor_b32 v13, s100, v13
    v_cmp_ne_u32 vcc, 0, v13
    s_nop 1
    s_cmp_lg_u64 vcc, 0
    s_cbranch_scc0 Lh_w
    s_mov_b32 s60, 200000
Up42:
    s_sleep 4
    buffer_load_dword v4, v15, s[20:23], 0 offen sc1
    s_sub_u32 s60, s60, 1
    s_cbranch_scc1 Ue43
    s_waitcnt vmcnt(0)
    v_xor_b32 v4, s100, v4
    v_cmp_ne_u32 vcc, 0, v4
    s_nop 1
    s_cmp_lg_u64 vcc, 0
    s_cbranch_scc1 Up42
Ue43:
    s_waitcnt vmcnt(0)
    s_mov_b64 exec, -1
Lh_w:
    s_mov_b32 s57, s39
    s_mul_i32 s39, s63, 143360
    s_add_u32 s39, s39, 25894912
    s_add_u32 s39, s39, s38
    buffer_load_dwordx4 v[168:171], v1, s[20:23], s39 offen sc1
    s_add_u32 s39, s39, 4096
    buffer_load_dwordx4 v[172:175], v1, s[20:23], s39 offen sc1
    s_add_u32 s39, s39, 4096
    buffer_load_dwordx4 v[176:179], v1, s[20:23], s39 offen sc1
    s_add_u32 s39, s39, 4096
    buffer_load_dwordx4 v[180:183], v1, s[20:23], s39 offen sc1
    s_add_u32 s39, s39, 4096
    buffer_load_dwordx4 v[184:187], v1, s[20:23], s39 offen sc1
    s_add_u32 s39, s39, 4096
    buffer_load_dwordx4 v[188:191], v1, s[20:23], s39 offen sc1
    s_add_u32 s39, s39, 4096
    buffer_load_dwordx4 v[192:195], v1, s[20:23], s39 offen sc1
    s_add_u32 s39, s39, 4096
    buffer_load_dwordx4 v[196:199], v1, s[20:23], s39 offen sc1
    s_add_u32 s39, s39, 4096
    buffer_load_dwordx4 v[200:203], v1, s[20:23], s39 offen sc1
    s_add_u32 s39, s39, 4096
    buffer_load_dwordx4 v[204:207], v1, s[20:23], s39 offen sc1
    s_add_u32 s39, s39, 4096
    buffer_load_dwordx4 v[208:211], v1, s[20:23], s39 offen sc1
    s_add_u32 s39, s39, 4096
    buffer_load_dwordx4 v[212:215], v1, s[20:23], s39 offen sc1
    s_add_u32 s39, s39, 4096
    buffer_load_dwordx4 v[216:219], v1, s[20:23], s39 offen sc1
    s_add_u32 s39, s39, 4096
    buffer_load_dwordx4 v[220:223], v1, s[20:23], s39 offen sc1
    s_add_u32 s39, s39, 4096
    buffer_load_dwordx4 v[224:227], v1, s[20:23], s39 offen sc1
    s_add_u32 s39, s39, 4096
    buffer_load_dwordx4 v[228:231], v1, s[20:23], s39 offen sc1
    s_add_u32 s39, s39, 4096
    buffer_load_dwordx4 v[232:235], v1, s[20:23], s39 offen sc1
    s_add_u32 s39, s39, 4096
    buffer_load_dwordx4 v[236:239], v1, s[20:23], s39 offen sc1
    s_add_u32 s39, s39, 4096
    buffer_load_dwordx4 v[240:243], v1, s[20:23], s39 offen sc1
    s_add_u32 s39, s39, 4096
    buffer_load_dwordx4 v[244:247], v1, s[20:23], s39 offen sc1
    s_add_u32 s39, s39, 4096
    buffer_load_dwordx4 v[248:251], v1, s[20:23], s39 offen sc1
    s_add_u32 s39, s39, 4096
    v_add_u32 v8, s38, v1
    v_add_u32 v9, 61440, v8
    v_lshlrev_b32 v3, 7, v0
    s_cmp_lg_u32 s28, 1
    s_cbranch_scc1 Lh3a
    v_add_u32 v2, 28721152, v3
    s_mov_b32 s60, 200000
Up44:
    buffer_load_dword v4, v2, s[20:23], 0 offen sc1
    s_sub_u32 s60, s60, 1
    s_cbranch_scc1 Ue45
    s_waitcnt vmcnt(0)
    v_xor_b32 v4, s100, v4
    v_cmp_ne_u32 vcc, 0, v4
    s_nop 1
    s_cmp_lg_u64 vcc, 0
    s_cbranch_scc1 Up44
Ue45:
    s_waitcnt vmcnt(0)
    s_mov_b64 exec, -1
Lh3a:
    s_or_b32 s33, s31, s32
    s_cbranch_scc1 Lh3
    s_lshl_b32 s33, s28, 13
    s_add_u32 s33, s33, 28467200
    v_add_u32 v2, s33, v3
    s_mov_b32 s60, 200000
Up46:
    buffer_load_dword v4, v2, s[20:23], 0 offen sc1
    s_sub_u32 s60, s60, 1
    s_cbranch_scc1 Ue47
    s_waitcnt vmcnt(0)
    v_xor_b32 v4, s100, v4
    v_cmp_ne_u32 vcc, 0, v4
    s_nop 1
    s_cmp_lg_u64 vcc, 0
    s_cbranch_scc1 Up46
Ue47:
    s_waitcnt vmcnt(0)
    s_mov_b64 exec, -1
Lh3:
    s_setprio 0
    s_mul_i32 s39, s30, 102400
    s_add_u32 s39, s39, 22806528
    s_add_u32 s39, s39, s38
    s_mov_b32 m0, s38
    s_barrier
    s_mov_b32 s37, 25
Ud48:
    buffer_load_dwordx4 v1, s[20:23], s39 offen sc1 lds
    s_waitcnt vmcnt(20)
    s_add_u32 m0, m0, 4096
    s_add_u32 s39, s39, 4096
    s_sub_u32 s37, s37, 1
    s_cmp_lg_u32 s37, 0
    s_cbranch_scc1 Ud48
    buffer_load_dword v18, v19, s[20:23], 0 offen sc1
    s_waitcnt vmcnt(0)
    s_mul_i32 s39, s63, 143360
    s_add_u32 s39, s39, 25837568
    s_add_u32 s39, s39, s38
    s_add_u32 m0, s38, 102400
    s_barrier
    s_barrier
    s_barrier
    s_mov_b32 s37, 14
Ud49:
    buffer_load_dwordx4 v1, s[20:23], s39 offen sc1 lds
    s_waitcnt vmcnt(20)
    s_add_u32 m0, m0, 4096
    s_add_u32 s39, s39, 4096
    s_sub_u32 s37, s37, 1
    s_cmp_lg_u32 s37, 0
    s_cbranch_scc1 Ud49
    s_barrier
    s_mov_b32 m0, s38
    s_waitcnt vmcnt(0)
    s_barrier
    ds_write_b128 v8, v[168:171] offset:0
    ds_write_b128 v8, v[172:175] offset:4096
    ds_write_b128 v8, v[176:179] offset:8192
    ds_write_b128 v8, v[180:183] offset:12288
    ds_write_b128 v8, v[184:187] offset:16384
    ds_write_b128 v8, v[188:191] offset:20480
    ds_write_b128 v8, v[192:195] offset:24576
    ds_write_b128 v8, v[196:199] offset:28672
    ds_write_b128 v8, v[200:203] offset:32768
    ds_write_b128 v8, v[204:207] offset:36864
    ds_write_b128 v8, v[208:211] offset:40960
    ds_write_b128 v8, v[212:215] offset:45056
    ds_write_b128 v8, v[216:219] offset:49152
    ds_write_b128 v8, v[220:223] offset:53248
    ds_write_b128 v8, v[224:227] offset:57344
    ds_write_b128 v9, v[228:231] offset:0
    ds_write_b128 v9, v[232:235] offset:4096
    ds_write_b128 v9, v[236:239] offset:8192
    ds_write_b128 v9, v[240:243] offset:12288
    ds_write_b128 v9, v[244:247] offset:16384
    ds_write_b128 v9, v[248:251] offset:20480
    s_waitcnt lgkmcnt(0)
    s_barrier
    s_add_u32 s39, s55, 122880
    s_add_u32 m0, s38, 122880
    s_barrier
    buffer_load_dwordx4 v1, s[20:23], s39 offen sc1 lds
    s_add_u32 m0, m0, 4096
    s_add_u32 s39, s39, 4096
    buffer_load_dwordx4 v1, s[20:23], s39 offen sc1 lds
    s_add_u32 m0, m0, 4096
    s_add_u32 s39, s39, 4096
    buffer_load_dwordx4 v1, s[20:23], s39 offen sc1 lds
    s_add_u32 m0, m0, 4096
    s_add_u32 s39, s39, 4096
    buffer_load_dwordx4 v1, s[20:23], s39 offen sc1 lds
    s_add_u32 m0, m0, 4096
    s_add_u32 s39, s39, 4096
    buffer_load_dwordx4 v1, s[20:23], s39 offen sc1 lds
    s_add_u32 m0, m0, 4096
    s_add_u32 s39, s39, 4096
    buffer_load_dwordx4 v1, s[20:23], s39 offen sc1 lds
    s_add_u32 m0, m0, 4096
    s_add_u32 s39, s39, 4096
    buffer_load_dwordx4 v1, s[20:23], s39 offen sc1 lds
    s_add_u32 m0, m0, 4096
    s_add_u32 s39, s39, 4096
    buffer_load_dwordx4 v1, s[20:23], s39 offen sc1 lds
    s_add_u32 m0, m0, 4096
    s_add_u32 s39, s39, 4096
    buffer_load_dwordx4 v1, s[20:23], s39 offen sc1 lds
    s_add_u32 m0, m0, 4096
    s_add_u32 s39, s39, 4096
    buffer_load_dwordx4 v1, s[20:23], s39 offen sc1 lds
    s_add_u32 m0, m0, 4096
    s_add_u32 s39, s39, 4096
    buffer_load_dwordx4 v[168:171], v1, s[20:23], s57 offen sc1
    s_add_u32 s57, s57, 4096
    buffer_load_dwordx4 v[172:175], v1, s[20:23], s57 offen sc1
    s_add_u32 s57, s57, 4096
    buffer_load_dwordx4 v[176:179], v1, s[20:23], s57 offen sc1
    s_add_u32 s57, s57, 4096
    buffer_load_dwordx4 v[180:183], v1, s[20:23], s57 offen sc1
    s_add_u32 s57, s57, 4096
    buffer_load_dwordx4 v[184:187], v1, s[20:23], s57 offen sc1
    s_add_u32 s57, s57, 4096
    buffer_load_dwordx4 v[188:191], v1, s[20:23], s57 offen sc1
    s_add_u32 s57, s57, 4096
    buffer_load_dwordx4 v[192:195], v1, s[20:23], s57 offen sc1
    s_add_u32 s57, s57, 4096
    buffer_load_dwordx4 v[196:199], v1, s[20:23], s57 offen sc1
    s_add_u32 s57, s57, 4096
    buffer_load_dwordx4 v[200:203], v1, s[20:23], s57 offen sc1
    s_add_u32 s57, s57, 4096
    buffer_load_dwordx4 v[204:207], v1, s[20:23], s57 offen sc1
    s_add_u32 s57, s57, 4096
    buffer_load_dwordx4 v[208:211], v1, s[20:23], s57 offen sc1
    s_add_u32 s57, s57, 4096
    buffer_load_dwordx4 v[212:215], v1, s[20:23], s57 offen sc1
    s_add_u32 s57, s57, 4096
    buffer_load_dwordx4 v[216:219], v1, s[20:23], s57 offen sc1
    s_add_u32 s57, s57, 4096
    buffer_load_dwordx4 v[220:223], v1, s[20:23], s57 offen sc1
    s_add_u32 s57, s57, 4096
    buffer_load_dwordx4 v[224:227], v1, s[20:23], s57 offen sc1
    s_add_u32 s57, s57, 4096
    buffer_load_dwordx4 v[228:231], v1, s[20:23], s57 offen sc1
    s_add_u32 s57, s57, 4096
    buffer_load_dwordx4 v[232:235], v1, s[20:23], s57 offen sc1
    s_add_u32 s57, s57, 4096
    buffer_load_dwordx4 v[236:239], v1, s[20:23], s57 offen sc1
    s_add_u32 s57, s57, 4096
    buffer_load_dwordx4 v[240:243], v1, s[20:23], s57 offen sc1
    s_add_u32 s57, s57, 4096
    buffer_load_dwordx4 v[244:247], v1, s[20:23], s57 offen sc1
    s_add_u32 s57, s57, 4096
    buffer_load_dwordx4 v[248:251], v1, s[20:23], s57 offen sc1
    s_add_u32 s57, s57, 4096
    s_barrier
    ds_write_b128 v8, v[20:23] offset:0
    ds_write_b128 v8, v[24:27] offset:4096
    ds_write_b128 v8, v[28:31] offset:8192
    ds_write_b128 v8, v[32:35] offset:12288
    ds_write_b128 v8, v[36:39] offset:16384
    ds_write_b128 v8, v[40:43] offset:20480
    ds_write_b128 v8, v[44:47] offset:24576
    ds_write_b128 v8, v[48:51] offset:28672
    ds_write_b128 v8, v[52:55] offset:32768
    ds_write_b128 v8, v[56:59] offset:36864
    ds_write_b128 v8, v[60:63] offset:40960
    ds_write_b128 v8, v[64:67] offset:45056
    ds_write_b128 v8, v[68:71] offset:49152
    ds_write_b128 v8, v[72:75] offset:53248
    ds_write_b128 v8, v[76:79] offset:57344
    ds_write_b128 v9, v[80:83] offset:0
    ds_write_b128 v9, v[84:87] offset:4096
    ds_write_b128 v9, v[88:91] offset:8192
    ds_write_b128 v9, v[92:95] offset:12288
    ds_write_b128 v9, v[96:99] offset:16384
    ds_write_b128 v9, v[100:103] offset:20480
    ds_write_b128 v9, v[104:107] offset:24576
    ds_write_b128 v9, v[108:111] offset:28672
    ds_write_b128 v9, v[112:115] offset:32768
    ds_write_b128 v9, v[116:119] offset:36864
    ds_write_b128 v9, v[120:123] offset:40960
    ds_write_b128 v9, v[124:127] offset:45056
    ds_write_b128 v9, v[128:131] offset:49152
    ds_write_b128 v9, v[132:135] offset:53248
    ds_write_b128 v9, v[136:139] offset:57344
    s_waitcnt lgkmcnt(0)
    s_setprio 3
    s_waitcnt vmcnt(0)
    s_cmp_lg_u32 s28, 0
    s_cbranch_scc1 Uh50
    s_mov_b32 s60, 200000
    s_mov_b32 exec_lo, 0xffffffff
    s_mov_b32 exec_hi, 0x0
Up51:
    s_sleep 2
    buffer_load_dword v4, v10, s[20:23], 0 offen sc1
    s_sub_u32 s60, s60, 1
    s_cbranch_scc1 Ue52
    s_waitcnt vmcnt(0)
    v_xor_b32 v4, s100, v4
    v_cmp_ne_u32 vcc, 0, v4
    s_nop 1
    s_cmp_lg_u64 vcc, 0
    s_cbranch_scc1 Up51
Ue52:
    s_waitcnt vmcnt(0)
    s_mov_b64 exec, -1
Uh50:
    s_barrier
    s_cmp_lg_u32 s28, 0
    s_cbranch_scc1 Uh53
    buffer_load_dword v13, v11, s[20:23], 0 offen sc1
Uh53:
    s_setprio 0
    s_barrier
    s_cmp_lg_u32 s28, 0
    s_cbranch_scc1 Uh54
    s_waitcnt vmcnt(0)
    v_xor_b32 v13, s100, v13
    v_cmp_ne_u32 vcc, 0, v13
    s_nop 1
    s_cmp_lg_u64 vcc, 0
    s_cbranch_scc0 Uk55
    s_mov_b32 s60, 200000
    s_mov_b32 exec_lo, 0xffffffff
    s_mov_b32 exec_hi, 0x0
Up56:
    buffer_load_dword v4, v11, s[20:23], 0 offen sc1
    s_sub_u32 s60, s60, 1
    s_cbranch_scc1 Ue57
    s_waitcnt vmcnt(0)
    v_xor_b32 v4, s100, v4
    v_cmp_ne_u32 vcc, 0, v4
    s_nop 1
    s_cmp_lg_u64 vcc, 0
    s_cbranch_scc1 Up56
Ue57:
    s_waitcnt vmcnt(0)
    s_mov_b64 exec, -1
Uk55:
Uh54:
    s_barrier
    s_waitcnt lgkmcnt(0)
    ds_write_b128 v8, v[140:143] offset:0
    ds_write_b128 v8, v[144:147] offset:4096
    ds_write_b128 v8, v[148:151] offset:8192
    s_barrier
    s_cmp_lg_u32 s28, 0
    s_cbranch_scc1 Uh58
    buffer_load_dword v13, v12, s[20:23], 0 offen sc1
Uh58:
    ds_write_b128 v8, v[152:155] offset:12288
    ds_write_b128 v8, v[156:159] offset:16384
    ds_write_b128 v8, v[160:163] offset:20480
    s_barrier
    ds_write_b128 v8, v[164:167] offset:24576
    ds_write_b128 v8, v[168:171] offset:28672
    ds_write_b128 v8, v[172:175] offset:32768
    s_barrier
    ds_write_b128 v8, v[176:179] offset:36864
    ds_write_b128 v8, v[180:183] offset:40960
    ds_write_b128 v8, v[184:187] offset:45056
    s_cmp_lg_u32 s28, 0
    s_cbranch_scc1 Uh59
    s_waitcnt vmcnt(0)
    v_xor_b32 v13, s100, v13
    v_cmp_ne_u32 vcc, 0, v13
    s_nop 1
    s_cmp_lg_u64 vcc, 0
    s_cbranch_scc0 Uk60
    s_mov_b32 s60, 200000
    s_mov_b32 exec_lo, 0xffffffff
    s_mov_b32 exec_hi, 0x0
Up61:
    buffer_load_dword v4, v12, s[20:23], 0 offen sc1
    s_sub_u32 s60, s60, 1
    s_cbranch_scc1 Ue62
    s_waitcnt vmcnt(0)
    v_xor_b32 v4, s100, v4
    v_cmp_ne_u32 vcc, 0, v4
    s_nop 1
    s_cmp_lg_u64 vcc, 0
    s_cbranch_scc1 Up61
Ue62:
    s_waitcnt vmcnt(0)
    s_mov_b64 exec, -1
Uk60:
Uh59:
    s_barrier
    ds_write_b128 v8, v[188:191] offset:49152
    ds_write_b128 v8, v[192:195] offset:53248
    ds_write_b128 v8, v[196:199] offset:57344
    s_barrier
    ds_write_b128 v9, v[200:203] offset:0
    ds_write_b128 v9, v[204:207] offset:4096
    ds_write_b128 v9, v[208:211] offset:8192
    s_waitcnt lgkmcnt(3)
    s_barrier
    ds_write_b128 v9, v[212:215] offset:12288
    ds_write_b128 v9, v[216:219] offset:16384
    ds_write_b128 v9, v[220:223] offset:20480
    s_waitcnt lgkmcnt(3)
    s_barrier
    ds_write_b128 v9, v[224:227] offset:24576
    ds_write_b128 v9, v[228:231] offset:28672
    ds_write_b128 v9, v[232:235] offset:32768
    s_waitcnt lgkmcnt(3)
    s_barrier
    ds_write_b128 v9, v[236:239] offset:36864
    ds_write_b128 v9, v[240:243] offset:40960
    ds_write_b128 v9, v[244:247] offset:45056
    s_waitcnt lgkmcnt(3)
    s_barrier
    ds_write_b128 v9, v[248:251] offset:49152
    s_waitcnt lgkmcnt(1)
    s_barrier
    s_waitcnt lgkmcnt(0)
    s_barrier
    s_waitcnt lgkmcnt(0)
    s_or_b32 s33, s31, s32
    s_or_b32 s33, s33, s28
    s_cbranch_scc1 Lh5
    s_mov_b32 s24, s82
    s_mov_b32 s25, s83
    s_mov_b32 s26, 256
    s_mov_b32 s27, 0x20000
    v_lshlrev_b32 v2, 2, v0
    v_mov_b32 v3, 0
    buffer_store_dword v3, v2, s[24:27], 0 offen sc1
Lh5:
    s_endpgm
Lend:
    s_endpgm
Lspare_h:
    s_mov_b32 s24, s82
    s_mov_b32 s25, s83
    s_mov_b32 s26, 256
    s_mov_b32 s27, 0x20000
    v_mov_b32 v205, 0
    buffer_load_dword v204, v205, s[24:27], 0 offen sc1
    s_waitcnt vmcnt(0)
    s_mov_b32 s60, 200000
Uz63:
    v_readfirstlane_b32 s100, v204
    s_nop 0
    s_cmp_lg_u32 s100, 0
    s_cbranch_scc1 Uz64
    buffer_load_dword v204, v205, s[24:27], 0 offen sc1
    s_waitcnt vmcnt(0)
    s_sub_u32 s60, s60, 1
    s_cbranch_scc0 Uz63
Uz64:
    s_mov_b32 s101, s100
    s_branch Lspare
Lspare_c:
    s_cmp_ge_u32 s3, 2
    s_cbranch_scc1 Uw65
    v_mov_b32 v234, 0x3f803f80
    v_mov_b32 v236, 0
    v_mov_b32 v237, 0
    v_mov_b32 v238, 0
    v_mov_b32 v239, 0
    s_waitcnt vmcnt(0)
    v_dot2_f32_bf16 v236, v208, v234, v236
    v_dot2_f32_bf16 v238, v208, v208, v238
    v_dot2_f32_bf16 v237, v209, v234, v237
    v_dot2_f32_bf16 v239, v209, v209, v239
    v_dot2_f32_bf16 v236, v210, v234, v236
    v_dot2_f32_bf16 v238, v210, v210, v238
    v_dot2_f32_bf16 v237, v211, v234, v237
    v_dot2_f32_bf16 v239, v211, v211, v239
    v_dot2_f32_bf16 v236, v212, v234, v236
    v_dot2_f32_bf16 v238, v212, v212, v238
    v_dot2_f32_bf16 v237, v213, v234, v237
    v_dot2_f32_bf16 v239, v213, v213, v239
    v_dot2_f32_bf16 v236, v214, v234, v236
    v_dot2_f32_bf16 v238, v214, v214, v238
    v_dot2_f32_bf16 v237, v215, v234, v237
    v_dot2_f32_bf16 v239, v215, v215, v239
    v_dot2_f32_bf16 v236, v216, v234, v236
    v_dot2_f32_bf16 v238, v216, v216, v238
    v_dot2_f32_bf16 v237, v217, v234, v237
    v_dot2_f32_bf16 v239, v217, v217, v239
    v_dot2_f32_bf16 v236, v218, v234, v236
    v_dot2_f32_bf16 v238, v218, v218, v238
    v_dot2_f32_bf16 v237, v219, v234, v237
    v_dot2_f32_bf16 v239, v219, v219, v239
    v_dot2_f32_bf16 v236, v220, v234, v236
    v_dot2_f32_bf16 v238, v220, v220, v238
    v_dot2_f32_bf16 v237, v221, v234, v237
    v_dot2_f32_bf16 v239, v221, v221, v239
    v_dot2_f32_bf16 v236, v222, v234, v236
    v_dot2_f32_bf16 v238, v222, v222, v238
    v_dot2_f32_bf16 v237, v223, v234, v237
    v_dot2_f32_bf16 v239, v223, v223, v239
    v_dot2_f32_bf16 v236, v224, v234, v236
    v_dot2_f32_bf16 v238, v224, v224, v238
    v_dot2_f32_bf16 v237, v225, v234, v237
    v_dot2_f32_bf16 v239, v225, v225, v239
    v_dot2_f32_bf16 v236, v226, v234, v236
    v_dot2_f32_bf16 v238, v226, v226, v238
    v_dot2_f32_bf16 v237, v227, v234, v237
    v_dot2_f32_bf16 v239, v227, v227, v239
    s_nop 2
    v_add_f32 v236, v236, v237
    v_add_f32 v238, v238, v239
    s_nop 1
    v_add_f32_dpp v236, v236, v236 row_ror:8 row_mask:0xf bank_mask:0xf
    v_add_f32_dpp v238, v238, v238 row_ror:8 row_mask:0xf bank_mask:0xf
    s_nop 1
    v_add_f32_dpp v236, v236, v236 row_ror:4 row_mask:0xf bank_mask:0xf
    v_add_f32_dpp v238, v238, v238 row_ror:4 row_mask:0xf bank_mask:0xf
    s_nop 1
    v_add_f32_dpp v236, v236, v236 row_ror:2 row_mask:0xf bank_mask:0xf
    v_add_f32_dpp v238, v238, v238 row_ror:2 row_mask:0xf bank_mask:0xf
    s_nop 1
    v_add_f32_dpp v236, v236, v236 row_ror:1 row_mask:0xf bank_mask:0xf
    v_add_f32_dpp v238, v238, v238 row_ror:1 row_mask:0xf bank_mask:0xf
    v_mul_f32 v236, 0x3acccccd, v236
    v_mul_f32 v238, 0x3acccccd, v238
    v_fma_f32 v238, -v236, v236, v238
    v_max_f32 v238, 0, v238
    v_cvt_pk_bf16_f32 v238, v238, v238
    v_lshlrev_b32 v238, 16, v238
    v_add_f32 v238, 0x3727c5ac, v238
    v_cvt_pk_bf16_f32 v238, v238, v238
    v_lshlrev_b32 v238, 16, v238
    v_sqrt_f32 v238, v238
    v_mul_f32 v236, 0x3e800000, v236
    v_cvt_pk_bf16_f32 v238, v238, v238
    v_lshlrev_b32 v238, 16, v238
    v_cvt_pk_bf16_f32 v244, -v236, -v236
    v_rcp_f32 v246, v238
    v_mul_f32 v238, 0x3e800000, v238
    v_lshrrev_b32 v245, 16, v238
    v_and_b32 v230, 48, v0
    s_lshl_b32 s54, s52, 6
    s_add_u32 s54, s54, 28278784
    s_mov_b32 exec_lo, 0x00010001
    s_mov_b32 exec_hi, 0x00010001
    buffer_store_dwordx4 v[244:247], v230, s[20:23], s54 offen sc1
    s_mov_b64 exec, -1
    s_branch Uw66
Uw65:
    v_mov_b32 v234, 0x3f80
    v_mov_b32 v235, 0x3f800000
    v_mov_b32 v236, 0
    v_mov_b32 v237, 0
    v_mov_b32 v238, 0
    v_mov_b32 v239, 0
    v_mov_b32 v240, 0
    v_mov_b32 v241, 0
    v_mov_b32 v242, 0
    v_mov_b32 v243, 0
    s_waitcnt vmcnt(0)
    v_dot2_f32_bf16 v236, v208, v234, v236
    v_dot2_f32_bf16 v237, v208, v235, v237
    v_dot2_f32_bf16 v238, v209, v234, v238
    v_dot2_f32_bf16 v239, v209, v235, v239
    v_dot2_f32_bf16 v240, v210, v234, v240
    v_dot2_f32_bf16 v241, v210, v235, v241
    v_dot2_f32_bf16 v242, v211, v234, v242
    v_dot2_f32_bf16 v243, v211, v235, v243
    v_dot2_f32_bf16 v236, v212, v234, v236
    v_dot2_f32_bf16 v237, v212, v235, v237
    v_dot2_f32_bf16 v238, v213, v234, v238
    v_dot2_f32_bf16 v239, v213, v235, v239
    v_dot2_f32_bf16 v240, v214, v234, v240
    v_dot2_f32_bf16 v241, v214, v235, v241
    v_dot2_f32_bf16 v242, v215, v234, v242
    v_dot2_f32_bf16 v243, v215, v235, v243
    v_dot2_f32_bf16 v236, v216, v234, v236
    v_dot2_f32_bf16 v237, v216, v235, v237
    v_dot2_f32_bf16 v238, v217, v234, v238
    v_dot2_f32_bf16 v239, v217, v235, v239
    v_dot2_f32_bf16 v240, v218, v234, v240
    v_dot2_f32_bf16 v241, v218, v235, v241
    v_dot2_f32_bf16 v242, v219, v234, v242
    v_dot2_f32_bf16 v243, v219, v235, v243
    v_dot2_f32_bf16 v236, v220, v234, v236
    v_dot2_f32_bf16 v237, v220, v235, v237
    v_dot2_f32_bf16 v238, v221, v234, v238
    v_dot2_f32_bf16 v239, v221, v235, v239
    v_dot2_f32_bf16 v240, v222, v234, v240
    v_dot2_f32_bf16 v241, v222, v235, v241
    v_dot2_f32_bf16 v242, v223, v234, v242
    v_dot2_f32_bf16 v243, v223, v235, v243
    v_dot2_f32_bf16 v236, v224, v234, v236
    v_dot2_f32_bf16 v237, v224, v235, v237
    v_dot2_f32_bf16 v238, v225, v234, v238
    v_dot2_f32_bf16 v239, v225, v235, v239
    v_dot2_f32_bf16 v240, v226, v234, v240
    v_dot2_f32_bf16 v241, v226, v235, v241
    v_dot2_f32_bf16 v242, v227, v234, v242
    v_dot2_f32_bf16 v243, v227, v235, v243
    s_nop 2
    v_permlane32_swap_b32 v236, v240
    v_permlane32_swap_b32 v237, v241
    v_permlane32_swap_b32 v238, v242
    v_permlane32_swap_b32 v239, v243
    v_add_f32 v236, v236, v240
    v_add_f32 v237, v237, v241
    v_add_f32 v238, v238, v242
    v_add_f32 v239, v239, v243
    s_nop 0
    v_permlane16_swap_b32 v236, v238
    v_permlane16_swap_b32 v237, v239
    v_add_f32 v236, v236, v238
    v_add_f32 v237, v237, v239
    v_and_b32 v230, 7, v0
    v_lshlrev_b32 v230, 5, v230
    v_add_f32_dpp v236, v236, v236 row_ror:8 row_mask:0xf bank_mask:0xf
    v_add_f32_dpp v237, v237, v237 row_ror:8 row_mask:0xf bank_mask:0xf
    v_lshrrev_b32 v231, 4, v0
    v_lshl_add_u32 v230, v231, 3, v230
    s_mul_i32 s54, s52, 7680
    s_lshl_b32 s55, s53, 8
    s_add_u32 s54, s54, s55
    s_add_u32 s54, s54, 28311552
    buffer_store_dwordx2 v[236:237], v230, s[20:23], s54 offen sc1
Uw66:
    s_mov_b32 s24, s82
    s_mov_b32 s25, s83
    s_mov_b32 s26, 256
    s_mov_b32 s27, 0x20000
    v_mov_b32 v205, 0
    buffer_load_dword v204, v205, s[24:27], 0 offen sc1
    s_waitcnt vmcnt(0)
    s_mov_b32 s60, 200000
Uz67:
    v_readfirstlane_b32 s100, v204
    s_nop 0
    s_cmp_lg_u32 s100, 0
    s_cbranch_scc1 Uz68
    buffer_load_dword v204, v205, s[24:27], 0 offen sc1
    s_waitcnt vmcnt(0)
    s_sub_u32 s60, s60, 1
    s_cbranch_scc0 Uz67
Uz68:
    s_mov_b32 s101, s100
    s_lshl_b32 s33, s2, 7
    s_add_u32 s33, s33, 28434432
    v_mov_b32 v202, s100
    v_lshlrev_b32 v203, 2, s28
    s_waitcnt vmcnt(0)
    s_mov_b64 exec, 1
    buffer_store_dword v202, v203, s[20:23], s33 offen sc1
    s_mov_b64 exec, -1
Lspare:
    s_barrier
    s_cmp_ge_u32 s29, 14
    s_cbranch_scc1 Lsp_done
    s_mov_b32 s12, s72
    s_mov_b32 s13, s73
    s_mov_b32 s14, 2211840
    s_mov_b32 s15, 0x20000
    s_mov_b32 s16, s74
    s_mov_b32 s17, s75
    s_mov_b32 s18, 3456
    s_mov_b32 s19, 0x20000
    v_lshrrev_b32 v2, 4, v0
    v_and_b32 v3, 15, v0
    v_mul_u32_u24 v2, 3456, v2
    v_lshl_add_u32 v2, v3, 4, v2
    s_mul_i32 s33, s3, 276480
    s_lshl_b32 s34, s29, 8
    s_add_u32 s33, s33, s34
    buffer_load_dwordx4 v[96:99], v2, s[12:15], s33 offen
    s_add_u32 s33, s33, 13824
    buffer_load_dwordx4 v[100:103], v2, s[12:15], s33 offen
    s_add_u32 s33, s33, 13824
    buffer_load_dwordx4 v[104:107], v2, s[12:15], s33 offen
    s_add_u32 s33, s33, 13824
    buffer_load_dwordx4 v[108:111], v2, s[12:15], s33 offen
    s_add_u32 s33, s33, 13824
    buffer_load_dwordx4 v[112:115], v2, s[12:15], s33 offen
    s_add_u32 s33, s33, 13824
    buffer_load_dwordx4 v[116:119], v2, s[12:15], s33 offen
    s_add_u32 s33, s33, 13824
    buffer_load_dwordx4 v[120:123], v2, s[12:15], s33 offen
    s_add_u32 s33, s33, 13824
    buffer_load_dwordx4 v[124:127], v2, s[12:15], s33 offen
    s_add_u32 s33, s33, 13824
    buffer_load_dwordx4 v[128:131], v2, s[12:15], s33 offen
    s_add_u32 s33, s33, 13824
    buffer_load_dwordx4 v[132:135], v2, s[12:15], s33 offen
    s_add_u32 s33, s33, 13824
    buffer_load_dwordx4 v[136:139], v2, s[12:15], s33 offen
    s_add_u32 s33, s33, 13824
    buffer_load_dwordx4 v[140:143], v2, s[12:15], s33 offen
    s_add_u32 s33, s33, 13824
    buffer_load_dwordx4 v[144:147], v2, s[12:15], s33 offen
    s_add_u32 s33, s33, 13824
    buffer_load_dwordx4 v[148:151], v2, s[12:15], s33 offen
    s_add_u32 s33, s33, 13824
    buffer_load_dwordx4 v[152:155], v2, s[12:15], s33 offen
    s_add_u32 s33, s33, 13824
    buffer_load_dwordx4 v[156:159], v2, s[12:15], s33 offen
    s_add_u32 s33, s33, 13824
    buffer_load_dwordx4 v[160:163], v2, s[12:15], s33 offen
    s_add_u32 s33, s33, 13824
    buffer_load_dwordx4 v[164:167], v2, s[12:15], s33 offen
    s_add_u32 s33, s33, 13824
    buffer_load_dwordx4 v[168:171], v2, s[12:15], s33 offen
    s_add_u32 s33, s33, 13824
    buffer_load_dwordx4 v[172:175], v2, s[12:15], s33 offen
    s_add_u32 s33, s33, 13824
    v_lshlrev_b32 v4, 1, v0
    s_lshl_b32 s35, s3, 7
    s_add_u32 s35, s35, s34
    buffer_load_ushort v90, v4, s[16:19], s35 offen
    v_mov_b32 v88, 0x3f80
    v_mov_b32 v89, 0x3f800000
    v_mov_b32 v80, 0
    v_mov_b32 v81, 0
    v_mov_b32 v82, 0
    v_mov_b32 v83, 0
    v_mov_b32 v84, 0
    v_mov_b32 v85, 0
    v_mov_b32 v86, 0
    v_mov_b32 v87, 0
    s_waitcnt vmcnt(20)
    v_dot2_f32_bf16 v80, v96, v88, v80
    v_dot2_f32_bf16 v81, v96, v89, v81
    v_dot2_f32_bf16 v82, v97, v88, v82
    v_dot2_f32_bf16 v83, v97, v89, v83
    v_dot2_f32_bf16 v84, v98, v88, v84
    v_dot2_f32_bf16 v85, v98, v89, v85
    v_dot2_f32_bf16 v86, v99, v88, v86
    v_dot2_f32_bf16 v87, v99, v89, v87
    s_waitcnt vmcnt(19)
    v_dot2_f32_bf16 v80, v100, v88, v80
    v_dot2_f32_bf16 v81, v100, v89, v81
    v_dot2_f32_bf16 v82, v101, v88, v82
    v_dot2_f32_bf16 v83, v101, v89, v83
    v_dot2_f32_bf16 v84, v102, v88, v84
    v_dot2_f32_bf16 v85, v102, v89, v85
    v_dot2_f32_bf16 v86, v103, v88, v86
    v_dot2_f32_bf16 v87, v103, v89, v87
    s_waitcnt vmcnt(18)
    v_dot2_f32_bf16 v80, v104, v88, v80
    v_dot2_f32_bf16 v81, v104, v89, v81
    v_dot2_f32_bf16 v82, v105, v88, v82
    v_dot2_f32_bf16 v83, v105, v89, v83
    v_dot2_f32_bf16 v84, v106, v88, v84
    v_dot2_f32_bf16 v85, v106, v89, v85
    v_dot2_f32_bf16 v86, v107, v88, v86
    v_dot2_f32_bf16 v87, v107, v89, v87
    s_waitcnt vmcnt(17)
    v_dot2_f32_bf16 v80, v108, v88, v80
    v_dot2_f32_bf16 v81, v108, v89, v81
    v_dot2_f32_bf16 v82, v109, v88, v82
    v_dot2_f32_bf16 v83, v109, v89, v83
    v_dot2_f32_bf16 v84, v110, v88, v84
    v_dot2_f32_bf16 v85, v110, v89, v85
    v_dot2_f32_bf16 v86, v111, v88, v86
    v_dot2_f32_bf16 v87, v111, v89, v87
    s_waitcnt vmcnt(16)
    v_dot2_f32_bf16 v80, v112, v88, v80
    v_dot2_f32_bf16 v81, v112, v89, v81
    v_dot2_f32_bf16 v82, v113, v88, v82
    v_dot2_f32_bf16 v83, v113, v89, v83
    v_dot2_f32_bf16 v84, v114, v88, v84
    v_dot2_f32_bf16 v85, v114, v89, v85
    v_dot2_f32_bf16 v86, v115, v88, v86
    v_dot2_f32_bf16 v87, v115, v89, v87
    s_waitcnt vmcnt(15)
    v_dot2_f32_bf16 v80, v116, v88, v80
    v_dot2_f32_bf16 v81, v116, v89, v81
    v_dot2_f32_bf16 v82, v117, v88, v82
    v_dot2_f32_bf16 v83, v117, v89, v83
    v_dot2_f32_bf16 v84, v118, v88, v84
    v_dot2_f32_bf16 v85, v118, v89, v85
    v_dot2_f32_bf16 v86, v119, v88, v86
    v_dot2_f32_bf16 v87, v119, v89, v87
    s_waitcnt vmcnt(14)
    v_dot2_f32_bf16 v80, v120, v88, v80
    v_dot2_f32_bf16 v81, v120, v89, v81
    v_dot2_f32_bf16 v82, v121, v88, v82
    v_dot2_f32_bf16 v83, v121, v89, v83
    v_dot2_f32_bf16 v84, v122, v88, v84
    v_dot2_f32_bf16 v85, v122, v89, v85
    v_dot2_f32_bf16 v86, v123, v88, v86
    v_dot2_f32_bf16 v87, v123, v89, v87
    s_waitcnt vmcnt(13)
    v_dot2_f32_bf16 v80, v124, v88, v80
    v_dot2_f32_bf16 v81, v124, v89, v81
    v_dot2_f32_bf16 v82, v125, v88, v82
    v_dot2_f32_bf16 v83, v125, v89, v83
    v_dot2_f32_bf16 v84, v126, v88, v84
    v_dot2_f32_bf16 v85, v126, v89, v85
    v_dot2_f32_bf16 v86, v127, v88, v86
    v_dot2_f32_bf16 v87, v127, v89, v87
    s_waitcnt vmcnt(12)
    v_dot2_f32_bf16 v80, v128, v88, v80
    v_dot2_f32_bf16 v81, v128, v89, v81
    v_dot2_f32_bf16 v82, v129, v88, v82
    v_dot2_f32_bf16 v83, v129, v89, v83
    v_dot2_f32_bf16 v84, v130, v88, v84
    v_dot2_f32_bf16 v85, v130, v89, v85
    v_dot2_f32_bf16 v86, v131, v88, v86
    v_dot2_f32_bf16 v87, v131, v89, v87
    s_waitcnt vmcnt(11)
    v_dot2_f32_bf16 v80, v132, v88, v80
    v_dot2_f32_bf16 v81, v132, v89, v81
    v_dot2_f32_bf16 v82, v133, v88, v82
    v_dot2_f32_bf16 v83, v133, v89, v83
    v_dot2_f32_bf16 v84, v134, v88, v84
    v_dot2_f32_bf16 v85, v134, v89, v85
    v_dot2_f32_bf16 v86, v135, v88, v86
    v_dot2_f32_bf16 v87, v135, v89, v87
    s_waitcnt vmcnt(10)
    v_dot2_f32_bf16 v80, v136, v88, v80
    v_dot2_f32_bf16 v81, v136, v89, v81
    v_dot2_f32_bf16 v82, v137, v88, v82
    v_dot2_f32_bf16 v83, v137, v89, v83
    v_dot2_f32_bf16 v84, v138, v88, v84
    v_dot2_f32_bf16 v85, v138, v89, v85
    v_dot2_f32_bf16 v86, v139, v88, v86
    v_dot2_f32_bf16 v87, v139, v89, v87
    s_waitcnt vmcnt(9)
    v_dot2_f32_bf16 v80, v140, v88, v80
    v_dot2_f32_bf16 v81, v140, v89, v81
    v_dot2_f32_bf16 v82, v141, v88, v82
    v_dot2_f32_bf16 v83, v141, v89, v83
    v_dot2_f32_bf16 v84, v142, v88, v84
    v_dot2_f32_bf16 v85, v142, v89, v85
    v_dot2_f32_bf16 v86, v143, v88, v86
    v_dot2_f32_bf16 v87, v143, v89, v87
    s_waitcnt vmcnt(8)
    v_dot2_f32_bf16 v80, v144, v88, v80
    v_dot2_f32_bf16 v81, v144, v89, v81
    v_dot2_f32_bf16 v82, v145, v88, v82
    v_dot2_f32_bf16 v83, v145, v89, v83
    v_dot2_f32_bf16 v84, v146, v88, v84
    v_dot2_f32_bf16 v85, v146, v89, v85
    v_dot2_f32_bf16 v86, v147, v88, v86
    v_dot2_f32_bf16 v87, v147, v89, v87
    s_waitcnt vmcnt(7)
    v_dot2_f32_bf16 v80, v148, v88, v80
    v_dot2_f32_bf16 v81, v148, v89, v81
    v_dot2_f32_bf16 v82, v149, v88, v82
    v_dot2_f32_bf16 v83, v149, v89, v83
    v_dot2_f32_bf16 v84, v150, v88, v84
    v_dot2_f32_bf16 v85, v150, v89, v85
    v_dot2_f32_bf16 v86, v151, v88, v86
    v_dot2_f32_bf16 v87, v151, v89, v87
    s_waitcnt vmcnt(6)
    v_dot2_f32_bf16 v80, v152, v88, v80
    v_dot2_f32_bf16 v81, v152, v89, v81
    v_dot2_f32_bf16 v82, v153, v88, v82
    v_dot2_f32_bf16 v83, v153, v89, v83
    v_dot2_f32_bf16 v84, v154, v88, v84
    v_dot2_f32_bf16 v85, v154, v89, v85
    v_dot2_f32_bf16 v86, v155, v88, v86
    v_dot2_f32_bf16 v87, v155, v89, v87
    s_waitcnt vmcnt(5)
    v_dot2_f32_bf16 v80, v156, v88, v80
    v_dot2_f32_bf16 v81, v156, v89, v81
    v_dot2_f32_bf16 v82, v157, v88, v82
    v_dot2_f32_bf16 v83, v157, v89, v83
    v_dot2_f32_bf16 v84, v158, v88, v84
    v_dot2_f32_bf16 v85, v158, v89, v85
    v_dot2_f32_bf16 v86, v159, v88, v86
    v_dot2_f32_bf16 v87, v159, v89, v87
    s_waitcnt vmcnt(4)
    v_dot2_f32_bf16 v80, v160, v88, v80
    v_dot2_f32_bf16 v81, v160, v89, v81
    v_dot2_f32_bf16 v82, v161, v88, v82
    v_dot2_f32_bf16 v83, v161, v89, v83
    v_dot2_f32_bf16 v84, v162, v88, v84
    v_dot2_f32_bf16 v85, v162, v89, v85
    v_dot2_f32_bf16 v86, v163, v88, v86
    v_dot2_f32_bf16 v87, v163, v89, v87
    s_waitcnt vmcnt(3)
    v_dot2_f32_bf16 v80, v164, v88, v80
    v_dot2_f32_bf16 v81, v164, v89, v81
    v_dot2_f32_bf16 v82, v165, v88, v82
    v_dot2_f32_bf16 v83, v165, v89, v83
    v_dot2_f32_bf16 v84, v166, v88, v84
    v_dot2_f32_bf16 v85, v166, v89, v85
    v_dot2_f32_bf16 v86, v167, v88, v86
    v_dot2_f32_bf16 v87, v167, v89, v87
    s_waitcnt vmcnt(2)
    v_dot2_f32_bf16 v80, v168, v88, v80
    v_dot2_f32_bf16 v81, v168, v89, v81
    v_dot2_f32_bf16 v82, v169, v88, v82
    v_dot2_f32_bf16 v83, v169, v89, v83
    v_dot2_f32_bf16 v84, v170, v88, v84
    v_dot2_f32_bf16 v85, v170, v89, v85
    v_dot2_f32_bf16 v86, v171, v88, v86
    v_dot2_f32_bf16 v87, v171, v89, v87
    s_waitcnt vmcnt(1)
    v_dot2_f32_bf16 v80, v172, v88, v80
    v_dot2_f32_bf16 v81, v172, v89, v81
    v_dot2_f32_bf16 v82, v173, v88, v82
    v_dot2_f32_bf16 v83, v173, v89, v83
    v_dot2_f32_bf16 v84, v174, v88, v84
    v_dot2_f32_bf16 v85, v174, v89, v85
    v_dot2_f32_bf16 v86, v175, v88, v86
    v_dot2_f32_bf16 v87, v175, v89, v87
    v_lshlrev_b32 v4, 5, v0
    s_lshl_b32 s33, s3, 11
    v_add_u32 v4, s33, v4
    s_nop 0
    ds_write_b128 v4, v[80:83]
    ds_write_b128 v4, v[84:87] offset:16
    s_waitcnt lgkmcnt(0)
    s_barrier
    s_cmp_ge_u32 s3, 2
    s_cbranch_scc1 Lsp_done
    v_lshlrev_b32 v4, 2, v0
    s_lshl_b32 s33, s3, 8
    v_add_u32 v4, s33, v4
    ds_read_b32 v96, v4 offset:0
    ds_read_b32 v97, v4 offset:512
    ds_read_b32 v98, v4 offset:1024
    ds_read_b32 v99, v4 offset:1536
    ds_read_b32 v100, v4 offset:2048
    ds_read_b32 v101, v4 offset:2560
    ds_read_b32 v102, v4 offset:3072
    ds_read_b32 v103, v4 offset:3584
    s_waitcnt lgkmcnt(0)
    ds_read_b32 v104, v4 offset:4096
    ds_read_b32 v105, v4 offset:4608
    ds_read_b32 v106, v4 offset:5120
    ds_read_b32 v107, v4 offset:5632
    ds_read_b32 v108, v4 offset:6144
    ds_read_b32 v109, v4 offset:6656
    ds_read_b32 v110, v4 offset:7168
    ds_read_b32 v111, v4 offset:7680
    s_waitcnt lgkmcnt(0)
    ds_read_b32 v112, v4 offset:8192
    ds_read_b32 v113, v4 offset:8704
    ds_read_b32 v114, v4 offset:9216
    ds_read_b32 v115, v4 offset:9728
    ds_read_b32 v116, v4 offset:10240
    ds_read_b32 v117, v4 offset:10752
    ds_read_b32 v118, v4 offset:11264
    ds_read_b32 v119, v4 offset:11776
    s_waitcnt lgkmcnt(0)
    ds_read_b32 v120, v4 offset:12288
    ds_read_b32 v121, v4 offset:12800
    ds_read_b32 v122, v4 offset:13312
    ds_read_b32 v123, v4 offset:13824
    ds_read_b32 v124, v4 offset:14336
    ds_read_b32 v125, v4 offset:14848
    ds_read_b32 v126, v4 offset:15360
    ds_read_b32 v127, v4 offset:15872
    s_waitcnt lgkmcnt(0)
    v_add_f32 v96, v96, v97
    v_add_f32 v96, v96, v98
    v_add_f32 v96, v96, v99
    v_add_f32 v96, v96, v100
    v_add_f32 v96, v96, v101
    v_add_f32 v96, v96, v102
    v_add_f32 v96, v96, v103
    v_add_f32 v96, v96, v104
    v_add_f32 v96, v96, v105
    v_add_f32 v96, v96, v106
    v_add_f32 v96, v96, v107
    v_add_f32 v96, v96, v108
    v_add_f32 v96, v96, v109
    v_add_f32 v96, v96, v110
    v_add_f32 v96, v96, v111
    v_add_f32 v96, v96, v112
    v_add_f32 v96, v96, v113
    v_add_f32 v96, v96, v114
    v_add_f32 v96, v96, v115
    v_add_f32 v96, v96, v116
    v_add_f32 v96, v96, v117
    v_add_f32 v96, v96, v118
    v_add_f32 v96, v96, v119
    v_add_f32 v96, v96, v120
    v_add_f32 v96, v96, v121
    v_add_f32 v96, v96, v122
    v_add_f32 v96, v96, v123
    v_add_f32 v96, v96, v124
    v_add_f32 v96, v96, v125
    v_add_f32 v96, v96, v126
    v_add_f32 v96, v96, v127
    v_cvt_pk_bf16_f32 v97, v96, v96
    v_lshlrev_b32 v97, 16, v97
    v_sub_f32 v96, v96, v97
    v_cvt_pk_bf16_f32 v92, v97, v96
    s_waitcnt vmcnt(0)
    v_mov_b32 v93, v90
    v_lshlrev_b32 v4, 3, v0
    s_lshl_b32 s35, s35, 2
    s_add_u32 s35, s35, 28262400
    buffer_store_dwordx2 v[92:93], v4, s[20:23], s35 offen sc1
Lsp_done:
    s_waitcnt vmcnt(0)
    s_barrier
    s_cmp_ge_u32 s3, 4
    s_cbranch_scc1 Lh2
    s_mov_b32 s30, 15
    s_lshl_b32 s58, s30, 1
    s_lshr_b32 s33, s28, 1
    s_add_u32 s58, s58, s33
    s_lshl_b32 s58, s58, 4
    s_add_u32 s58, s58, s29
    s_lshl_b32 s58, s58, 1
    s_and_b32 s33, s28, 1
    s_add_u32 s58, s58, s33
    s_lshl_b32 s58, s58, 7
    s_add_u32 s58, s58, 28598272
    s_branch Lc2
Lcode_end:
.section .rodata,"a"
.p2align 6
.amdhsa_kernel sequential_preLN__softmax_full_mha__dense_activation_gelu__prompt_kernel
  .amdhsa_next_free_vgpr 256
  .amdhsa_next_free_sgpr 102
  .amdhsa_accum_offset 256
  .amdhsa_group_segment_fixed_size 0
  .amdhsa_kernarg_size 88
  .amdhsa_user_sgpr_count 2
  .amdhsa_user_sgpr_kernarg_segment_ptr 1
  .amdhsa_system_sgpr_workgroup_id_x 1
.end_amdhsa_kernel
```
